```python
import torch

def _softmax(x, axis=-1):
    return torch.softmax(x, dim=axis)
def _gelu(x):
    return torch.nn.functional.gelu(x, approximate="tanh")
def _silu(x):
    return torch.nn.functional.silu(x)
def _sigmoid(x):
    return torch.sigmoid(x)
def _layernorm(x, axis=-1, eps=1e-5):
    m = x.mean(dim=axis, keepdim=True)
    v = x.var(dim=axis, keepdim=True, unbiased=False)
    return (x - m) / torch.sqrt(v + eps)
def _scatter_add(tgt, idx, src, axis=0):
    return tgt.clone().index_add_(axis, idx, src)
def _segment_sum(src, seg, n):
    out = torch.zeros((n,) + src.shape[1:], dtype=src.dtype)
    return out.index_add_(0, seg, src)
def _pad(x, pw):
    flat = tuple(v for pair in reversed(pw) for v in pair)
    return torch.nn.functional.pad(x, flat)

kernel_name = 'sequential_preLN__ssm_conv_h3__glu_gated_swiglu__prompt'

def setup_inputs():

    _w = (lambda a: (lambda t: t.to(torch.bfloat16) if t.is_floating_point() else t)(torch.as_tensor(a)))
    def _A_setup():
        B, S, D = 1, 2048, 448
        ks = 4
        return {
            "q": _w((lambda *s: torch.randn(*s, dtype=torch.bfloat16) * 0.05)(B, S, D)),
            "k": _w((lambda *s: torch.randn(*s, dtype=torch.bfloat16) * 0.2)(B, S, D)),
            "v": _w((lambda *s: torch.randn(*s, dtype=torch.bfloat16) * 0.2)(B, S, D)),
            "shift_k": _w((lambda *s: torch.randn(*s, dtype=torch.bfloat16) * 0.2)(D, ks) * 0.5),
            "ssm_k": _w((lambda *s: torch.randn(*s, dtype=torch.bfloat16) * 0.4)(D, S) * (1.0 / S ** 0.5)),
            "ssm_D": _w((lambda *s: torch.randn(*s, dtype=torch.bfloat16) * 0.2)(D)),
        }
    _A_in = _A_setup()

    def _B_setup():
        B, S, D, F = 1, 2048, 448, 1792
        return {
            "x": _w((lambda *s: torch.randn(*s, dtype=torch.bfloat16) * 0.05)(B, S, D)),
            "w1": _w((lambda *s: torch.randn(*s, dtype=torch.bfloat16) * 0.2)(D, F) * (2.0 / D) ** 0.5),
            "w3": _w((lambda *s: torch.randn(*s, dtype=torch.bfloat16) * 0.2)(D, F) * (2.0 / D) ** 0.5),
            "w2": _w((lambda *s: torch.randn(*s, dtype=torch.bfloat16) * 0.2)(F, D) * (2.0 / F) ** 0.5),
        }
    _B_in = _B_setup()

    return {
        "A_q": _A_in["q"],
        "A_k": _A_in["k"],
        "A_v": _A_in["v"],
        "A_shift_k": _A_in["shift_k"],
        "A_ssm_k": _A_in["ssm_k"],
        "A_ssm_D": _A_in["ssm_D"],
        "B_x": _B_in["x"],
        "B_w1": _B_in["w1"],
        "B_w3": _B_in["w3"],
        "B_w2": _B_in["w2"],
    }

def reference(A_q, A_k, A_v, A_shift_k, A_ssm_k, A_ssm_D, B_x, B_w1, B_w3, B_w2):
    def _A_ref(q, k, v, shift_k, ssm_k, ssm_D):
        B, S, D = q.shape
        ks = shift_k.shape[-1]
        k_pad = _pad(k, ((0, 0), (ks - 1, 0), (0, 0)))
        k_shift = torch.zeros_like(k)
        for t in range(ks):
            k_shift = k_shift + k_pad[:, t:t + S, :] * shift_k[:, ks - 1 - t][None, None, :]
        kv = k_shift * v
        L = 2 * S
        kv_pad = _pad(kv, ((0, 0), (0, S), (0, 0)))
        kf_pad = _pad(ssm_k, ((0, 0), (0, S)))
        kv_f = (lambda x, axes=(-2,-1): torch.fft.rfft2(x.float(), dim=axes))(kv_pad[:, None, :, :], axes=(1, 2))
        kf_f = (lambda x, axes=(-2,-1): torch.fft.rfft2(x.float(), dim=axes))(kf_pad[:, None, :], axes=(1, 2))
        kf_f = (lambda x, *d: x.permute(*d))(kf_f, 1, 2, 0)
        y_f = kv_f * kf_f[None, :, :, :]
        y = (lambda x, s, axes=(-2,-1): torch.fft.irfft2(x, s=s, dim=axes).to(torch.bfloat16))(y_f, (1, L), axes=(1, 2))[:, 0, :S, :]
        y = y + kv * ssm_D[None, None, :]
        return q * y

    def _B_ref(x, w1, w3, w2):
        gate = torch.einsum("bsd,df->bsf", x, w1)
        up = torch.einsum("bsd,df->bsf", x, w3)
        h = _silu(gate) * up
        out = torch.einsum("bsf,fd->bsd", h, w2)
        return out

    x = A_q
    h = x + _A_ref(_layernorm(x, axis=-1), A_k, A_v, A_shift_k, A_ssm_k, A_ssm_D)
    h2 = h + _B_ref(_layernorm(h, axis=-1), B_w1, B_w3, B_w2)
    return h2
```

```asm
; @launch grid=(256,1,1) block=(512,1,1) lds=163840
.amdgcn_target "amdgcn-amd-amdhsa--gfx950"
.text
.globl sequential_preLN__ssm_conv_h3__glu_gated_swiglu__prompt_kernel
.p2align 8
.type sequential_preLN__ssm_conv_h3__glu_gated_swiglu__prompt_kernel,@function
sequential_preLN__ssm_conv_h3__glu_gated_swiglu__prompt_kernel:
    s_cmp_ge_u32 s2, 256
    s_cbranch_scc1 k_end
    s_load_dwordx2 s[16:17], s[0:1], 96
    v_lshrrev_b32 v2, 6, v0
    s_nop 0
    v_readfirstlane_b32 s30, v2
    v_and_b32 v1, 63, v0
    s_mov_b32 s18, 67108864
    s_mov_b32 s19, 0x00020000
    s_lshr_b32 s31, s2, 3
    s_and_b32 s35, s2, 7
    s_cmp_ge_u32 s30, 4
    s_cbranch_scc1 k_roleY
    s_load_dwordx2 s[4:5], s[0:1], 8
    s_mov_b32 s6, 1835008
    s_mov_b32 s7, 0x00020000
    s_load_dwordx2 s[8:9], s[0:1], 16
    s_mov_b32 s10, 1835008
    s_mov_b32 s11, 0x00020000
    s_load_dwordx2 s[92:93], s[0:1], 24
    s_mov_b32 s94, 3584
    s_mov_b32 s95, 0x00020000
    s_load_dwordx2 s[12:13], s[0:1], 0
    s_mov_b32 s14, 1835008
    s_mov_b32 s15, 0x00020000
    s_load_dwordx2 s[96:97], s[0:1], 88
    s_mov_b32 s98, 256
    s_mov_b32 s99, 0x00020000
    s_load_dwordx2 s[26:27], s[0:1], 40
    s_load_dwordx2 s[20:21], s[0:1], 80
    s_mov_b32 s22, 1835008
    s_mov_b32 s23, 0x00020000
    s_setprio 3
    v_lshrrev_b32 v3, 3, v1
    v_mul_u32_u24 v3, 896, v3
    v_and_b32 v6, 7, v1
    v_lshl_add_u32 v3, v6, 4, v3
    v_mov_b32 v31, 160768
    v_mov_b32 v15, 1
    v_mov_b32 v250, 0
    s_cmp_eq_u32 s35, 7
    s_cbranch_scc1 k_statX
    s_lshl_b32 s34, s31, 2
    s_add_u32 s34, s34, s30
    s_mul_i32 s44, s34, 14336
    s_lshl_b32 s48, s35, 7
    s_add_u32 s44, s44, s48
    s_sub_u32 s48, s44, 3584
    v_add_u32 v4, s48, v3
    s_add_u32 s45, s44, 3584
    s_add_u32 s46, s44, 10752
    s_add_u32 s42, s44, 7168
    s_lshl_b32 s43, s35, 9
    v_lshlrev_b32 v5, 3, v1
    s_lshr_b32 s32, s30, 1
    s_and_b32 s33, s30, 1
    s_mul_i32 s41, s32, 6432
    s_add_u32 s41, s41, 16640
    s_mul_i32 s40, s33, 2560
    s_add_u32 s40, s40, s41
    s_lshl_b32 s38, s30, 12
    s_add_u32 s38, s38, 29504
    s_cmp_eq_u32 s34, 0
    s_cselect_b32 s39, 0, -1
    s_mul_i32 s48, s35, 266240
    s_lshl_b32 s49, s34, 6
    s_add_u32 s53, s48, s49
    s_add_u32 s53, s53, 18874368
    s_add_u32 s54, s53, 8320
    s_sub_u32 s51, s48, s49
    s_add_u32 s51, s51, 16785344
    s_add_u32 s52, s51, 8320
    s_mov_b32 s37, s34
    s_lshl_b32 s36, s35, 5
    s_add_u32 s36, s36, s31
    s_lshl_b32 s34, s36, 1
    s_add_u32 s34, s34, s32
    s_lshl_b32 s48, s34, 8
    s_add_u32 s57, s48, 5242880
    s_add_u32 s58, s57, 458752
    v_lshlrev_b32 v249, 2, v1
    v_and_b32 v12, 48, v1
    v_and_b32 v13, 3, v1
    v_lshl_add_u32 v12, v13, 2, v12
    v_bfe_u32 v13, v1, 2, 2
    s_lshl_b32 s48, s33, 3
    v_add_u32 v13, s48, v13
    v_mul_u32_u24 v13, 114688, v13
    v_lshl_add_u32 v2, v12, 2, v13
    v_mov_b32 v240, -1
    v_mov_b32 v241, -1
    v_mov_b32 v242, -1
    v_mov_b32 v243, -1
    s_mov_b32 m0, s40
    s_waitcnt lgkmcnt(0)
    buffer_load_dwordx2 v[32:33], v5, s[92:95], s43 offen
    buffer_load_dwordx4 v4, s[4:7], 0 offen nt lds
    s_add_u32 m0, s40, 1024
    s_nop 0
    buffer_load_dwordx4 v3, s[4:7], s45 offen nt lds
    s_add_u32 m0, s40, 2048
    s_mov_b32 exec_hi, 0
    buffer_load_dwordx4 v3, s[4:7], s46 offen nt lds
    s_mov_b32 exec_hi, -1
    s_mov_b32 m0, s38
    s_nop 0
    buffer_load_dwordx4 v3, s[8:11], s44 offen nt lds
    s_add_u32 m0, s38, 1024
    s_nop 0
    buffer_load_dwordx4 v3, s[8:11], s42 offen nt lds
    s_add_u32 m0, s38, 2048
    s_nop 0
    buffer_load_dwordx4 v3, s[12:15], s44 offen nt lds
    s_add_u32 m0, s38, 3072
    s_nop 0
    buffer_load_dwordx4 v3, s[12:15], s42 offen nt lds
    s_barrier
    buffer_store_dwordx4 v[240:243], v2, s[16:19], s57 offen sc1
    buffer_store_dwordx4 v[240:243], v2, s[16:19], s58 offen sc1
    s_mov_b64 exec, 1
    buffer_load_dword v251, v250, s[96:99], 0 offen sc1
    s_mov_b64 exec, -1
    s_lshl_b32 s43, s36, 2
    s_load_dword s28, s[26:27], s43
    s_mul_i32 s55, s36, 8320
    s_lshl_b32 s48, s33, 12
    s_add_u32 s56, s55, s48
    s_lshl_b32 s48, s32, 4
    s_add_u32 s56, s56, s48
    s_add_u32 s56, s56, 18874368
    s_lshl_b32 s48, s30, 11
    s_add_u32 s55, s55, s48
    s_add_u32 s55, s55, 16777216
    s_lshl_b32 s46, s35, 1
    s_add_u32 s46, s46, s33
    s_lshl_b32 s46, s46, 12
    s_add_u32 s46, s46, 20971520
    s_getreg_b32 s48, hwreg(HW_REG_XCC_ID)
    s_and_b32 s48, s48, 7
    s_lshl_b32 s48, s48, 3
    s_add_u32 s48, s48, s35
    s_add_u32 s48, s48, 0x40
    s_mul_i32 s59, s48, 0x01010101
    v_lshlrev_b32 v30, 4, v1
    v_bfe_u32 v7, v1, 2, 2
    v_lshlrev_b32 v7, 7, v7
    v_and_b32 v6, 48, v1
    v_lshl_add_u32 v7, v6, 1, v7
    v_and_b32 v6, 3, v1
    v_lshl_add_u32 v7, v6, 3, v7
    v_add_u32 v8, s40, v7
    v_add_u32 v9, s38, v7
    v_lshrrev_b32 v11, 2, v1
    v_mul_u32_u24 v11, 16640, v11
    v_lshl_add_u32 v11, v6, 4, v11
    v_and_b32 v3, 15, v1
    v_lshrrev_b32 v4, 4, v1
    v_add_u32 v12, 2, v3
    v_lshrrev_b32 v12, 1, v12
    v_and_b32 v13, 1, v3
    v_mul_u32_u24 v13, 4160, v13
    v_lshl_add_u32 v12, v12, 2, v13
    v_and_b32 v13, 1, v4
    v_lshl_add_u32 v12, v13, 4, v12
    v_lshrrev_b32 v13, 1, v4
    v_lshl_add_u32 v12, v13, 9, v12
    s_mul_i32 s49, s32, 8320
    s_lshl_b32 s50, s33, 8
    s_add_u32 s49, s49, s50
    v_add_u32 v16, s49, v12
    v_add_u32 v17, 1024, v16
    v_add_u32 v18, 2048, v16
    v_add_u32 v19, 3072, v16
    v_lshlrev_b32 v12, 2, v3
    v_sub_u32 v12, 60, v12
    v_and_b32 v13, 1, v4
    v_add_u32 v12, v12, v13
    v_lshrrev_b32 v13, 1, v4
    v_lshl_add_u32 v12, v13, 5, v12
    s_lshl_b32 s50, s33, 4
    v_add_u32 v12, s50, v12
    s_movk_i32 s49, 320
    s_movk_i32 s50, 1280
    v_add_u32 v13, 0, v12
    v_and_b32 v14, 60, v13
    v_lshl_add_u32 v14, v14, 2, s41
    v_and_b32 v5, 3, v13
    v_mad_u32_u24 v14, v5, s49, v14
    v_lshrrev_b32 v5, 6, v13
    v_mad_u32_u24 v20, v5, s50, v14
    v_add_u32 v13, 2, v12
    v_and_b32 v14, 60, v13
    v_lshl_add_u32 v14, v14, 2, s41
    v_and_b32 v5, 3, v13
    v_mad_u32_u24 v14, v5, s49, v14
    v_lshrrev_b32 v5, 6, v13
    v_mad_u32_u24 v21, v5, s50, v14
    v_add_u32 v13, 4, v12
    v_and_b32 v14, 60, v13
    v_lshl_add_u32 v14, v14, 2, s41
    v_and_b32 v5, 3, v13
    v_mad_u32_u24 v14, v5, s49, v14
    v_lshrrev_b32 v5, 6, v13
    v_mad_u32_u24 v22, v5, s50, v14
    v_add_u32 v13, 6, v12
    v_and_b32 v14, 60, v13
    v_lshl_add_u32 v14, v14, 2, s41
    v_and_b32 v5, 3, v13
    v_mad_u32_u24 v14, v5, s49, v14
    v_lshrrev_b32 v5, 6, v13
    v_mad_u32_u24 v23, v5, s50, v14
    v_add_u32 v13, 8, v12
    v_and_b32 v14, 60, v13
    v_lshl_add_u32 v14, v14, 2, s41
    v_and_b32 v5, 3, v13
    v_mad_u32_u24 v14, v5, s49, v14
    v_lshrrev_b32 v5, 6, v13
    v_mad_u32_u24 v24, v5, s50, v14
    v_add_u32 v13, 10, v12
    v_and_b32 v14, 60, v13
    v_lshl_add_u32 v14, v14, 2, s41
    v_and_b32 v5, 3, v13
    v_mad_u32_u24 v14, v5, s49, v14
    v_lshrrev_b32 v5, 6, v13
    v_mad_u32_u24 v25, v5, s50, v14
    v_add_u32 v13, 12, v12
    v_and_b32 v14, 60, v13
    v_lshl_add_u32 v14, v14, 2, s41
    v_and_b32 v5, 3, v13
    v_mad_u32_u24 v14, v5, s49, v14
    v_lshrrev_b32 v5, 6, v13
    v_mad_u32_u24 v26, v5, s50, v14
    v_add_u32 v13, 14, v12
    v_and_b32 v14, 60, v13
    v_lshl_add_u32 v14, v14, 2, s41
    v_and_b32 v5, 3, v13
    v_mad_u32_u24 v14, v5, s49, v14
    v_lshrrev_b32 v5, 6, v13
    v_mad_u32_u24 v27, v5, s50, v14
    v_lshrrev_b32 v12, 1, v4
    v_and_b32 v13, 1, v4
    v_lshl_or_b32 v12, v13, 1, v12
    v_lshlrev_b32 v13, 5, v12
    v_lshl_add_u32 v248, v3, 7, v13
    v_mul_u32_u24 v12, 320, v12
    v_lshl_add_u32 v12, v3, 4, v12
    s_mul_i32 s50, s33, 2560
    s_sub_u32 s50, s41, s50
    s_add_u32 s50, s50, 3760
    v_sub_u32 v28, s50, v12
    v_and_b32 v13, 1, v1
    v_mul_u32_u24 v13, 6432, v13
    v_bfe_u32 v12, v1, 1, 2
    v_mad_u32_u24 v13, v12, s49, v13
    v_lshrrev_b32 v12, 3, v1
    v_lshl_add_u32 v12, v12, 4, v13
    s_mul_i32 s50, s30, 1280
    s_add_u32 s50, s50, 16640
    v_add_u32 v29, s50, v12
    s_lshl_b32 s50, s32, 2
    v_add_u32 v10, s50, v31
    v_mov_b32 v247, s59
    v_mov_b32 v246, -1
    s_and_b32 s48, s59, 0xff
    s_movk_i32 s50, 0xff
    v_writelane_b32 v246, s50, 31
    v_writelane_b32 v247, s48, 31
    s_mov_b32 s50, 0xffff
    s_mov_b32 vcc_lo, 0x33333333
    s_mov_b32 vcc_hi, 0x33333333
    s_waitcnt vmcnt(7)
    ds_read_b64_tr_b16 v[40:41], v8 offset:0
    ds_read_b64_tr_b16 v[42:43], v8 offset:512
    ds_read_b64_tr_b16 v[44:45], v8 offset:1024
    ds_read_b64_tr_b16 v[46:47], v8 offset:1536
    ds_read_b64_tr_b16 v[48:49], v8 offset:2048
    v_alignbit_b32 v34, v32, v32, 16
    v_alignbit_b32 v35, v33, v33, 16
    v_and_b32 v36, 0xffff, v32
    v_bfi_b32 v37, s50, v33, v32
    v_and_b32 v38, 0xffff0000, v33
    s_waitcnt vmcnt(5)
    ds_read_b64_tr_b16 v[50:51], v9 offset:0
    ds_read_b64_tr_b16 v[52:53], v9 offset:512
    ds_read_b64_tr_b16 v[54:55], v9 offset:1024
    ds_read_b64_tr_b16 v[56:57], v9 offset:1536
    s_waitcnt lgkmcnt(4)
    v_and_b32 v40, s39, v40
    v_and_b32 v41, s39, v41
    v_dot2_f32_bf16 v67, v42, v34, 0
    v_dot2_f32_bf16 v66, v42, v36, 0
    v_dot2_f32_bf16 v69, v43, v34, 0
    v_dot2_f32_bf16 v68, v43, v36, 0
    v_dot2_f32_bf16 v71, v44, v34, 0
    v_dot2_f32_bf16 v70, v44, v36, 0
    v_dot2_f32_bf16 v73, v45, v34, 0
    v_dot2_f32_bf16 v72, v45, v36, 0
    v_dot2_f32_bf16 v75, v46, v34, 0
    v_dot2_f32_bf16 v74, v46, v36, 0
    v_dot2_f32_bf16 v77, v47, v34, 0
    v_dot2_f32_bf16 v76, v47, v36, 0
    v_dot2_f32_bf16 v79, v48, v34, 0
    v_dot2_f32_bf16 v78, v48, v36, 0
    v_dot2_f32_bf16 v81, v49, v34, 0
    v_dot2_f32_bf16 v80, v49, v36, 0
    s_waitcnt vmcnt(3)
    ds_read_b64_tr_b16 v[58:59], v9 offset:2048
    ds_read_b64_tr_b16 v[60:61], v9 offset:2560
    ds_read_b64_tr_b16 v[62:63], v9 offset:3072
    ds_read_b64_tr_b16 v[64:65], v9 offset:3584
    v_dot2_f32_bf16 v67, v41, v35, v67
    v_dot2_f32_bf16 v66, v41, v37, v66
    v_dot2_f32_bf16 v69, v42, v35, v69
    v_dot2_f32_bf16 v68, v42, v37, v68
    v_dot2_f32_bf16 v71, v43, v35, v71
    v_dot2_f32_bf16 v70, v43, v37, v70
    v_dot2_f32_bf16 v73, v44, v35, v73
    v_dot2_f32_bf16 v72, v44, v37, v72
    v_dot2_f32_bf16 v75, v45, v35, v75
    v_dot2_f32_bf16 v74, v45, v37, v74
    v_dot2_f32_bf16 v77, v46, v35, v77
    v_dot2_f32_bf16 v76, v46, v37, v76
    v_dot2_f32_bf16 v79, v47, v35, v79
    v_dot2_f32_bf16 v78, v47, v37, v78
    v_dot2_f32_bf16 v81, v48, v35, v81
    v_dot2_f32_bf16 v80, v48, v37, v80
    v_dot2_f32_bf16 v66, v40, v38, v66
    v_dot2_f32_bf16 v68, v41, v38, v68
    v_dot2_f32_bf16 v70, v42, v38, v70
    v_dot2_f32_bf16 v72, v43, v38, v72
    v_dot2_f32_bf16 v74, v44, v38, v74
    v_dot2_f32_bf16 v76, v45, v38, v76
    v_dot2_f32_bf16 v78, v46, v38, v78
    v_dot2_f32_bf16 v80, v47, v38, v80
    s_waitcnt lgkmcnt(4)
    v_lshlrev_b32 v82, 16, v50
    v_and_b32 v83, 0xffff0000, v50
    v_lshlrev_b32 v84, 16, v51
    v_and_b32 v85, 0xffff0000, v51
    v_lshlrev_b32 v86, 16, v52
    v_and_b32 v87, 0xffff0000, v52
    v_lshlrev_b32 v88, 16, v53
    v_and_b32 v89, 0xffff0000, v53
    v_lshlrev_b32 v90, 16, v54
    v_and_b32 v91, 0xffff0000, v54
    v_lshlrev_b32 v92, 16, v55
    v_and_b32 v93, 0xffff0000, v55
    v_lshlrev_b32 v94, 16, v56
    v_and_b32 v95, 0xffff0000, v56
    v_lshlrev_b32 v96, 16, v57
    v_and_b32 v97, 0xffff0000, v57
    v_pk_mul_f32 v[66:67], v[66:67], v[82:83]
    v_pk_mul_f32 v[68:69], v[68:69], v[84:85]
    v_pk_mul_f32 v[70:71], v[70:71], v[86:87]
    v_pk_mul_f32 v[72:73], v[72:73], v[88:89]
    v_pk_mul_f32 v[74:75], v[74:75], v[90:91]
    v_pk_mul_f32 v[76:77], v[76:77], v[92:93]
    v_pk_mul_f32 v[78:79], v[78:79], v[94:95]
    v_pk_mul_f32 v[80:81], v[80:81], v[96:97]
    v_cvt_pk_bf16_f32 v98, v81, v80
    v_cvt_pk_bf16_f32 v99, v79, v78
    v_cvt_pk_bf16_f32 v100, v77, v76
    v_cvt_pk_bf16_f32 v101, v75, v74
    v_cvt_pk_bf16_f32 v102, v73, v72
    v_cvt_pk_bf16_f32 v103, v71, v70
    v_cvt_pk_bf16_f32 v104, v69, v68
    v_cvt_pk_bf16_f32 v105, v67, v66
    s_waitcnt lgkmcnt(0)
    v_cndmask_b32_dpp v224, v102, v98, vcc quad_perm:[0,1,0,1] row_mask:0xf bank_mask:0xf
    v_cndmask_b32_dpp v225, v103, v99, vcc quad_perm:[0,1,0,1] row_mask:0xf bank_mask:0xf
    v_cndmask_b32_dpp v226, v104, v100, vcc quad_perm:[0,1,0,1] row_mask:0xf bank_mask:0xf
    v_cndmask_b32_dpp v227, v105, v101, vcc quad_perm:[0,1,0,1] row_mask:0xf bank_mask:0xf
    buffer_store_dwordx4 v[224:227], v11, s[16:19], s51 offen
    v_cndmask_b32_dpp v232, v62, v58, vcc quad_perm:[0,1,0,1] row_mask:0xf bank_mask:0xf
    v_cndmask_b32_dpp v233, v63, v59, vcc quad_perm:[0,1,0,1] row_mask:0xf bank_mask:0xf
    v_cndmask_b32_dpp v234, v64, v60, vcc quad_perm:[0,1,0,1] row_mask:0xf bank_mask:0xf
    v_cndmask_b32_dpp v235, v65, v61, vcc quad_perm:[0,1,0,1] row_mask:0xf bank_mask:0xf
    buffer_store_dwordx4 v[232:235], v11, s[16:19], s53 offen
    s_not_b64 vcc, vcc
    v_cndmask_b32_dpp v228, v98, v102, vcc quad_perm:[2,3,2,3] row_mask:0xf bank_mask:0xf
    v_cndmask_b32_dpp v229, v99, v103, vcc quad_perm:[2,3,2,3] row_mask:0xf bank_mask:0xf
    v_cndmask_b32_dpp v230, v100, v104, vcc quad_perm:[2,3,2,3] row_mask:0xf bank_mask:0xf
    v_cndmask_b32_dpp v231, v101, v105, vcc quad_perm:[2,3,2,3] row_mask:0xf bank_mask:0xf
    buffer_store_dwordx4 v[228:231], v11, s[16:19], s52 offen
    v_cndmask_b32_dpp v236, v58, v62, vcc quad_perm:[2,3,2,3] row_mask:0xf bank_mask:0xf
    v_cndmask_b32_dpp v237, v59, v63, vcc quad_perm:[2,3,2,3] row_mask:0xf bank_mask:0xf
    v_cndmask_b32_dpp v238, v60, v64, vcc quad_perm:[2,3,2,3] row_mask:0xf bank_mask:0xf
    v_cndmask_b32_dpp v239, v61, v65, vcc quad_perm:[2,3,2,3] row_mask:0xf bank_mask:0xf
    buffer_store_dwordx4 v[236:239], v11, s[16:19], s54 offen
    s_mov_b64 exec, 1
    ds_add_u32 v31, v15 offset:4
    s_mov_b64 exec, -1
    s_lshl_b32 s29, s30, 10
    s_add_u32 s29, s29, 103424
    v_add_u32 v12, s29, v30
    ds_write_b128 v12, v[240:243]
    ds_write_b128 v12, v[240:243] offset:4096
    s_lshl_b32 s29, s28, 16
    s_and_b32 s28, s28, 0xffff0000
    s_cmp_eq_u32 s32, 0
    s_cselect_b32 s28, s29, s28
    s_cmp_eq_u32 s31, 31
    s_cbranch_scc1 k_w31
k_w31r:
    s_mov_b32 s47, 16361
    s_and_b32 s48, s96, 127
    s_cbranch_scc1 k_plr
    s_mov_b32 s47, 0x4000
    s_mov_b64 exec, 1
    s_cmp_eq_u32 s31, 31
    s_waitcnt vmcnt(0)
    s_cbranch_scc1 k_fl31
    buffer_store_byte v247, v250, s[96:99], s37 offen
k_fl31r:
    s_mov_b32 exec_lo, -1
k_pl:
    buffer_load_dword v251, v249, s[96:99], 0 offen sc1
    s_waitcnt vmcnt(0)
    v_and_b32 v14, v246, v251
    v_cmp_ne_u32 vcc, v14, v247
    s_nop 0
    s_cmp_lg_u32 vcc_lo, 0
    s_cbranch_scc1 k_plr
k_plok:
    s_mov_b64 exec, -1
k_wx0:
    buffer_load_dwordx4 v[32:35], v30, s[16:19], s55 offen offset:0 sc1
    buffer_load_dwordx4 v[36:39], v30, s[16:19], s55 offen offset:1024 sc1
    s_waitcnt vmcnt(1)
    ds_write_b128 v29, v[32:35]
    s_waitcnt vmcnt(0)
    ds_write_b128 v29, v[36:39] offset:128
    s_mov_b64 exec, 1
    ds_add_u32 v31, v15 offset:12
    s_mov_b64 exec, -1
    buffer_load_dwordx4 v[176:179], v248, s[16:19], s56 offen offset:0 sc1
    buffer_load_dwordx4 v[180:183], v248, s[16:19], s56 offen offset:2048 sc1
    s_mov_b64 exec, 1
    ds_add_u32 v31, v15 offset:24
    s_mov_b64 exec, -1
    s_mov_b32 s47, 0x8000
L1_sp:
    ds_read_b32 v12, v31 offset:12
    s_waitcnt lgkmcnt(0)
    v_readfirstlane_b32 s48, v12
    s_nop 0
    s_cmp_ge_u32 s48, 8
    s_cbranch_scc1 L2_ok
    s_sleep 0
    s_sub_u32 s47, s47, 1
    s_cbranch_scc0 L1_sp
L2_ok:
    ds_read_b128 v[80:83], v20 offset:0
    ds_read_b128 v[84:87], v20 offset:1280
    ds_read_b128 v[88:91], v20 offset:2560
    ds_read_b128 v[92:95], v20 offset:3840
    ds_read2_b32 v[32:33], v16 offset0:0 offset1:1
    ds_read2_b32 v[34:35], v16 offset0:2 offset1:3
    ds_read2_b32 v[36:37], v17 offset0:0 offset1:1
    ds_read2_b32 v[38:39], v17 offset0:2 offset1:3
    ds_read2_b32 v[40:41], v18 offset0:0 offset1:1
    ds_read2_b32 v[42:43], v18 offset0:2 offset1:3
    ds_read2_b32 v[44:45], v19 offset0:0 offset1:1
    ds_read2_b32 v[46:47], v19 offset0:2 offset1:3
    ds_read2_b32 v[48:49], v16 offset0:8 offset1:9
    ds_read2_b32 v[50:51], v16 offset0:10 offset1:11
    ds_read2_b32 v[52:53], v17 offset0:8 offset1:9
    ds_read2_b32 v[54:55], v17 offset0:10 offset1:11
    ds_read2_b32 v[56:57], v18 offset0:8 offset1:9
    ds_read2_b32 v[58:59], v18 offset0:10 offset1:11
    ds_read2_b32 v[60:61], v19 offset0:8 offset1:9
    ds_read2_b32 v[62:63], v19 offset0:10 offset1:11
    s_lshl_b32 s49, s30, 12
    s_add_u32 s49, s49, 29504
    v_add_u32 v12, s49, v30
    s_xor_b32 s49, s30, 1
    s_lshl_b32 s49, s49, 12
    s_add_u32 s49, s49, 29504
    v_add_u32 v13, s49, v30
    s_lshl_b32 s49, s33, 11
    s_add_u32 s49, s49, 103424
    v_add_u32 v248, s49, v30
    s_waitcnt lgkmcnt(0)
    v_mfma_f32_16x16x32_bf16 v[112:115], v[32:35], v[92:95], 0
    ds_read_b128 v[96:99], v21 offset:0
    v_mfma_f32_16x16x32_bf16 v[120:123], v[32:35], v[88:91], 0
    ds_read_b128 v[100:103], v21 offset:1280
    v_mfma_f32_16x16x32_bf16 v[120:123], v[36:39], v[92:95], v[120:123]
    ds_read_b128 v[104:107], v21 offset:2560
    v_mfma_f32_16x16x32_bf16 v[128:131], v[32:35], v[84:87], 0
    ds_read_b128 v[108:111], v21 offset:3840
    v_mfma_f32_16x16x32_bf16 v[128:131], v[36:39], v[88:91], v[128:131]
    ds_read2_b32 v[64:65], v16 offset0:16 offset1:17
    v_mfma_f32_16x16x32_bf16 v[128:131], v[40:43], v[92:95], v[128:131]
    ds_read2_b32 v[66:67], v16 offset0:18 offset1:19
    v_mfma_f32_16x16x32_bf16 v[136:139], v[32:35], v[80:83], 0
    ds_read2_b32 v[68:69], v17 offset0:16 offset1:17
    v_mfma_f32_16x16x32_bf16 v[136:139], v[36:39], v[84:87], v[136:139]
    ds_read2_b32 v[70:71], v17 offset0:18 offset1:19
    v_mfma_f32_16x16x32_bf16 v[136:139], v[40:43], v[88:91], v[136:139]
    ds_read2_b32 v[72:73], v18 offset0:16 offset1:17
    v_mfma_f32_16x16x32_bf16 v[136:139], v[44:47], v[92:95], v[136:139]
    ds_read2_b32 v[74:75], v18 offset0:18 offset1:19
    v_mfma_f32_16x16x32_bf16 v[116:119], v[48:51], v[92:95], 0
    ds_read2_b32 v[76:77], v19 offset0:16 offset1:17
    v_mfma_f32_16x16x32_bf16 v[124:127], v[48:51], v[88:91], 0
    ds_read2_b32 v[78:79], v19 offset0:18 offset1:19
    v_mfma_f32_16x16x32_bf16 v[124:127], v[52:55], v[92:95], v[124:127]
    ds_read_b128 v[200:203], v28 offset:1280
    v_mfma_f32_16x16x32_bf16 v[132:135], v[48:51], v[84:87], 0
    ds_read_b128 v[204:207], v28
    v_mfma_f32_16x16x32_bf16 v[132:135], v[52:55], v[88:91], v[132:135]
    v_mfma_f32_16x16x32_bf16 v[132:135], v[56:59], v[92:95], v[132:135]
    v_mfma_f32_16x16x32_bf16 v[140:143], v[48:51], v[80:83], 0
    v_mfma_f32_16x16x32_bf16 v[140:143], v[52:55], v[84:87], v[140:143]
    v_mfma_f32_16x16x32_bf16 v[140:143], v[56:59], v[88:91], v[140:143]
    v_mfma_f32_16x16x32_bf16 v[140:143], v[60:63], v[92:95], v[140:143]
    s_waitcnt lgkmcnt(0)
    v_mfma_f32_16x16x32_bf16 v[112:115], v[48:51], v[108:111], v[112:115]
    ds_read_b128 v[80:83], v22 offset:0
    v_and_b32 v160, 0xffff0000, v203
    v_mfma_f32_16x16x32_bf16 v[120:123], v[48:51], v[104:107], v[120:123]
    ds_read_b128 v[84:87], v22 offset:1280
    v_lshlrev_b32 v161, 16, v203
    v_mfma_f32_16x16x32_bf16 v[120:123], v[52:55], v[108:111], v[120:123]
    ds_read_b128 v[88:91], v22 offset:2560
    v_and_b32 v162, 0xffff0000, v202
    v_mfma_f32_16x16x32_bf16 v[128:131], v[48:51], v[100:103], v[128:131]
    ds_read_b128 v[92:95], v22 offset:3840
    v_lshlrev_b32 v163, 16, v202
    v_mfma_f32_16x16x32_bf16 v[128:131], v[52:55], v[104:107], v[128:131]
    ds_read2_b32 v[32:33], v16 offset0:24 offset1:25
    v_and_b32 v164, 0xffff0000, v201
    v_mfma_f32_16x16x32_bf16 v[128:131], v[56:59], v[108:111], v[128:131]
    ds_read2_b32 v[34:35], v16 offset0:26 offset1:27
    v_lshlrev_b32 v165, 16, v201
    v_mfma_f32_16x16x32_bf16 v[136:139], v[48:51], v[96:99], v[136:139]
    ds_read2_b32 v[36:37], v17 offset0:24 offset1:25
    v_and_b32 v166, 0xffff0000, v200
    v_mfma_f32_16x16x32_bf16 v[136:139], v[52:55], v[100:103], v[136:139]
    ds_read2_b32 v[38:39], v17 offset0:26 offset1:27
    v_lshlrev_b32 v167, 16, v200
    v_mfma_f32_16x16x32_bf16 v[136:139], v[56:59], v[104:107], v[136:139]
    ds_read2_b32 v[40:41], v18 offset0:24 offset1:25
    v_and_b32 v168, 0xffff0000, v207
    v_mfma_f32_16x16x32_bf16 v[136:139], v[60:63], v[108:111], v[136:139]
    ds_read2_b32 v[42:43], v18 offset0:26 offset1:27
    v_lshlrev_b32 v169, 16, v207
    v_mfma_f32_16x16x32_bf16 v[116:119], v[64:67], v[108:111], v[116:119]
    ds_read2_b32 v[44:45], v19 offset0:24 offset1:25
    v_and_b32 v170, 0xffff0000, v206
    v_mfma_f32_16x16x32_bf16 v[124:127], v[64:67], v[104:107], v[124:127]
    ds_read2_b32 v[46:47], v19 offset0:26 offset1:27
    v_lshlrev_b32 v171, 16, v206
    v_mfma_f32_16x16x32_bf16 v[124:127], v[68:71], v[108:111], v[124:127]
    v_and_b32 v172, 0xffff0000, v205
    v_lshlrev_b32 v173, 16, v205
    v_mfma_f32_16x16x32_bf16 v[132:135], v[64:67], v[100:103], v[132:135]
    v_and_b32 v174, 0xffff0000, v204
    v_lshlrev_b32 v175, 16, v204
    v_mfma_f32_16x16x32_bf16 v[132:135], v[68:71], v[104:107], v[132:135]
    v_mul_f32 v160, s28, v160
    v_mul_f32 v161, s28, v161
    v_mfma_f32_16x16x32_bf16 v[132:135], v[72:75], v[108:111], v[132:135]
    v_mul_f32 v162, s28, v162
    v_mul_f32 v163, s28, v163
    v_mfma_f32_16x16x32_bf16 v[140:143], v[64:67], v[96:99], v[140:143]
    v_mul_f32 v164, s28, v164
    v_mul_f32 v165, s28, v165
    v_mfma_f32_16x16x32_bf16 v[140:143], v[68:71], v[100:103], v[140:143]
    v_mul_f32 v166, s28, v166
    v_mul_f32 v167, s28, v167
    v_mfma_f32_16x16x32_bf16 v[140:143], v[72:75], v[104:107], v[140:143]
    v_mul_f32 v168, s28, v168
    v_mul_f32 v169, s28, v169
    v_mfma_f32_16x16x32_bf16 v[140:143], v[76:79], v[108:111], v[140:143]
    v_mul_f32 v170, s28, v170
    v_mul_f32 v171, s28, v171
    s_waitcnt lgkmcnt(0)
    v_mfma_f32_16x16x32_bf16 v[112:115], v[64:67], v[92:95], v[112:115]
    ds_read_b128 v[96:99], v23 offset:0
    v_mul_f32 v172, s28, v172
    v_mfma_f32_16x16x32_bf16 v[120:123], v[64:67], v[88:91], v[120:123]
    ds_read_b128 v[100:103], v23 offset:1280
    v_mul_f32 v173, s28, v173
    v_mfma_f32_16x16x32_bf16 v[120:123], v[68:71], v[92:95], v[120:123]
    ds_read_b128 v[104:107], v23 offset:2560
    v_mul_f32 v174, s28, v174
    v_mfma_f32_16x16x32_bf16 v[128:131], v[64:67], v[84:87], v[128:131]
    ds_read_b128 v[108:111], v23 offset:3840
    v_mul_f32 v175, s28, v175
    v_mfma_f32_16x16x32_bf16 v[128:131], v[68:71], v[88:91], v[128:131]
    ds_read2_b32 v[48:49], v16 offset0:32 offset1:33
    v_mfma_f32_16x16x32_bf16 v[128:131], v[72:75], v[92:95], v[128:131]
    ds_read2_b32 v[50:51], v16 offset0:34 offset1:35
    v_mfma_f32_16x16x32_bf16 v[136:139], v[64:67], v[80:83], v[136:139]
    ds_read2_b32 v[52:53], v17 offset0:32 offset1:33
    v_mfma_f32_16x16x32_bf16 v[136:139], v[68:71], v[84:87], v[136:139]
    ds_read2_b32 v[54:55], v17 offset0:34 offset1:35
    v_mfma_f32_16x16x32_bf16 v[136:139], v[72:75], v[88:91], v[136:139]
    ds_read2_b32 v[56:57], v18 offset0:32 offset1:33
    v_mfma_f32_16x16x32_bf16 v[136:139], v[76:79], v[92:95], v[136:139]
    ds_read2_b32 v[58:59], v18 offset0:34 offset1:35
    v_mfma_f32_16x16x32_bf16 v[116:119], v[32:35], v[92:95], v[116:119]
    ds_read2_b32 v[60:61], v19 offset0:32 offset1:33
    v_mfma_f32_16x16x32_bf16 v[124:127], v[32:35], v[88:91], v[124:127]
    ds_read2_b32 v[62:63], v19 offset0:34 offset1:35
    v_mfma_f32_16x16x32_bf16 v[124:127], v[36:39], v[92:95], v[124:127]
    v_mfma_f32_16x16x32_bf16 v[132:135], v[32:35], v[84:87], v[132:135]
    v_mfma_f32_16x16x32_bf16 v[132:135], v[36:39], v[88:91], v[132:135]
    v_mfma_f32_16x16x32_bf16 v[132:135], v[40:43], v[92:95], v[132:135]
    v_mfma_f32_16x16x32_bf16 v[140:143], v[32:35], v[80:83], v[140:143]
    v_mfma_f32_16x16x32_bf16 v[140:143], v[36:39], v[84:87], v[140:143]
    v_mfma_f32_16x16x32_bf16 v[140:143], v[40:43], v[88:91], v[140:143]
    v_mfma_f32_16x16x32_bf16 v[140:143], v[44:47], v[92:95], v[140:143]
    s_waitcnt lgkmcnt(0)
    v_mfma_f32_16x16x32_bf16 v[112:115], v[32:35], v[108:111], v[112:115]
    ds_read_b128 v[80:83], v24 offset:0
    v_mfma_f32_16x16x32_bf16 v[120:123], v[32:35], v[104:107], v[120:123]
    ds_read_b128 v[84:87], v24 offset:1280
    v_mfma_f32_16x16x32_bf16 v[120:123], v[36:39], v[108:111], v[120:123]
    ds_read_b128 v[88:91], v24 offset:2560
    v_mfma_f32_16x16x32_bf16 v[128:131], v[32:35], v[100:103], v[128:131]
    ds_read_b128 v[92:95], v24 offset:3840
    v_mfma_f32_16x16x32_bf16 v[128:131], v[36:39], v[104:107], v[128:131]
    ds_read2_b32 v[64:65], v16 offset0:40 offset1:41
    v_mfma_f32_16x16x32_bf16 v[128:131], v[40:43], v[108:111], v[128:131]
    ds_read2_b32 v[66:67], v16 offset0:42 offset1:43
    v_mfma_f32_16x16x32_bf16 v[136:139], v[32:35], v[96:99], v[136:139]
    ds_read2_b32 v[68:69], v17 offset0:40 offset1:41
    v_mfma_f32_16x16x32_bf16 v[136:139], v[36:39], v[100:103], v[136:139]
    ds_read2_b32 v[70:71], v17 offset0:42 offset1:43
    v_mfma_f32_16x16x32_bf16 v[136:139], v[40:43], v[104:107], v[136:139]
    ds_read2_b32 v[72:73], v18 offset0:40 offset1:41
    v_mfma_f32_16x16x32_bf16 v[136:139], v[44:47], v[108:111], v[136:139]
    ds_read2_b32 v[74:75], v18 offset0:42 offset1:43
    v_mfma_f32_16x16x32_bf16 v[116:119], v[48:51], v[108:111], v[116:119]
    ds_read2_b32 v[76:77], v19 offset0:40 offset1:41
    v_mfma_f32_16x16x32_bf16 v[124:127], v[48:51], v[104:107], v[124:127]
    ds_read2_b32 v[78:79], v19 offset0:42 offset1:43
    v_mfma_f32_16x16x32_bf16 v[124:127], v[52:55], v[108:111], v[124:127]
    v_mfma_f32_16x16x32_bf16 v[132:135], v[48:51], v[100:103], v[132:135]
    v_mfma_f32_16x16x32_bf16 v[132:135], v[52:55], v[104:107], v[132:135]
    v_mfma_f32_16x16x32_bf16 v[132:135], v[56:59], v[108:111], v[132:135]
    v_mfma_f32_16x16x32_bf16 v[140:143], v[48:51], v[96:99], v[140:143]
    v_mfma_f32_16x16x32_bf16 v[140:143], v[52:55], v[100:103], v[140:143]
    v_mfma_f32_16x16x32_bf16 v[140:143], v[56:59], v[104:107], v[140:143]
    v_mfma_f32_16x16x32_bf16 v[140:143], v[60:63], v[108:111], v[140:143]
    s_waitcnt lgkmcnt(0)
    v_mfma_f32_16x16x32_bf16 v[112:115], v[48:51], v[92:95], v[112:115]
    ds_read_b128 v[96:99], v25 offset:0
    s_waitcnt vmcnt(0)
    v_mfma_f32_16x16x32_bf16 v[120:123], v[48:51], v[88:91], v[120:123]
    ds_read_b128 v[100:103], v25 offset:1280
    v_lshlrev_b32 v184, 16, v176
    v_mfma_f32_16x16x32_bf16 v[120:123], v[52:55], v[92:95], v[120:123]
    ds_read_b128 v[104:107], v25 offset:2560
    v_and_b32 v185, 0xffff0000, v176
    v_mfma_f32_16x16x32_bf16 v[128:131], v[48:51], v[84:87], v[128:131]
    ds_read_b128 v[108:111], v25 offset:3840
    v_lshlrev_b32 v186, 16, v177
    v_mfma_f32_16x16x32_bf16 v[128:131], v[52:55], v[88:91], v[128:131]
    ds_read2_b32 v[32:33], v16 offset0:48 offset1:49
    v_and_b32 v187, 0xffff0000, v177
    v_mfma_f32_16x16x32_bf16 v[128:131], v[56:59], v[92:95], v[128:131]
    ds_read2_b32 v[34:35], v16 offset0:50 offset1:51
    v_lshlrev_b32 v188, 16, v178
    v_mfma_f32_16x16x32_bf16 v[136:139], v[48:51], v[80:83], v[136:139]
    ds_read2_b32 v[36:37], v17 offset0:48 offset1:49
    v_and_b32 v189, 0xffff0000, v178
    v_mfma_f32_16x16x32_bf16 v[136:139], v[52:55], v[84:87], v[136:139]
    ds_read2_b32 v[38:39], v17 offset0:50 offset1:51
    v_lshlrev_b32 v190, 16, v179
    v_mfma_f32_16x16x32_bf16 v[136:139], v[56:59], v[88:91], v[136:139]
    ds_read2_b32 v[40:41], v18 offset0:48 offset1:49
    v_and_b32 v191, 0xffff0000, v179
    v_mfma_f32_16x16x32_bf16 v[136:139], v[60:63], v[92:95], v[136:139]
    ds_read2_b32 v[42:43], v18 offset0:50 offset1:51
    v_lshlrev_b32 v192, 16, v180
    v_mfma_f32_16x16x32_bf16 v[116:119], v[64:67], v[92:95], v[116:119]
    ds_read2_b32 v[44:45], v19 offset0:48 offset1:49
    v_and_b32 v193, 0xffff0000, v180
    v_mfma_f32_16x16x32_bf16 v[124:127], v[64:67], v[88:91], v[124:127]
    ds_read2_b32 v[46:47], v19 offset0:50 offset1:51
    v_lshlrev_b32 v194, 16, v181
    v_mfma_f32_16x16x32_bf16 v[124:127], v[68:71], v[92:95], v[124:127]
    ds_read_b128 v[216:219], v248 offset:0
    v_and_b32 v195, 0xffff0000, v181
    v_mfma_f32_16x16x32_bf16 v[132:135], v[64:67], v[84:87], v[132:135]
    ds_read_b128 v[220:223], v248 offset:4096
    v_lshlrev_b32 v196, 16, v182
    v_mfma_f32_16x16x32_bf16 v[132:135], v[68:71], v[88:91], v[132:135]
    ds_read_b128 v[224:227], v248 offset:1024
    v_and_b32 v197, 0xffff0000, v182
    v_mfma_f32_16x16x32_bf16 v[132:135], v[72:75], v[92:95], v[132:135]
    ds_read_b128 v[228:231], v248 offset:5120
    v_lshlrev_b32 v198, 16, v183
    v_mfma_f32_16x16x32_bf16 v[140:143], v[64:67], v[80:83], v[140:143]
    v_and_b32 v199, 0xffff0000, v183
    v_mfma_f32_16x16x32_bf16 v[140:143], v[68:71], v[84:87], v[140:143]
    v_mfma_f32_16x16x32_bf16 v[140:143], v[72:75], v[88:91], v[140:143]
    v_mfma_f32_16x16x32_bf16 v[140:143], v[76:79], v[92:95], v[140:143]
    s_waitcnt lgkmcnt(0)
    v_mfma_f32_16x16x32_bf16 v[112:115], v[64:67], v[108:111], v[112:115]
    ds_read_b128 v[80:83], v26 offset:0
    v_max3_u32 v144, v216, v217, v218
    v_mfma_f32_16x16x32_bf16 v[120:123], v[64:67], v[104:107], v[120:123]
    ds_read_b128 v[84:87], v26 offset:1280
    v_max3_u32 v145, v219, v220, v221
    v_mfma_f32_16x16x32_bf16 v[120:123], v[68:71], v[108:111], v[120:123]
    ds_read_b128 v[88:91], v26 offset:2560
    v_max3_u32 v144, v144, v222, v223
    v_mfma_f32_16x16x32_bf16 v[128:131], v[64:67], v[100:103], v[128:131]
    ds_read_b128 v[92:95], v26 offset:3840
    v_max3_u32 v145, v145, v224, v225
    v_mfma_f32_16x16x32_bf16 v[128:131], v[68:71], v[104:107], v[128:131]
    ds_read2_b32 v[48:49], v16 offset0:56 offset1:57
    v_max3_u32 v144, v144, v226, v227
    v_mfma_f32_16x16x32_bf16 v[128:131], v[72:75], v[108:111], v[128:131]
    ds_read2_b32 v[50:51], v16 offset0:58 offset1:59
    v_max3_u32 v145, v145, v228, v229
    v_mfma_f32_16x16x32_bf16 v[136:139], v[64:67], v[96:99], v[136:139]
    ds_read2_b32 v[52:53], v17 offset0:56 offset1:57
    v_max3_u32 v144, v144, v230, v231
    v_mfma_f32_16x16x32_bf16 v[136:139], v[68:71], v[100:103], v[136:139]
    ds_read2_b32 v[54:55], v17 offset0:58 offset1:59
    v_max_u32 v144, v144, v145
    v_mfma_f32_16x16x32_bf16 v[136:139], v[72:75], v[104:107], v[136:139]
    ds_read2_b32 v[56:57], v18 offset0:56 offset1:57
    v_cmp_eq_u32 vcc, -1, v144
    v_mfma_f32_16x16x32_bf16 v[136:139], v[76:79], v[108:111], v[136:139]
    ds_read2_b32 v[58:59], v18 offset0:58 offset1:59
    s_nop 0
    v_mfma_f32_16x16x32_bf16 v[116:119], v[32:35], v[108:111], v[116:119]
    ds_read2_b32 v[60:61], v19 offset0:56 offset1:57
    s_cbranch_vccnz k_sf
k_sfr:
    s_mov_b64 exec, 1
    ds_add_u32 v31, v15 offset:8
    s_mov_b64 exec, -1
    v_mfma_f32_16x16x32_bf16 v[124:127], v[32:35], v[104:107], v[124:127]
    ds_read2_b32 v[62:63], v19 offset0:58 offset1:59
    v_lshlrev_b32 v144, 16, v216
    v_mfma_f32_16x16x32_bf16 v[124:127], v[36:39], v[108:111], v[124:127]
    v_lshlrev_b32 v145, 16, v217
    v_lshlrev_b32 v146, 16, v218
    v_mfma_f32_16x16x32_bf16 v[132:135], v[32:35], v[100:103], v[132:135]
    v_lshlrev_b32 v147, 16, v219
    v_lshlrev_b32 v148, 16, v220
    v_mfma_f32_16x16x32_bf16 v[132:135], v[36:39], v[104:107], v[132:135]
    v_lshlrev_b32 v149, 16, v221
    v_lshlrev_b32 v150, 16, v222
    v_mfma_f32_16x16x32_bf16 v[132:135], v[40:43], v[108:111], v[132:135]
    v_lshlrev_b32 v151, 16, v223
    v_and_b32 v216, 0xffff0000, v216
    v_mfma_f32_16x16x32_bf16 v[140:143], v[32:35], v[96:99], v[140:143]
    v_and_b32 v217, 0xffff0000, v217
    v_and_b32 v218, 0xffff0000, v218
    v_mfma_f32_16x16x32_bf16 v[140:143], v[36:39], v[100:103], v[140:143]
    v_and_b32 v219, 0xffff0000, v219
    v_and_b32 v220, 0xffff0000, v220
    v_mfma_f32_16x16x32_bf16 v[140:143], v[40:43], v[104:107], v[140:143]
    v_and_b32 v221, 0xffff0000, v221
    v_and_b32 v222, 0xffff0000, v222
    v_mfma_f32_16x16x32_bf16 v[140:143], v[44:47], v[108:111], v[140:143]
    v_and_b32 v223, 0xffff0000, v223
    v_rcp_f32 v216, v216
    s_waitcnt lgkmcnt(0)
    v_mfma_f32_16x16x32_bf16 v[112:115], v[32:35], v[92:95], v[112:115]
    ds_read_b128 v[96:99], v27 offset:0
    v_sub_f32 v144, v184, v144
    v_mfma_f32_16x16x32_bf16 v[120:123], v[32:35], v[88:91], v[120:123]
    ds_read_b128 v[100:103], v27 offset:1280
    v_rcp_f32 v217, v217
    v_mfma_f32_16x16x32_bf16 v[120:123], v[36:39], v[92:95], v[120:123]
    ds_read_b128 v[104:107], v27 offset:2560
    v_sub_f32 v145, v185, v145
    v_mfma_f32_16x16x32_bf16 v[128:131], v[32:35], v[84:87], v[128:131]
    ds_read_b128 v[108:111], v27 offset:3840
    v_rcp_f32 v218, v218
    v_mfma_f32_16x16x32_bf16 v[128:131], v[36:39], v[88:91], v[128:131]
    ds_read2_b32 v[64:65], v16 offset0:64 offset1:65
    v_sub_f32 v146, v186, v146
    v_mfma_f32_16x16x32_bf16 v[128:131], v[40:43], v[92:95], v[128:131]
    ds_read2_b32 v[66:67], v16 offset0:66 offset1:67
    v_rcp_f32 v219, v219
    v_mfma_f32_16x16x32_bf16 v[136:139], v[32:35], v[80:83], v[136:139]
    ds_read2_b32 v[68:69], v17 offset0:64 offset1:65
    v_sub_f32 v147, v187, v147
    v_mfma_f32_16x16x32_bf16 v[136:139], v[36:39], v[84:87], v[136:139]
    ds_read2_b32 v[70:71], v17 offset0:66 offset1:67
    v_rcp_f32 v220, v220
    v_mfma_f32_16x16x32_bf16 v[136:139], v[40:43], v[88:91], v[136:139]
    ds_read2_b32 v[72:73], v18 offset0:64 offset1:65
    v_sub_f32 v148, v188, v148
    v_mfma_f32_16x16x32_bf16 v[136:139], v[44:47], v[92:95], v[136:139]
    ds_read2_b32 v[74:75], v18 offset0:66 offset1:67
    v_rcp_f32 v221, v221
    v_mfma_f32_16x16x32_bf16 v[116:119], v[48:51], v[92:95], v[116:119]
    ds_read2_b32 v[76:77], v19 offset0:64 offset1:65
    v_sub_f32 v149, v189, v149
    v_mfma_f32_16x16x32_bf16 v[124:127], v[48:51], v[88:91], v[124:127]
    ds_read2_b32 v[78:79], v19 offset0:66 offset1:67
    v_rcp_f32 v222, v222
    v_mfma_f32_16x16x32_bf16 v[124:127], v[52:55], v[92:95], v[124:127]
    v_sub_f32 v150, v190, v150
    v_rcp_f32 v223, v223
    v_mfma_f32_16x16x32_bf16 v[132:135], v[48:51], v[84:87], v[132:135]
    v_sub_f32 v151, v191, v151
    v_mul_f32 v144, v144, v216
    v_mfma_f32_16x16x32_bf16 v[132:135], v[52:55], v[88:91], v[132:135]
    v_mul_f32 v145, v145, v217
    v_mul_f32 v146, v146, v218
    v_mfma_f32_16x16x32_bf16 v[132:135], v[56:59], v[92:95], v[132:135]
    v_mul_f32 v147, v147, v219
    v_mul_f32 v148, v148, v220
    v_mfma_f32_16x16x32_bf16 v[140:143], v[48:51], v[80:83], v[140:143]
    v_mul_f32 v149, v149, v221
    v_mul_f32 v150, v150, v222
    v_mfma_f32_16x16x32_bf16 v[140:143], v[52:55], v[84:87], v[140:143]
    v_mul_f32 v151, v151, v223
    v_fma_f32 v160, v144, v160, v184
    v_mfma_f32_16x16x32_bf16 v[140:143], v[56:59], v[88:91], v[140:143]
    v_fma_f32 v161, v145, v161, v185
    v_fma_f32 v162, v146, v162, v186
    v_mfma_f32_16x16x32_bf16 v[140:143], v[60:63], v[92:95], v[140:143]
    v_fma_f32 v163, v147, v163, v187
    v_fma_f32 v164, v148, v164, v188
    s_waitcnt lgkmcnt(0)
    v_mfma_f32_16x16x32_bf16 v[112:115], v[48:51], v[108:111], v[112:115]
    v_fma_f32 v165, v149, v165, v189
    v_fma_f32 v166, v150, v166, v190
    v_mfma_f32_16x16x32_bf16 v[120:123], v[48:51], v[104:107], v[120:123]
    v_fma_f32 v167, v151, v167, v191
    v_lshlrev_b32 v152, 16, v224
    v_mfma_f32_16x16x32_bf16 v[120:123], v[52:55], v[108:111], v[120:123]
    v_lshlrev_b32 v153, 16, v225
    v_lshlrev_b32 v154, 16, v226
    v_mfma_f32_16x16x32_bf16 v[128:131], v[48:51], v[100:103], v[128:131]
    v_lshlrev_b32 v155, 16, v227
    v_lshlrev_b32 v156, 16, v228
    v_mfma_f32_16x16x32_bf16 v[128:131], v[52:55], v[104:107], v[128:131]
    v_lshlrev_b32 v157, 16, v229
    v_lshlrev_b32 v158, 16, v230
    v_mfma_f32_16x16x32_bf16 v[128:131], v[56:59], v[108:111], v[128:131]
    v_lshlrev_b32 v159, 16, v231
    v_and_b32 v224, 0xffff0000, v224
    v_mfma_f32_16x16x32_bf16 v[136:139], v[48:51], v[96:99], v[136:139]
    v_and_b32 v225, 0xffff0000, v225
    v_and_b32 v226, 0xffff0000, v226
    v_mfma_f32_16x16x32_bf16 v[136:139], v[52:55], v[100:103], v[136:139]
    v_and_b32 v227, 0xffff0000, v227
    v_and_b32 v228, 0xffff0000, v228
    v_mfma_f32_16x16x32_bf16 v[136:139], v[56:59], v[104:107], v[136:139]
    v_and_b32 v229, 0xffff0000, v229
    v_and_b32 v230, 0xffff0000, v230
    v_mfma_f32_16x16x32_bf16 v[136:139], v[60:63], v[108:111], v[136:139]
    v_and_b32 v231, 0xffff0000, v231
    v_rcp_f32 v224, v224
    v_mfma_f32_16x16x32_bf16 v[116:119], v[64:67], v[108:111], v[116:119]
    v_sub_f32 v152, v192, v152
    v_rcp_f32 v225, v225
    v_mfma_f32_16x16x32_bf16 v[124:127], v[64:67], v[104:107], v[124:127]
    v_sub_f32 v153, v193, v153
    v_rcp_f32 v226, v226
    v_mfma_f32_16x16x32_bf16 v[124:127], v[68:71], v[108:111], v[124:127]
    v_sub_f32 v154, v194, v154
    v_rcp_f32 v227, v227
    v_mfma_f32_16x16x32_bf16 v[132:135], v[64:67], v[100:103], v[132:135]
    v_sub_f32 v155, v195, v155
    v_rcp_f32 v228, v228
    v_mfma_f32_16x16x32_bf16 v[132:135], v[68:71], v[104:107], v[132:135]
    v_sub_f32 v156, v196, v156
    v_rcp_f32 v229, v229
    v_mfma_f32_16x16x32_bf16 v[132:135], v[72:75], v[108:111], v[132:135]
    v_sub_f32 v157, v197, v157
    v_rcp_f32 v230, v230
    v_mfma_f32_16x16x32_bf16 v[140:143], v[64:67], v[96:99], v[140:143]
    v_sub_f32 v158, v198, v158
    v_rcp_f32 v231, v231
    v_mfma_f32_16x16x32_bf16 v[140:143], v[68:71], v[100:103], v[140:143]
    v_sub_f32 v159, v199, v159
    v_mul_f32 v152, v152, v224
    v_mfma_f32_16x16x32_bf16 v[140:143], v[72:75], v[104:107], v[140:143]
    v_mul_f32 v153, v153, v225
    v_mul_f32 v154, v154, v226
    v_mfma_f32_16x16x32_bf16 v[140:143], v[76:79], v[108:111], v[140:143]
    v_mul_f32 v155, v155, v227
    v_mul_f32 v156, v156, v228
    v_mul_f32 v157, v157, v229
    v_mul_f32 v158, v158, v230
    v_mul_f32 v159, v159, v231
    v_fma_f32 v168, v152, v168, v192
    v_fma_f32 v169, v153, v169, v193
    v_fma_f32 v170, v154, v170, v194
    v_fma_f32 v171, v155, v171, v195
    v_fma_f32 v172, v156, v172, v196
    v_fma_f32 v173, v157, v173, v197
    v_fma_f32 v174, v158, v174, v198
    v_fma_f32 v175, v159, v175, v199
    s_cmp_ge_u32 s2, 224
    s_cbranch_scc1 k_s2f
k_s2fr:
    s_cmp_eq_u32 s33, 0
    s_cbranch_scc0 k_hf1
    ds_write_b128 v12, v[128:131] offset:0
    ds_write_b128 v12, v[132:135] offset:1024
    ds_write_b128 v12, v[136:139] offset:2048
    ds_write_b128 v12, v[140:143] offset:3072
    s_mov_b64 exec, 1
    ds_add_u32 v10, v15 offset:16
    s_mov_b64 exec, -1
    s_mov_b32 s47, 0x8000
L3_sp:
    ds_read_b32 v14, v10 offset:16
    s_waitcnt lgkmcnt(0)
    v_readfirstlane_b32 s48, v14
    s_nop 0
    s_cmp_ge_u32 s48, 2
    s_cbranch_scc1 L4_ok
    s_sleep 0
    s_sub_u32 s47, s47, 1
    s_cbranch_scc0 L3_sp
L4_ok:
    ds_read_b128 v[32:35], v13 offset:0
    ds_read_b128 v[36:39], v13 offset:1024
    ds_read_b128 v[40:43], v13 offset:2048
    ds_read_b128 v[44:47], v13 offset:3072
    s_waitcnt lgkmcnt(3)
    v_pk_add_f32 v[32:33], v[32:33], v[112:113]
    v_pk_add_f32 v[34:35], v[34:35], v[114:115]
    s_waitcnt lgkmcnt(2)
    v_pk_add_f32 v[36:37], v[36:37], v[116:117]
    v_pk_add_f32 v[38:39], v[38:39], v[118:119]
    s_waitcnt lgkmcnt(1)
    v_pk_add_f32 v[40:41], v[40:41], v[120:121]
    v_pk_add_f32 v[42:43], v[42:43], v[122:123]
    s_waitcnt lgkmcnt(0)
    v_pk_add_f32 v[44:45], v[44:45], v[124:125]
    v_pk_add_f32 v[46:47], v[46:47], v[126:127]
    s_branch k_join
k_hf1:
    s_nop 7
    ds_write_b128 v12, v[112:115] offset:0
    ds_write_b128 v12, v[116:119] offset:1024
    ds_write_b128 v12, v[120:123] offset:2048
    ds_write_b128 v12, v[124:127] offset:3072
    s_mov_b64 exec, 1
    ds_add_u32 v10, v15 offset:16
    s_mov_b64 exec, -1
    s_mov_b32 s47, 0x8000
L5_sp:
    ds_read_b32 v14, v10 offset:16
    s_waitcnt lgkmcnt(0)
    v_readfirstlane_b32 s48, v14
    s_nop 0
    s_cmp_ge_u32 s48, 2
    s_cbranch_scc1 L6_ok
    s_sleep 0
    s_sub_u32 s47, s47, 1
    s_cbranch_scc0 L5_sp
L6_ok:
    ds_read_b128 v[32:35], v13 offset:0
    ds_read_b128 v[36:39], v13 offset:1024
    ds_read_b128 v[40:43], v13 offset:2048
    ds_read_b128 v[44:47], v13 offset:3072
    s_waitcnt lgkmcnt(3)
    v_pk_add_f32 v[32:33], v[32:33], v[128:129]
    v_pk_add_f32 v[34:35], v[34:35], v[130:131]
    s_waitcnt lgkmcnt(2)
    v_pk_add_f32 v[36:37], v[36:37], v[132:133]
    v_pk_add_f32 v[38:39], v[38:39], v[134:135]
    s_waitcnt lgkmcnt(1)
    v_pk_add_f32 v[40:41], v[40:41], v[136:137]
    v_pk_add_f32 v[42:43], v[42:43], v[138:139]
    s_waitcnt lgkmcnt(0)
    v_pk_add_f32 v[44:45], v[44:45], v[140:141]
    v_pk_add_f32 v[46:47], v[46:47], v[142:143]
k_join:
    s_nop 1
    v_permlane16_swap_b32 v32, v36
    v_permlane16_swap_b32 v33, v37
    v_permlane16_swap_b32 v34, v38
    v_permlane16_swap_b32 v35, v39
    v_permlane16_swap_b32 v40, v44
    v_permlane16_swap_b32 v41, v45
    v_permlane16_swap_b32 v42, v46
    v_permlane16_swap_b32 v43, v47
    v_pk_fma_f32 v[160:161], v[144:145], v[32:33], v[160:161]
    v_pk_fma_f32 v[162:163], v[146:147], v[34:35], v[162:163]
    v_pk_fma_f32 v[164:165], v[148:149], v[36:37], v[164:165]
    v_pk_fma_f32 v[166:167], v[150:151], v[38:39], v[166:167]
    v_pk_fma_f32 v[168:169], v[152:153], v[40:41], v[168:169]
    v_pk_fma_f32 v[170:171], v[154:155], v[42:43], v[170:171]
    v_pk_fma_f32 v[172:173], v[156:157], v[44:45], v[172:173]
    v_pk_fma_f32 v[174:175], v[158:159], v[46:47], v[174:175]
    v_cvt_pk_bf16_f32 v208, v160, v161
    v_cvt_pk_bf16_f32 v209, v162, v163
    v_cvt_pk_bf16_f32 v210, v164, v165
    v_cvt_pk_bf16_f32 v211, v166, v167
    v_cvt_pk_bf16_f32 v212, v168, v169
    v_cvt_pk_bf16_f32 v213, v170, v171
    v_cvt_pk_bf16_f32 v214, v172, v173
    v_cvt_pk_bf16_f32 v215, v174, v175
    buffer_store_dwordx4 v[208:211], v2, s[16:19], s57 offen sc1
    buffer_store_dwordx4 v[212:215], v2, s[16:19], s58 offen sc1
    s_mov_b64 exec, 1
    ds_add_u32 v31, v15 offset:32
    s_mov_b64 exec, -1
    s_cmp_ge_u32 s2, 224
    s_cbranch_scc1 k_s2
k_xw:
    v_mov_b32 v210, v31
    v_bfe_u32 v12, v1, 4, 1
    v_bfe_u32 v13, v1, 3, 1
    v_lshl_or_b32 v13, v12, 1, v13
    v_xor_b32 v13, s30, v13
    v_lshlrev_b32 v208, 11, v12
    v_lshl_add_u32 v208, v13, 5, v208
    v_lshrrev_b32 v12, 5, v1
    v_lshl_add_u32 v208, v12, 10, v208
    v_bfe_u32 v12, v1, 2, 2
    v_lshl_add_u32 v208, v12, 7, v208
    v_and_b32 v12, 1, v1
    v_lshl_add_u32 v208, v12, 4, v208
    v_bfe_u32 v12, v1, 1, 1
    v_lshl_add_u32 v208, v12, 3, v208
    v_add_u32 v208, 46080, v208
    v_add_u32 v209, 57344, v208
    v_lshrrev_b32 v12, 2, v1
    v_xor_b32 v12, v12, v1
    v_and_b32 v12, 4, v12
    v_cmp_eq_u32 vcc, 0, v12
    v_mov_b32 v12, 0x3f803f80
    s_nop 0
    v_cndmask_b32 v216, 0, v12, vcc
    v_cndmask_b32 v217, 0, v12, vcc
    v_cndmask_b32 v218, 0, v12, vcc
    v_cndmask_b32 v219, 0, v12, vcc
    v_mov_b32 v252, 0
    v_mov_b32 v253, 0
    v_mov_b32 v254, 0
    v_mov_b32 v255, 0
    s_mov_b32 s47, 0x8000
L7_sp:
    ds_read_b32 v14, v210 offset:64
    s_waitcnt lgkmcnt(0)
    v_readfirstlane_b32 s48, v14
    s_nop 0
    s_cmp_ge_u32 s48, 4
    s_cbranch_scc1 L8_ok
    s_sleep 1
    s_sub_u32 s47, s47, 1
    s_cbranch_scc0 L7_sp
L8_ok:
    ds_read_b64_tr_b16 v[16:17], v208 offset:0
    ds_read_b64_tr_b16 v[18:19], v208 offset:512
    ds_read_b64_tr_b16 v[32:33], v208 offset:4096
    ds_read_b64_tr_b16 v[34:35], v208 offset:4608
    ds_read_b64_tr_b16 v[48:49], v208 offset:8192
    ds_read_b64_tr_b16 v[50:51], v208 offset:8704
    ds_read_b64_tr_b16 v[64:65], v208 offset:12288
    ds_read_b64_tr_b16 v[66:67], v208 offset:12800
    ds_read_b64_tr_b16 v[80:81], v208 offset:16384
    ds_read_b64_tr_b16 v[82:83], v208 offset:16896
    ds_read_b64_tr_b16 v[96:97], v208 offset:20480
    ds_read_b64_tr_b16 v[98:99], v208 offset:20992
    ds_read_b64_tr_b16 v[112:113], v208 offset:24576
    ds_read_b64_tr_b16 v[114:115], v208 offset:25088
    s_and_b32 s31, s2, 7
    s_lshr_b32 s32, s2, 3
    s_mul_i32 s33, s32, 37
    s_lshr_b32 s33, s33, 8
    s_mul_i32 s34, s33, 7
    s_sub_u32 s34, s32, s34
    s_lshr_b32 s44, s31, 1
    s_lshl_b32 s44, s44, 2
    s_and_b32 s35, s31, 1
    v_lshlrev_b32 v2, 4, v1
    s_and_b32 s9, s33, 1
    s_lshl_b32 s9, s9, 2
    s_xor_b32 s9, s9, s30
    s_add_u32 s33, s33, s44
    s_mul_i32 s36, s35, 7
    s_add_u32 s36, s36, s34
    s_lshl_b32 s36, s36, 3
    s_add_u32 s36, s36, s9
    s_and_b32 s39, s30, 3
    s_lshl_b32 s39, s39, 10
    s_mul_i32 s52, s33, 114688
    s_add_u32 s52, s52, s39
    s_add_u32 s52, s52, 5242880
    v_lshrrev_b32 v12, 4, v1
    v_and_b32 v13, 15, v1
    v_lshlrev_b32 v14, 2, v12
    v_xor_b32 v13, v13, v14
    s_and_b32 s48, s30, 2
    v_xor_b32 v13, s48, v13
    v_lshlrev_b32 v14, 8, v12
    v_lshl_add_u32 v3, v13, 4, v14
    v_bfe_u32 v13, v1, 2, 2
    v_and_b32 v14, 3, v1
    v_lshrrev_b32 v15, 1, v12
    v_xor_b32 v12, v12, v15
    v_and_b32 v12, 1, v12
    v_lshl_add_u32 v15, v15, 3, v13
    v_lshlrev_b32 v15, 8, v15
    v_lshl_add_u32 v15, v13, 6, v15
    v_lshl_add_u32 v15, v12, 5, v15
    v_lshl_add_u32 v4, v14, 3, v15
    v_xor_b32 v5, 64, v4
    v_xor_b32 v6, 128, v4
    v_xor_b32 v7, 192, v4
    v_add_u32 v8, 0x10000, v4
    v_add_u32 v9, 0x10000, v5
    v_add_u32 v10, 0x10000, v6
    v_add_u32 v11, 0x10000, v7
    s_mul_i32 s40, s33, 448
    s_add_u32 s40, s40, s36
    s_lshl_b32 s40, s40, 10
    s_add_u32 s40, s40, 8388608
    s_lshl_b32 s41, s33, 3
    s_add_u32 s41, s41, s9
    s_lshl_b32 s41, s41, 7
    s_add_u32 s41, s41, 27262976
    s_lshl_b32 s42, s34, 3
    s_add_u32 s42, s42, s9
    s_mul_i32 s42, s42, 28672
    s_add_u32 s42, s42, 25165824
    s_lshl_b32 s43, s33, 2
    s_add_u32 s43, s43, s35
    s_mul_i32 s43, s43, 112
    s_add_u32 s43, s43, s9
    s_lshl_b32 s43, s43, 10
    s_add_u32 s43, s43, 8388608
    v_and_b32 v13, 31, v1
    v_lshlrev_b32 v13, 4, v13
    v_add_u32 v13, 161792, v13
    v_mov_b32 v224, 0
    v_mov_b32 v225, 0
    v_mov_b32 v227, 0
    v_mov_b32 v228, 0
    v_mov_b32 v229, 0
    v_mov_b32 v230, 0
    v_mov_b32 v232, 0
    v_mov_b32 v233, 0
    s_mul_i32 s11, s34, 3
    s_lshr_b32 s11, s11, 3
    s_lshl_b32 s11, s11, 1
    s_add_u32 s10, s11, s35
    s_lshl_b32 s10, s10, 2
    s_and_b32 s48, s34, 3
    s_add_u32 s10, s10, s48
    s_lshl_b32 s10, s10, 3
    s_add_u32 s10, s10, s9
    s_lshl_b32 s10, s10, 7
    s_add_u32 s10, s10, 21037056
    s_and_b32 s48, s33, 3
    s_mul_i32 s48, s48, 7
    s_add_u32 s48, s48, 1
    s_lshr_b32 s48, s48, 1
    s_mul_i32 s44, s34, 2
    s_add_u32 s48, s48, s44
    s_sub_u32 s44, s48, 14
    s_cselect_b32 s48, s48, s44
    s_mov_b32 s4, s42
    s_add_u32 s5, s42, 28672
    s_lshl_b32 s44, s48, 11
    s_add_u32 s42, s42, s44
    s_mov_b32 s6, s43
    s_add_u32 s7, s43, 114688
    s_lshl_b32 s44, s48, 13
    s_add_u32 s43, s43, s44
    s_mov_b32 s8, s43
    s_mov_b32 s47, 0x8000
L9_sp:
    ds_read_b32 v14, v210 offset:68
    s_waitcnt lgkmcnt(0)
    v_readfirstlane_b32 s48, v14
    s_nop 0
    s_cmp_ge_u32 s48, 4
    s_cbranch_scc1 L10_ok
    s_sleep 1
    s_sub_u32 s47, s47, 1
    s_cbranch_scc0 L9_sp
L10_ok:
    ds_read_b64_tr_b16 v[20:21], v208 offset:28672
    ds_read_b64_tr_b16 v[22:23], v208 offset:29184
    v_mfma_f32_16x16x32_bf16 v[252:255], v[216:219], v[16:19], v[252:255]
    ds_read_b64_tr_b16 v[36:37], v208 offset:32768
    ds_read_b64_tr_b16 v[38:39], v208 offset:33280
    v_mfma_f32_16x16x32_bf16 v[252:255], v[216:219], v[32:35], v[252:255]
    ds_read_b64_tr_b16 v[52:53], v208 offset:36864
    ds_read_b64_tr_b16 v[54:55], v208 offset:37376
    v_mfma_f32_16x16x32_bf16 v[252:255], v[216:219], v[48:51], v[252:255]
    ds_read_b64_tr_b16 v[68:69], v208 offset:40960
    ds_read_b64_tr_b16 v[70:71], v208 offset:41472
    v_mfma_f32_16x16x32_bf16 v[252:255], v[216:219], v[64:67], v[252:255]
    ds_read_b64_tr_b16 v[84:85], v208 offset:45056
    ds_read_b64_tr_b16 v[86:87], v208 offset:45568
    v_mfma_f32_16x16x32_bf16 v[252:255], v[216:219], v[80:83], v[252:255]
    ds_read_b64_tr_b16 v[100:101], v208 offset:49152
    ds_read_b64_tr_b16 v[102:103], v208 offset:49664
    v_mfma_f32_16x16x32_bf16 v[252:255], v[216:219], v[96:99], v[252:255]
    ds_read_b64_tr_b16 v[116:117], v208 offset:53248
    ds_read_b64_tr_b16 v[118:119], v208 offset:53760
    v_mfma_f32_16x16x32_bf16 v[252:255], v[216:219], v[112:115], v[252:255]
    s_mov_b32 s47, 0x8000
L11_sp:
    ds_read_b32 v14, v210 offset:72
    s_waitcnt lgkmcnt(0)
    v_readfirstlane_b32 s48, v14
    s_nop 0
    s_cmp_ge_u32 s48, 4
    s_cbranch_scc1 L12_ok
    s_sleep 1
    s_sub_u32 s47, s47, 1
    s_cbranch_scc0 L11_sp
L12_ok:
    ds_read_b64_tr_b16 v[24:25], v209 offset:0
    ds_read_b64_tr_b16 v[26:27], v209 offset:512
    v_mfma_f32_16x16x32_bf16 v[252:255], v[216:219], v[20:23], v[252:255]
    ds_read_b64_tr_b16 v[40:41], v209 offset:4096
    ds_read_b64_tr_b16 v[42:43], v209 offset:4608
    v_mfma_f32_16x16x32_bf16 v[252:255], v[216:219], v[36:39], v[252:255]
    ds_read_b64_tr_b16 v[56:57], v209 offset:8192
    ds_read_b64_tr_b16 v[58:59], v209 offset:8704
    v_mfma_f32_16x16x32_bf16 v[252:255], v[216:219], v[52:55], v[252:255]
    ds_read_b64_tr_b16 v[72:73], v209 offset:12288
    ds_read_b64_tr_b16 v[74:75], v209 offset:12800
    v_mfma_f32_16x16x32_bf16 v[252:255], v[216:219], v[68:71], v[252:255]
    ds_read_b64_tr_b16 v[88:89], v209 offset:16384
    ds_read_b64_tr_b16 v[90:91], v209 offset:16896
    v_mfma_f32_16x16x32_bf16 v[252:255], v[216:219], v[84:87], v[252:255]
    ds_read_b64_tr_b16 v[104:105], v209 offset:20480
    ds_read_b64_tr_b16 v[106:107], v209 offset:20992
    v_mfma_f32_16x16x32_bf16 v[252:255], v[216:219], v[100:103], v[252:255]
    ds_read_b64_tr_b16 v[120:121], v209 offset:24576
    ds_read_b64_tr_b16 v[122:123], v209 offset:25088
    v_mfma_f32_16x16x32_bf16 v[252:255], v[216:219], v[116:119], v[252:255]
    s_mov_b32 s47, 0x8000
L13_sp:
    ds_read_b32 v14, v210 offset:76
    s_waitcnt lgkmcnt(0)
    v_readfirstlane_b32 s48, v14
    s_nop 0
    s_cmp_ge_u32 s48, 4
    s_cbranch_scc1 L14_ok
    s_sleep 1
    s_sub_u32 s47, s47, 1
    s_cbranch_scc0 L13_sp
L14_ok:
    ds_read_b64_tr_b16 v[28:29], v209 offset:28672
    ds_read_b64_tr_b16 v[30:31], v209 offset:29184
    v_mfma_f32_16x16x32_bf16 v[252:255], v[216:219], v[24:27], v[252:255]
    ds_read_b64_tr_b16 v[44:45], v209 offset:32768
    ds_read_b64_tr_b16 v[46:47], v209 offset:33280
    v_mfma_f32_16x16x32_bf16 v[252:255], v[216:219], v[40:43], v[252:255]
    ds_read_b64_tr_b16 v[60:61], v209 offset:36864
    ds_read_b64_tr_b16 v[62:63], v209 offset:37376
    v_mfma_f32_16x16x32_bf16 v[252:255], v[216:219], v[56:59], v[252:255]
    ds_read_b64_tr_b16 v[76:77], v209 offset:40960
    ds_read_b64_tr_b16 v[78:79], v209 offset:41472
    v_mfma_f32_16x16x32_bf16 v[252:255], v[216:219], v[72:75], v[252:255]
    ds_read_b64_tr_b16 v[92:93], v209 offset:45056
    ds_read_b64_tr_b16 v[94:95], v209 offset:45568
    v_mfma_f32_16x16x32_bf16 v[252:255], v[216:219], v[88:91], v[252:255]
    ds_read_b64_tr_b16 v[108:109], v209 offset:49152
    ds_read_b64_tr_b16 v[110:111], v209 offset:49664
    v_mfma_f32_16x16x32_bf16 v[252:255], v[216:219], v[104:107], v[252:255]
    ds_read_b64_tr_b16 v[124:125], v209 offset:53248
    ds_read_b64_tr_b16 v[126:127], v209 offset:53760
    v_mfma_f32_16x16x32_bf16 v[252:255], v[216:219], v[120:123], v[252:255]
    s_waitcnt lgkmcnt(12)
    v_mfma_f32_16x16x32_bf16 v[252:255], v[216:219], v[28:31], v[252:255]
    s_waitcnt lgkmcnt(10)
    v_mfma_f32_16x16x32_bf16 v[252:255], v[216:219], v[44:47], v[252:255]
    s_waitcnt lgkmcnt(8)
    v_mfma_f32_16x16x32_bf16 v[252:255], v[216:219], v[60:63], v[252:255]
    s_waitcnt lgkmcnt(6)
    v_mfma_f32_16x16x32_bf16 v[252:255], v[216:219], v[76:79], v[252:255]
    s_waitcnt lgkmcnt(4)
    v_mfma_f32_16x16x32_bf16 v[252:255], v[216:219], v[92:95], v[252:255]
    s_waitcnt lgkmcnt(2)
    v_mfma_f32_16x16x32_bf16 v[252:255], v[216:219], v[108:111], v[252:255]
    s_waitcnt lgkmcnt(0)
    v_mfma_f32_16x16x32_bf16 v[252:255], v[216:219], v[124:127], v[252:255]
    s_lshr_b32 s48, s33, 1
    s_cmp_eq_u32 s48, s11
    s_cbranch_scc1 k_cso
k_csr:
    s_mov_b32 vcc_lo, 0
    s_mov_b32 vcc_hi, -1
    s_nop 2
    v_sub_f32 v252, 0, v252
    v_cvt_pk_bf16_f32 v253, v252, 0
    v_lshlrev_b32 v254, 16, v253
    v_sub_f32 v254, v252, v254
    v_cvt_pk_bf16_f32 v254, v254, 0
    v_cndmask_b32 v226, v253, v254, vcc
    v_cndmask_b32 v231, v253, v254, vcc
    s_lshl_b32 s48, s30, 3
    s_add_u32 s48, s48, s31
    s_cmp_eq_u32 s48, 7
    s_cbranch_scc1 k_can
k_canr:
    s_mov_b32 s47, 0x1000
    s_setprio 2
    s_barrier
    ds_read_b64_tr_b16 v[192:193], v4 offset:0
    ds_read_b64_tr_b16 v[194:195], v4 offset:1024
    ds_read_b64_tr_b16 v[196:197], v5 offset:0
    ds_read_b64_tr_b16 v[198:199], v5 offset:1024
    ds_read_b64_tr_b16 v[200:201], v6 offset:0
    ds_read_b64_tr_b16 v[202:203], v6 offset:1024
    ds_read_b64_tr_b16 v[204:205], v7 offset:0
    ds_read_b64_tr_b16 v[206:207], v7 offset:1024
    s_waitcnt lgkmcnt(6)
    v_mfma_f32_32x32x16_bf16 v[128:143], v[16:19], v[192:195], 0
    s_barrier
    ds_read_b64_tr_b16 v[208:209], v4 offset:4096
    ds_read_b64_tr_b16 v[210:211], v4 offset:5120
    s_waitcnt lgkmcnt(6)
    v_mfma_f32_32x32x16_bf16 v[144:159], v[16:19], v[196:199], 0
    ds_read_b64_tr_b16 v[212:213], v5 offset:4096
    ds_read_b64_tr_b16 v[214:215], v5 offset:5120
    s_waitcnt lgkmcnt(6)
    v_mfma_f32_32x32x16_bf16 v[160:175], v[16:19], v[200:203], 0
    ds_read_b64_tr_b16 v[216:217], v6 offset:4096
    ds_read_b64_tr_b16 v[218:219], v6 offset:5120
    s_waitcnt lgkmcnt(6)
    v_mfma_f32_32x32x16_bf16 v[176:191], v[16:19], v[204:207], 0
    ds_read_b64_tr_b16 v[220:221], v7 offset:4096
    ds_read_b64_tr_b16 v[222:223], v7 offset:5120
    s_waitcnt lgkmcnt(6)
    v_mfma_f32_32x32x16_bf16 v[128:143], v[20:23], v[208:211], v[128:143]
    s_barrier
    ds_read_b64_tr_b16 v[192:193], v4 offset:8192
    ds_read_b64_tr_b16 v[194:195], v4 offset:9216
    s_waitcnt lgkmcnt(6)
    v_mfma_f32_32x32x16_bf16 v[144:159], v[20:23], v[212:215], v[144:159]
    ds_read_b64_tr_b16 v[196:197], v5 offset:8192
    ds_read_b64_tr_b16 v[198:199], v5 offset:9216
    s_waitcnt lgkmcnt(6)
    v_mfma_f32_32x32x16_bf16 v[160:175], v[20:23], v[216:219], v[160:175]
    ds_read_b64_tr_b16 v[200:201], v6 offset:8192
    ds_read_b64_tr_b16 v[202:203], v6 offset:9216
    s_waitcnt lgkmcnt(6)
    v_mfma_f32_32x32x16_bf16 v[176:191], v[20:23], v[220:223], v[176:191]
    ds_read_b64_tr_b16 v[204:205], v7 offset:8192
    ds_read_b64_tr_b16 v[206:207], v7 offset:9216
    s_waitcnt lgkmcnt(6)
    v_mfma_f32_32x32x16_bf16 v[128:143], v[24:27], v[192:195], v[128:143]
    ds_read_b64_tr_b16 v[208:209], v4 offset:12288
    ds_read_b64_tr_b16 v[210:211], v4 offset:13312
    s_waitcnt lgkmcnt(6)
    v_mfma_f32_32x32x16_bf16 v[144:159], v[24:27], v[196:199], v[144:159]
    ds_read_b64_tr_b16 v[212:213], v5 offset:12288
    ds_read_b64_tr_b16 v[214:215], v5 offset:13312
    s_waitcnt lgkmcnt(6)
    v_mfma_f32_32x32x16_bf16 v[160:175], v[24:27], v[200:203], v[160:175]
    ds_read_b64_tr_b16 v[216:217], v6 offset:12288
    ds_read_b64_tr_b16 v[218:219], v6 offset:13312
    s_waitcnt lgkmcnt(6)
    v_mfma_f32_32x32x16_bf16 v[176:191], v[24:27], v[204:207], v[176:191]
    ds_read_b64_tr_b16 v[220:221], v7 offset:12288
    ds_read_b64_tr_b16 v[222:223], v7 offset:13312
    s_waitcnt lgkmcnt(6)
    v_mfma_f32_32x32x16_bf16 v[128:143], v[28:31], v[208:211], v[128:143]
    s_barrier
    ds_read_b64_tr_b16 v[192:193], v4 offset:16384
    ds_read_b64_tr_b16 v[194:195], v4 offset:17408
    s_waitcnt lgkmcnt(6)
    v_mfma_f32_32x32x16_bf16 v[144:159], v[28:31], v[212:215], v[144:159]
    ds_read_b64_tr_b16 v[196:197], v5 offset:16384
    ds_read_b64_tr_b16 v[198:199], v5 offset:17408
    s_waitcnt lgkmcnt(6)
    v_mfma_f32_32x32x16_bf16 v[160:175], v[28:31], v[216:219], v[160:175]
    ds_read_b64_tr_b16 v[200:201], v6 offset:16384
    ds_read_b64_tr_b16 v[202:203], v6 offset:17408
    s_waitcnt lgkmcnt(6)
    v_mfma_f32_32x32x16_bf16 v[176:191], v[28:31], v[220:223], v[176:191]
    ds_read_b64_tr_b16 v[204:205], v7 offset:16384
    ds_read_b64_tr_b16 v[206:207], v7 offset:17408
    s_waitcnt lgkmcnt(6)
    v_mfma_f32_32x32x16_bf16 v[128:143], v[32:35], v[192:195], v[128:143]
    ds_read_b64_tr_b16 v[208:209], v4 offset:20480
    ds_read_b64_tr_b16 v[210:211], v4 offset:21504
    s_waitcnt lgkmcnt(6)
    v_mfma_f32_32x32x16_bf16 v[144:159], v[32:35], v[196:199], v[144:159]
    ds_read_b64_tr_b16 v[212:213], v5 offset:20480
    ds_read_b64_tr_b16 v[214:215], v5 offset:21504
    s_waitcnt lgkmcnt(6)
    v_mfma_f32_32x32x16_bf16 v[160:175], v[32:35], v[200:203], v[160:175]
    ds_read_b64_tr_b16 v[216:217], v6 offset:20480
    ds_read_b64_tr_b16 v[218:219], v6 offset:21504
    s_waitcnt lgkmcnt(6)
    v_mfma_f32_32x32x16_bf16 v[176:191], v[32:35], v[204:207], v[176:191]
    ds_read_b64_tr_b16 v[220:221], v7 offset:20480
    ds_read_b64_tr_b16 v[222:223], v7 offset:21504
    s_waitcnt lgkmcnt(6)
    v_mfma_f32_32x32x16_bf16 v[128:143], v[36:39], v[208:211], v[128:143]
    s_barrier
    ds_read_b64_tr_b16 v[192:193], v4 offset:24576
    ds_read_b64_tr_b16 v[194:195], v4 offset:25600
    s_waitcnt lgkmcnt(6)
    v_mfma_f32_32x32x16_bf16 v[144:159], v[36:39], v[212:215], v[144:159]
    ds_read_b64_tr_b16 v[196:197], v5 offset:24576
    ds_read_b64_tr_b16 v[198:199], v5 offset:25600
    s_waitcnt lgkmcnt(6)
    v_mfma_f32_32x32x16_bf16 v[160:175], v[36:39], v[216:219], v[160:175]
    ds_read_b64_tr_b16 v[200:201], v6 offset:24576
    ds_read_b64_tr_b16 v[202:203], v6 offset:25600
    s_waitcnt lgkmcnt(6)
    v_mfma_f32_32x32x16_bf16 v[176:191], v[36:39], v[220:223], v[176:191]
    ds_read_b64_tr_b16 v[204:205], v7 offset:24576
    ds_read_b64_tr_b16 v[206:207], v7 offset:25600
    s_waitcnt lgkmcnt(6)
    v_mfma_f32_32x32x16_bf16 v[128:143], v[40:43], v[192:195], v[128:143]
    ds_read_b64_tr_b16 v[208:209], v4 offset:28672
    ds_read_b64_tr_b16 v[210:211], v4 offset:29696
    s_waitcnt lgkmcnt(6)
    v_mfma_f32_32x32x16_bf16 v[144:159], v[40:43], v[196:199], v[144:159]
    ds_read_b64_tr_b16 v[212:213], v5 offset:28672
    ds_read_b64_tr_b16 v[214:215], v5 offset:29696
    s_waitcnt lgkmcnt(6)
    v_mfma_f32_32x32x16_bf16 v[160:175], v[40:43], v[200:203], v[160:175]
    ds_read_b64_tr_b16 v[216:217], v6 offset:28672
    ds_read_b64_tr_b16 v[218:219], v6 offset:29696
    s_waitcnt lgkmcnt(6)
    v_mfma_f32_32x32x16_bf16 v[176:191], v[40:43], v[204:207], v[176:191]
    ds_read_b64_tr_b16 v[220:221], v7 offset:28672
    ds_read_b64_tr_b16 v[222:223], v7 offset:29696
    s_waitcnt lgkmcnt(6)
    v_mfma_f32_32x32x16_bf16 v[128:143], v[44:47], v[208:211], v[128:143]
    s_barrier
    ds_read_b64_tr_b16 v[192:193], v4 offset:32768
    ds_read_b64_tr_b16 v[194:195], v4 offset:33792
    s_waitcnt lgkmcnt(6)
    v_mfma_f32_32x32x16_bf16 v[144:159], v[44:47], v[212:215], v[144:159]
    ds_read_b64_tr_b16 v[196:197], v5 offset:32768
    ds_read_b64_tr_b16 v[198:199], v5 offset:33792
    s_waitcnt lgkmcnt(6)
    v_mfma_f32_32x32x16_bf16 v[160:175], v[44:47], v[216:219], v[160:175]
    ds_read_b64_tr_b16 v[200:201], v6 offset:32768
    ds_read_b64_tr_b16 v[202:203], v6 offset:33792
    s_waitcnt lgkmcnt(6)
    v_mfma_f32_32x32x16_bf16 v[176:191], v[44:47], v[220:223], v[176:191]
    ds_read_b64_tr_b16 v[204:205], v7 offset:32768
    ds_read_b64_tr_b16 v[206:207], v7 offset:33792
    s_waitcnt lgkmcnt(6)
    v_mfma_f32_32x32x16_bf16 v[128:143], v[48:51], v[192:195], v[128:143]
    ds_read_b64_tr_b16 v[208:209], v4 offset:36864
    ds_read_b64_tr_b16 v[210:211], v4 offset:37888
    s_waitcnt lgkmcnt(6)
    v_mfma_f32_32x32x16_bf16 v[144:159], v[48:51], v[196:199], v[144:159]
    ds_read_b64_tr_b16 v[212:213], v5 offset:36864
    ds_read_b64_tr_b16 v[214:215], v5 offset:37888
    s_waitcnt lgkmcnt(6)
    v_mfma_f32_32x32x16_bf16 v[160:175], v[48:51], v[200:203], v[160:175]
    ds_read_b64_tr_b16 v[216:217], v6 offset:36864
    ds_read_b64_tr_b16 v[218:219], v6 offset:37888
    s_waitcnt lgkmcnt(6)
    v_mfma_f32_32x32x16_bf16 v[176:191], v[48:51], v[204:207], v[176:191]
    ds_read_b64_tr_b16 v[220:221], v7 offset:36864
    ds_read_b64_tr_b16 v[222:223], v7 offset:37888
    s_waitcnt lgkmcnt(6)
    v_mfma_f32_32x32x16_bf16 v[128:143], v[52:55], v[208:211], v[128:143]
    s_barrier
    ds_read_b64_tr_b16 v[192:193], v4 offset:40960
    ds_read_b64_tr_b16 v[194:195], v4 offset:41984
    s_waitcnt lgkmcnt(6)
    v_mfma_f32_32x32x16_bf16 v[144:159], v[52:55], v[212:215], v[144:159]
    ds_read_b64_tr_b16 v[196:197], v5 offset:40960
    ds_read_b64_tr_b16 v[198:199], v5 offset:41984
    s_waitcnt lgkmcnt(6)
    v_mfma_f32_32x32x16_bf16 v[160:175], v[52:55], v[216:219], v[160:175]
    ds_read_b64_tr_b16 v[200:201], v6 offset:40960
    ds_read_b64_tr_b16 v[202:203], v6 offset:41984
    s_waitcnt lgkmcnt(6)
    v_mfma_f32_32x32x16_bf16 v[176:191], v[52:55], v[220:223], v[176:191]
    ds_read_b64_tr_b16 v[204:205], v7 offset:40960
    ds_read_b64_tr_b16 v[206:207], v7 offset:41984
    s_waitcnt lgkmcnt(6)
    v_mfma_f32_32x32x16_bf16 v[128:143], v[56:59], v[192:195], v[128:143]
    ds_read_b64_tr_b16 v[208:209], v4 offset:45056
    ds_read_b64_tr_b16 v[210:211], v4 offset:46080
    s_waitcnt lgkmcnt(6)
    v_mfma_f32_32x32x16_bf16 v[144:159], v[56:59], v[196:199], v[144:159]
    ds_read_b64_tr_b16 v[212:213], v5 offset:45056
    ds_read_b64_tr_b16 v[214:215], v5 offset:46080
    s_waitcnt lgkmcnt(6)
    v_mfma_f32_32x32x16_bf16 v[160:175], v[56:59], v[200:203], v[160:175]
    ds_read_b64_tr_b16 v[216:217], v6 offset:45056
    ds_read_b64_tr_b16 v[218:219], v6 offset:46080
    s_waitcnt lgkmcnt(6)
    v_mfma_f32_32x32x16_bf16 v[176:191], v[56:59], v[204:207], v[176:191]
    ds_read_b64_tr_b16 v[220:221], v7 offset:45056
    ds_read_b64_tr_b16 v[222:223], v7 offset:46080
    s_waitcnt lgkmcnt(6)
    v_mfma_f32_32x32x16_bf16 v[128:143], v[60:63], v[208:211], v[128:143]
    s_barrier
    ds_read_b64_tr_b16 v[192:193], v4 offset:49152
    ds_read_b64_tr_b16 v[194:195], v4 offset:50176
    s_waitcnt lgkmcnt(6)
    v_mfma_f32_32x32x16_bf16 v[144:159], v[60:63], v[212:215], v[144:159]
    ds_read_b64_tr_b16 v[196:197], v5 offset:49152
    ds_read_b64_tr_b16 v[198:199], v5 offset:50176
    s_waitcnt lgkmcnt(6)
    v_mfma_f32_32x32x16_bf16 v[160:175], v[60:63], v[216:219], v[160:175]
    ds_read_b64_tr_b16 v[200:201], v6 offset:49152
    ds_read_b64_tr_b16 v[202:203], v6 offset:50176
    s_waitcnt lgkmcnt(6)
    v_mfma_f32_32x32x16_bf16 v[176:191], v[60:63], v[220:223], v[176:191]
    ds_read_b64_tr_b16 v[204:205], v7 offset:49152
    ds_read_b64_tr_b16 v[206:207], v7 offset:50176
    s_waitcnt lgkmcnt(6)
    v_mfma_f32_32x32x16_bf16 v[128:143], v[64:67], v[192:195], v[128:143]
    ds_read_b64_tr_b16 v[208:209], v4 offset:53248
    ds_read_b64_tr_b16 v[210:211], v4 offset:54272
    s_waitcnt lgkmcnt(6)
    v_mfma_f32_32x32x16_bf16 v[144:159], v[64:67], v[196:199], v[144:159]
    ds_read_b64_tr_b16 v[212:213], v5 offset:53248
    ds_read_b64_tr_b16 v[214:215], v5 offset:54272
    s_waitcnt lgkmcnt(6)
    v_mfma_f32_32x32x16_bf16 v[160:175], v[64:67], v[200:203], v[160:175]
    ds_read_b64_tr_b16 v[216:217], v6 offset:53248
    ds_read_b64_tr_b16 v[218:219], v6 offset:54272
    s_waitcnt lgkmcnt(6)
    v_mfma_f32_32x32x16_bf16 v[176:191], v[64:67], v[204:207], v[176:191]
    ds_read_b64_tr_b16 v[220:221], v7 offset:53248
    ds_read_b64_tr_b16 v[222:223], v7 offset:54272
    s_waitcnt lgkmcnt(6)
    v_mfma_f32_32x32x16_bf16 v[128:143], v[68:71], v[208:211], v[128:143]
    s_barrier
    ds_read_b64_tr_b16 v[192:193], v4 offset:57344
    ds_read_b64_tr_b16 v[194:195], v4 offset:58368
    s_waitcnt lgkmcnt(6)
    v_mfma_f32_32x32x16_bf16 v[144:159], v[68:71], v[212:215], v[144:159]
    ds_read_b64_tr_b16 v[196:197], v5 offset:57344
    ds_read_b64_tr_b16 v[198:199], v5 offset:58368
    s_waitcnt lgkmcnt(6)
    v_mfma_f32_32x32x16_bf16 v[160:175], v[68:71], v[216:219], v[160:175]
    ds_read_b64_tr_b16 v[200:201], v6 offset:57344
    ds_read_b64_tr_b16 v[202:203], v6 offset:58368
    s_waitcnt lgkmcnt(6)
    v_mfma_f32_32x32x16_bf16 v[176:191], v[68:71], v[220:223], v[176:191]
    ds_read_b64_tr_b16 v[204:205], v7 offset:57344
    ds_read_b64_tr_b16 v[206:207], v7 offset:58368
    s_waitcnt lgkmcnt(6)
    v_mfma_f32_32x32x16_bf16 v[128:143], v[72:75], v[192:195], v[128:143]
    ds_read_b64_tr_b16 v[208:209], v4 offset:61440
    ds_read_b64_tr_b16 v[210:211], v4 offset:62464
    s_waitcnt lgkmcnt(6)
    v_mfma_f32_32x32x16_bf16 v[144:159], v[72:75], v[196:199], v[144:159]
    ds_read_b64_tr_b16 v[212:213], v5 offset:61440
    ds_read_b64_tr_b16 v[214:215], v5 offset:62464
    s_waitcnt lgkmcnt(6)
    v_mfma_f32_32x32x16_bf16 v[160:175], v[72:75], v[200:203], v[160:175]
    ds_read_b64_tr_b16 v[216:217], v6 offset:61440
    ds_read_b64_tr_b16 v[218:219], v6 offset:62464
    s_waitcnt lgkmcnt(6)
    v_mfma_f32_32x32x16_bf16 v[176:191], v[72:75], v[204:207], v[176:191]
    ds_read_b64_tr_b16 v[220:221], v7 offset:61440
    ds_read_b64_tr_b16 v[222:223], v7 offset:62464
    s_waitcnt lgkmcnt(6)
    v_mfma_f32_32x32x16_bf16 v[128:143], v[76:79], v[208:211], v[128:143]
    s_barrier
    ds_read_b64_tr_b16 v[192:193], v8 offset:0
    ds_read_b64_tr_b16 v[194:195], v8 offset:1024
    s_waitcnt lgkmcnt(6)
    v_mfma_f32_32x32x16_bf16 v[144:159], v[76:79], v[212:215], v[144:159]
    ds_read_b64_tr_b16 v[196:197], v9 offset:0
    ds_read_b64_tr_b16 v[198:199], v9 offset:1024
    s_waitcnt lgkmcnt(6)
    v_mfma_f32_32x32x16_bf16 v[160:175], v[76:79], v[216:219], v[160:175]
    ds_read_b64_tr_b16 v[200:201], v10 offset:0
    ds_read_b64_tr_b16 v[202:203], v10 offset:1024
    s_waitcnt lgkmcnt(6)
    v_mfma_f32_32x32x16_bf16 v[176:191], v[76:79], v[220:223], v[176:191]
    ds_read_b64_tr_b16 v[204:205], v11 offset:0
    ds_read_b64_tr_b16 v[206:207], v11 offset:1024
    s_waitcnt lgkmcnt(6)
    v_mfma_f32_32x32x16_bf16 v[128:143], v[80:83], v[192:195], v[128:143]
    ds_read_b64_tr_b16 v[208:209], v8 offset:4096
    ds_read_b64_tr_b16 v[210:211], v8 offset:5120
    s_waitcnt lgkmcnt(6)
    v_mfma_f32_32x32x16_bf16 v[144:159], v[80:83], v[196:199], v[144:159]
    ds_read_b64_tr_b16 v[212:213], v9 offset:4096
    ds_read_b64_tr_b16 v[214:215], v9 offset:5120
    s_waitcnt lgkmcnt(6)
    v_mfma_f32_32x32x16_bf16 v[160:175], v[80:83], v[200:203], v[160:175]
    ds_read_b64_tr_b16 v[216:217], v10 offset:4096
    ds_read_b64_tr_b16 v[218:219], v10 offset:5120
    s_waitcnt lgkmcnt(6)
    v_mfma_f32_32x32x16_bf16 v[176:191], v[80:83], v[204:207], v[176:191]
    ds_read_b64_tr_b16 v[220:221], v11 offset:4096
    ds_read_b64_tr_b16 v[222:223], v11 offset:5120
    s_waitcnt lgkmcnt(6)
    v_mfma_f32_32x32x16_bf16 v[128:143], v[84:87], v[208:211], v[128:143]
    s_barrier
    ds_read_b64_tr_b16 v[192:193], v8 offset:8192
    ds_read_b64_tr_b16 v[194:195], v8 offset:9216
    s_waitcnt lgkmcnt(6)
    v_mfma_f32_32x32x16_bf16 v[144:159], v[84:87], v[212:215], v[144:159]
    ds_read_b64_tr_b16 v[196:197], v9 offset:8192
    ds_read_b64_tr_b16 v[198:199], v9 offset:9216
    s_waitcnt lgkmcnt(6)
    v_mfma_f32_32x32x16_bf16 v[160:175], v[84:87], v[216:219], v[160:175]
    ds_read_b64_tr_b16 v[200:201], v10 offset:8192
    ds_read_b64_tr_b16 v[202:203], v10 offset:9216
    s_waitcnt lgkmcnt(6)
    v_mfma_f32_32x32x16_bf16 v[176:191], v[84:87], v[220:223], v[176:191]
    ds_read_b64_tr_b16 v[204:205], v11 offset:8192
    ds_read_b64_tr_b16 v[206:207], v11 offset:9216
    s_waitcnt lgkmcnt(6)
    v_mfma_f32_32x32x16_bf16 v[128:143], v[88:91], v[192:195], v[128:143]
    ds_read_b64_tr_b16 v[208:209], v8 offset:12288
    ds_read_b64_tr_b16 v[210:211], v8 offset:13312
    s_waitcnt lgkmcnt(6)
    v_mfma_f32_32x32x16_bf16 v[144:159], v[88:91], v[196:199], v[144:159]
    ds_read_b64_tr_b16 v[212:213], v9 offset:12288
    ds_read_b64_tr_b16 v[214:215], v9 offset:13312
    s_waitcnt lgkmcnt(6)
    v_mfma_f32_32x32x16_bf16 v[160:175], v[88:91], v[200:203], v[160:175]
    ds_read_b64_tr_b16 v[216:217], v10 offset:12288
    ds_read_b64_tr_b16 v[218:219], v10 offset:13312
    s_waitcnt lgkmcnt(6)
    v_mfma_f32_32x32x16_bf16 v[176:191], v[88:91], v[204:207], v[176:191]
    ds_read_b64_tr_b16 v[220:221], v11 offset:12288
    ds_read_b64_tr_b16 v[222:223], v11 offset:13312
    s_waitcnt lgkmcnt(6)
    v_mfma_f32_32x32x16_bf16 v[128:143], v[92:95], v[208:211], v[128:143]
    s_barrier
    ds_read_b64_tr_b16 v[192:193], v8 offset:16384
    ds_read_b64_tr_b16 v[194:195], v8 offset:17408
    s_waitcnt lgkmcnt(6)
    v_mfma_f32_32x32x16_bf16 v[144:159], v[92:95], v[212:215], v[144:159]
    ds_read_b64_tr_b16 v[196:197], v9 offset:16384
    ds_read_b64_tr_b16 v[198:199], v9 offset:17408
    s_waitcnt lgkmcnt(6)
    v_mfma_f32_32x32x16_bf16 v[160:175], v[92:95], v[216:219], v[160:175]
    ds_read_b64_tr_b16 v[200:201], v10 offset:16384
    ds_read_b64_tr_b16 v[202:203], v10 offset:17408
    s_waitcnt lgkmcnt(6)
    v_mfma_f32_32x32x16_bf16 v[176:191], v[92:95], v[220:223], v[176:191]
    ds_read_b64_tr_b16 v[204:205], v11 offset:16384
    ds_read_b64_tr_b16 v[206:207], v11 offset:17408
    s_waitcnt lgkmcnt(6)
    v_mfma_f32_32x32x16_bf16 v[128:143], v[96:99], v[192:195], v[128:143]
    ds_read_b64_tr_b16 v[208:209], v8 offset:20480
    ds_read_b64_tr_b16 v[210:211], v8 offset:21504
    buffer_load_dwordx4 v[16:19], v2, s[16:19], s42 offen offset:0 sc1
    s_waitcnt lgkmcnt(6)
    v_mfma_f32_32x32x16_bf16 v[144:159], v[96:99], v[196:199], v[144:159]
    ds_read_b64_tr_b16 v[212:213], v9 offset:20480
    ds_read_b64_tr_b16 v[214:215], v9 offset:21504
    s_waitcnt lgkmcnt(6)
    v_mfma_f32_32x32x16_bf16 v[160:175], v[96:99], v[200:203], v[160:175]
    ds_read_b64_tr_b16 v[216:217], v10 offset:20480
    ds_read_b64_tr_b16 v[218:219], v10 offset:21504
    buffer_load_dwordx4 v[20:23], v2, s[16:19], s42 offen offset:1024 sc1
    s_add_u32 s42, s42, 2048
    s_cmp_eq_u32 s42, s5
    s_cselect_b32 s42, s4, s42
    s_waitcnt lgkmcnt(6)
    v_mfma_f32_32x32x16_bf16 v[176:191], v[96:99], v[204:207], v[176:191]
    ds_read_b64_tr_b16 v[220:221], v11 offset:20480
    ds_read_b64_tr_b16 v[222:223], v11 offset:21504
    s_waitcnt lgkmcnt(6)
    v_mfma_f32_32x32x16_bf16 v[128:143], v[100:103], v[208:211], v[128:143]
    s_barrier
    ds_read_b64_tr_b16 v[192:193], v8 offset:24576
    ds_read_b64_tr_b16 v[194:195], v8 offset:25600
    s_waitcnt lgkmcnt(6)
    v_mfma_f32_32x32x16_bf16 v[144:159], v[100:103], v[212:215], v[144:159]
    ds_read_b64_tr_b16 v[196:197], v9 offset:24576
    ds_read_b64_tr_b16 v[198:199], v9 offset:25600
    buffer_load_dwordx4 v[24:27], v2, s[16:19], s42 offen offset:0 sc1
    s_waitcnt lgkmcnt(6)
    v_mfma_f32_32x32x16_bf16 v[160:175], v[100:103], v[216:219], v[160:175]
    ds_read_b64_tr_b16 v[200:201], v10 offset:24576
    ds_read_b64_tr_b16 v[202:203], v10 offset:25600
    s_waitcnt lgkmcnt(6)
    v_mfma_f32_32x32x16_bf16 v[176:191], v[100:103], v[220:223], v[176:191]
    ds_read_b64_tr_b16 v[204:205], v11 offset:24576
    ds_read_b64_tr_b16 v[206:207], v11 offset:25600
    s_waitcnt lgkmcnt(6)
    v_mfma_f32_32x32x16_bf16 v[128:143], v[104:107], v[192:195], v[128:143]
    ds_read_b64_tr_b16 v[208:209], v8 offset:28672
    ds_read_b64_tr_b16 v[210:211], v8 offset:29696
    buffer_load_dwordx4 v[28:31], v2, s[16:19], s42 offen offset:1024 sc1
    s_add_u32 s42, s42, 2048
    s_cmp_eq_u32 s42, s5
    s_cselect_b32 s42, s4, s42
    s_waitcnt lgkmcnt(6)
    v_mfma_f32_32x32x16_bf16 v[144:159], v[104:107], v[196:199], v[144:159]
    ds_read_b64_tr_b16 v[212:213], v9 offset:28672
    ds_read_b64_tr_b16 v[214:215], v9 offset:29696
    s_waitcnt lgkmcnt(6)
    v_mfma_f32_32x32x16_bf16 v[160:175], v[104:107], v[200:203], v[160:175]
    ds_read_b64_tr_b16 v[216:217], v10 offset:28672
    ds_read_b64_tr_b16 v[218:219], v10 offset:29696
    buffer_load_dwordx4 v[32:35], v2, s[16:19], s42 offen offset:0 sc1
    s_waitcnt lgkmcnt(6)
    v_mfma_f32_32x32x16_bf16 v[176:191], v[104:107], v[204:207], v[176:191]
    ds_read_b64_tr_b16 v[220:221], v11 offset:28672
    ds_read_b64_tr_b16 v[222:223], v11 offset:29696
    s_waitcnt lgkmcnt(6)
    v_mfma_f32_32x32x16_bf16 v[128:143], v[108:111], v[208:211], v[128:143]
    s_barrier
    ds_read_b64_tr_b16 v[192:193], v8 offset:32768
    ds_read_b64_tr_b16 v[194:195], v8 offset:33792
    s_waitcnt lgkmcnt(6)
    v_mfma_f32_32x32x16_bf16 v[144:159], v[108:111], v[212:215], v[144:159]
    ds_read_b64_tr_b16 v[196:197], v9 offset:32768
    ds_read_b64_tr_b16 v[198:199], v9 offset:33792
    buffer_load_dwordx4 v[36:39], v2, s[16:19], s42 offen offset:1024 sc1
    s_add_u32 s42, s42, 2048
    s_cmp_eq_u32 s42, s5
    s_cselect_b32 s42, s4, s42
    s_waitcnt lgkmcnt(6)
    v_mfma_f32_32x32x16_bf16 v[160:175], v[108:111], v[216:219], v[160:175]
    ds_read_b64_tr_b16 v[200:201], v10 offset:32768
    ds_read_b64_tr_b16 v[202:203], v10 offset:33792
    s_waitcnt lgkmcnt(6)
    v_mfma_f32_32x32x16_bf16 v[176:191], v[108:111], v[220:223], v[176:191]
    ds_read_b64_tr_b16 v[204:205], v11 offset:32768
    ds_read_b64_tr_b16 v[206:207], v11 offset:33792
    s_waitcnt lgkmcnt(6)
    v_mfma_f32_32x32x16_bf16 v[128:143], v[112:115], v[192:195], v[128:143]
    ds_read_b64_tr_b16 v[208:209], v8 offset:36864
    ds_read_b64_tr_b16 v[210:211], v8 offset:37888
    buffer_load_dwordx4 v[40:43], v2, s[16:19], s42 offen offset:0 sc1
    s_waitcnt lgkmcnt(6)
    v_mfma_f32_32x32x16_bf16 v[144:159], v[112:115], v[196:199], v[144:159]
    ds_read_b64_tr_b16 v[212:213], v9 offset:36864
    ds_read_b64_tr_b16 v[214:215], v9 offset:37888
    s_waitcnt lgkmcnt(6)
    v_mfma_f32_32x32x16_bf16 v[160:175], v[112:115], v[200:203], v[160:175]
    ds_read_b64_tr_b16 v[216:217], v10 offset:36864
    ds_read_b64_tr_b16 v[218:219], v10 offset:37888
    buffer_load_dwordx4 v[44:47], v2, s[16:19], s42 offen offset:1024 sc1
    s_add_u32 s42, s42, 2048
    s_cmp_eq_u32 s42, s5
    s_cselect_b32 s42, s4, s42
    s_waitcnt lgkmcnt(6)
    v_mfma_f32_32x32x16_bf16 v[176:191], v[112:115], v[204:207], v[176:191]
    ds_read_b64_tr_b16 v[220:221], v11 offset:36864
    ds_read_b64_tr_b16 v[222:223], v11 offset:37888
    s_waitcnt lgkmcnt(6)
    v_mfma_f32_32x32x16_bf16 v[128:143], v[116:119], v[208:211], v[128:143]
    s_barrier
    ds_read_b64_tr_b16 v[192:193], v8 offset:40960
    ds_read_b64_tr_b16 v[194:195], v8 offset:41984
    s_waitcnt lgkmcnt(6)
    v_mfma_f32_32x32x16_bf16 v[144:159], v[116:119], v[212:215], v[144:159]
    ds_read_b64_tr_b16 v[196:197], v9 offset:40960
    ds_read_b64_tr_b16 v[198:199], v9 offset:41984
    buffer_load_dwordx4 v[48:51], v2, s[16:19], s42 offen offset:0 sc1
    s_waitcnt lgkmcnt(6)
    v_mfma_f32_32x32x16_bf16 v[160:175], v[116:119], v[216:219], v[160:175]
    ds_read_b64_tr_b16 v[200:201], v10 offset:40960
    ds_read_b64_tr_b16 v[202:203], v10 offset:41984
    s_waitcnt lgkmcnt(6)
    v_mfma_f32_32x32x16_bf16 v[176:191], v[116:119], v[220:223], v[176:191]
    ds_read_b64_tr_b16 v[204:205], v11 offset:40960
    ds_read_b64_tr_b16 v[206:207], v11 offset:41984
    s_waitcnt lgkmcnt(6)
    v_mfma_f32_32x32x16_bf16 v[128:143], v[120:123], v[192:195], v[128:143]
    ds_read_b64_tr_b16 v[208:209], v8 offset:45056
    ds_read_b64_tr_b16 v[210:211], v8 offset:46080
    buffer_load_dwordx4 v[52:55], v2, s[16:19], s42 offen offset:1024 sc1
    s_add_u32 s42, s42, 2048
    s_cmp_eq_u32 s42, s5
    s_cselect_b32 s42, s4, s42
    s_waitcnt lgkmcnt(6)
    v_mfma_f32_32x32x16_bf16 v[144:159], v[120:123], v[196:199], v[144:159]
    ds_read_b64_tr_b16 v[212:213], v9 offset:45056
    ds_read_b64_tr_b16 v[214:215], v9 offset:46080
    s_waitcnt lgkmcnt(6)
    v_mfma_f32_32x32x16_bf16 v[160:175], v[120:123], v[200:203], v[160:175]
    ds_read_b64_tr_b16 v[216:217], v10 offset:45056
    ds_read_b64_tr_b16 v[218:219], v10 offset:46080
    buffer_load_dwordx4 v[56:59], v2, s[16:19], s42 offen offset:0 sc1
    s_waitcnt lgkmcnt(6)
    v_mfma_f32_32x32x16_bf16 v[176:191], v[120:123], v[204:207], v[176:191]
    ds_read_b64_tr_b16 v[220:221], v11 offset:45056
    ds_read_b64_tr_b16 v[222:223], v11 offset:46080
    s_waitcnt lgkmcnt(6)
    v_mfma_f32_32x32x16_bf16 v[128:143], v[124:127], v[208:211], v[128:143]
    s_waitcnt lgkmcnt(4)
    v_mfma_f32_32x32x16_bf16 v[144:159], v[124:127], v[212:215], v[144:159]
    buffer_load_dwordx4 v[60:63], v2, s[16:19], s42 offen offset:1024 sc1
    s_add_u32 s42, s42, 2048
    s_cmp_eq_u32 s42, s5
    s_cselect_b32 s42, s4, s42
    ds_read_b128 v[248:251], v13
    s_waitcnt lgkmcnt(3)
    v_mfma_f32_32x32x16_bf16 v[160:175], v[124:127], v[216:219], v[160:175]
    s_waitcnt lgkmcnt(1)
    v_mfma_f32_32x32x16_bf16 v[176:191], v[124:127], v[220:223], v[176:191]
    s_waitcnt lgkmcnt(0)
L15_st:
    v_min_u32 v14, v248, v249
    v_min3_u32 v14, v14, v250, v251
    v_cmp_eq_u32 vcc, 0, v14
    s_nop 1
    s_cbranch_vccnz L15_str
L16_stok:
    v_mfma_f32_32x32x16_bf16 v[128:143], v[226:229], v[248:251], v[128:143]
    v_mfma_f32_32x32x16_bf16 v[144:159], v[230:233], v[248:251], v[144:159]
    v_mfma_f32_32x32x16_bf16 v[160:175], v[224:227], v[248:251], v[160:175]
    v_mfma_f32_32x32x16_bf16 v[176:191], v[228:231], v[248:251], v[176:191]
    s_setprio 2
    s_lshl_b32 s44, s34, 2
    s_add_u32 s44, s44, s30
    s_mul_i32 s48, s44, 37
    s_lshr_b32 s48, s48, 8
    s_mul_i32 s45, s48, 7
    s_sub_u32 s44, s44, s45
    s_sub_u32 s44, s44, s34
    s_cselect_b32 s45, 7, 0
    s_add_u32 s44, s44, s45
    s_sub_u32 s48, s48, s33
    s_and_b32 s48, s48, 3
    s_lshl_b32 s44, s44, 2
    s_add_u32 s44, s44, s48
    s_lshl_b32 s44, s44, 12
    s_lshl_b32 s48, s35, 6
    v_xor_b32 v12, s48, v4
    v_add_u32 v12, s44, v12
    v_xor_b32 v13, 128, v12
    ds_read_b64_tr_b16 v[4:5], v12 offset:0
    ds_read_b64_tr_b16 v[6:7], v12 offset:1024
    ds_read_b64_tr_b16 v[8:9], v13 offset:0
    ds_read_b64_tr_b16 v[10:11], v13 offset:1024
    v_and_b32 v254, 0xffff0000, v248
    v_rcp_f32 v253, v254
    v_mul_f32 v254, v254, v254
    v_mul_f32 v253, 0xbfb8aa3b, v253
    v_mul_f32 v240, v128, v253
    v_mul_f32 v241, v129, v253
    v_mul_f32 v242, v130, v253
    v_mul_f32 v243, v131, v253
    buffer_load_dwordx4 v[64:67], v2, s[16:19], s42 offen offset:0 sc1
    v_mul_f32 v244, v132, v253
    v_mul_f32 v245, v133, v253
    v_mul_f32 v246, v134, v253
    v_mul_f32 v247, v135, v253
    v_exp_f32 v240, v240
    v_mul_f32 v128, v128, v136
    v_exp_f32 v241, v241
    v_mul_f32 v129, v129, v137
    v_exp_f32 v242, v242
    v_mul_f32 v130, v130, v138
    v_exp_f32 v243, v243
    v_mul_f32 v131, v131, v139
    v_exp_f32 v244, v244
    v_mul_f32 v132, v132, v140
    buffer_load_dwordx4 v[68:71], v2, s[16:19], s42 offen offset:1024 sc1
    s_add_u32 s42, s42, 2048
    s_cmp_eq_u32 s42, s5
    s_cselect_b32 s42, s4, s42
    v_exp_f32 v245, v245
    v_mul_f32 v133, v133, v141
    v_exp_f32 v246, v246
    v_mul_f32 v134, v134, v142
    v_exp_f32 v247, v247
    v_mul_f32 v135, v135, v143
    v_fma_f32 v240, v240, v254, v254
    v_fma_f32 v241, v241, v254, v254
    v_fma_f32 v242, v242, v254, v254
    v_fma_f32 v243, v243, v254, v254
    v_fma_f32 v244, v244, v254, v254
    v_fma_f32 v245, v245, v254, v254
    v_fma_f32 v246, v246, v254, v254
    v_fma_f32 v247, v247, v254, v254
    buffer_load_dwordx4 v[72:75], v2, s[16:19], s42 offen offset:0 sc1
    v_rcp_f32 v240, v240
    v_rcp_f32 v241, v241
    v_rcp_f32 v242, v242
    v_rcp_f32 v243, v243
    v_rcp_f32 v244, v244
    v_rcp_f32 v245, v245
    v_rcp_f32 v246, v246
    v_rcp_f32 v247, v247
    v_mul_f32 v128, v128, v240
    v_mul_f32 v129, v129, v241
    v_mul_f32 v130, v130, v242
    v_mul_f32 v131, v131, v243
    v_mul_f32 v132, v132, v244
    v_mul_f32 v133, v133, v245
    buffer_load_dwordx4 v[76:79], v2, s[16:19], s42 offen offset:1024 sc1
    s_add_u32 s42, s42, 2048
    s_cmp_eq_u32 s42, s5
    s_cselect_b32 s42, s4, s42
    v_mul_f32 v134, v134, v246
    v_mul_f32 v135, v135, v247
    v_cvt_pk_bf16_f32 v136, v128, v129
    v_cvt_pk_bf16_f32 v137, v130, v131
    v_cvt_pk_bf16_f32 v138, v132, v133
    v_cvt_pk_bf16_f32 v139, v134, v135
    s_add_u32 s44, s40, 0
    buffer_store_dwordx4 v[136:139], v2, s[16:19], s44 offen sc1
    v_and_b32 v254, 0xffff0000, v249
    v_rcp_f32 v253, v254
    v_mul_f32 v254, v254, v254
    v_mul_f32 v253, 0xbfb8aa3b, v253
    v_mul_f32 v240, v144, v253
    v_mul_f32 v241, v145, v253
    v_mul_f32 v242, v146, v253
    v_mul_f32 v243, v147, v253
    buffer_load_dwordx4 v[80:83], v2, s[16:19], s42 offen offset:0 sc1
    v_mul_f32 v244, v148, v253
    v_mul_f32 v245, v149, v253
    v_mul_f32 v246, v150, v253
    v_mul_f32 v247, v151, v253
    v_exp_f32 v240, v240
    v_mul_f32 v144, v144, v152
    v_exp_f32 v241, v241
    v_mul_f32 v145, v145, v153
    v_exp_f32 v242, v242
    v_mul_f32 v146, v146, v154
    v_exp_f32 v243, v243
    v_mul_f32 v147, v147, v155
    v_exp_f32 v244, v244
    v_mul_f32 v148, v148, v156
    buffer_load_dwordx4 v[84:87], v2, s[16:19], s42 offen offset:1024 sc1
    s_add_u32 s42, s42, 2048
    s_cmp_eq_u32 s42, s5
    s_cselect_b32 s42, s4, s42
    v_exp_f32 v245, v245
    v_mul_f32 v149, v149, v157
    v_exp_f32 v246, v246
    v_mul_f32 v150, v150, v158
    v_exp_f32 v247, v247
    v_mul_f32 v151, v151, v159
    v_fma_f32 v240, v240, v254, v254
    v_fma_f32 v241, v241, v254, v254
    v_fma_f32 v242, v242, v254, v254
    v_fma_f32 v243, v243, v254, v254
    v_fma_f32 v244, v244, v254, v254
    v_fma_f32 v245, v245, v254, v254
    v_fma_f32 v246, v246, v254, v254
    v_fma_f32 v247, v247, v254, v254
    buffer_load_dwordx4 v[88:91], v2, s[16:19], s42 offen offset:0 sc1
    v_rcp_f32 v240, v240
    v_rcp_f32 v241, v241
    v_rcp_f32 v242, v242
    v_rcp_f32 v243, v243
    v_rcp_f32 v244, v244
    v_rcp_f32 v245, v245
    v_rcp_f32 v246, v246
    v_rcp_f32 v247, v247
    v_mul_f32 v144, v144, v240
    v_mul_f32 v145, v145, v241
    v_mul_f32 v146, v146, v242
    v_mul_f32 v147, v147, v243
    v_mul_f32 v148, v148, v244
    v_mul_f32 v149, v149, v245
    buffer_load_dwordx4 v[92:95], v2, s[16:19], s42 offen offset:1024 sc1
    s_add_u32 s42, s42, 2048
    s_cmp_eq_u32 s42, s5
    s_cselect_b32 s42, s4, s42
    v_mul_f32 v150, v150, v246
    v_mul_f32 v151, v151, v247
    v_cvt_pk_bf16_f32 v152, v144, v145
    v_cvt_pk_bf16_f32 v153, v146, v147
    v_cvt_pk_bf16_f32 v154, v148, v149
    v_cvt_pk_bf16_f32 v155, v150, v151
    s_add_u32 s44, s40, 114688
    buffer_store_dwordx4 v[152:155], v2, s[16:19], s44 offen sc1
    v_and_b32 v254, 0xffff0000, v250
    v_rcp_f32 v253, v254
    v_mul_f32 v254, v254, v254
    v_mul_f32 v253, 0xbfb8aa3b, v253
    v_mul_f32 v240, v160, v253
    v_mul_f32 v241, v161, v253
    v_mul_f32 v242, v162, v253
    v_mul_f32 v243, v163, v253
    buffer_load_dwordx4 v[96:99], v2, s[16:19], s42 offen offset:0 sc1
    v_mul_f32 v244, v164, v253
    v_mul_f32 v245, v165, v253
    v_mul_f32 v246, v166, v253
    v_mul_f32 v247, v167, v253
    v_exp_f32 v240, v240
    v_mul_f32 v160, v160, v168
    v_exp_f32 v241, v241
    v_mul_f32 v161, v161, v169
    v_exp_f32 v242, v242
    v_mul_f32 v162, v162, v170
    v_exp_f32 v243, v243
    v_mul_f32 v163, v163, v171
    v_exp_f32 v244, v244
    v_mul_f32 v164, v164, v172
    buffer_load_dwordx4 v[100:103], v2, s[16:19], s42 offen offset:1024 sc1
    s_add_u32 s42, s42, 2048
    s_cmp_eq_u32 s42, s5
    s_cselect_b32 s42, s4, s42
    v_exp_f32 v245, v245
    v_mul_f32 v165, v165, v173
    v_exp_f32 v246, v246
    v_mul_f32 v166, v166, v174
    v_exp_f32 v247, v247
    v_mul_f32 v167, v167, v175
    v_fma_f32 v240, v240, v254, v254
    v_fma_f32 v241, v241, v254, v254
    v_fma_f32 v242, v242, v254, v254
    v_fma_f32 v243, v243, v254, v254
    v_fma_f32 v244, v244, v254, v254
    v_fma_f32 v245, v245, v254, v254
    v_fma_f32 v246, v246, v254, v254
    v_fma_f32 v247, v247, v254, v254
    buffer_load_dwordx4 v[104:107], v2, s[16:19], s42 offen offset:0 sc1
    v_rcp_f32 v240, v240
    v_rcp_f32 v241, v241
    v_rcp_f32 v242, v242
    v_rcp_f32 v243, v243
    v_rcp_f32 v244, v244
    v_rcp_f32 v245, v245
    v_rcp_f32 v246, v246
    v_rcp_f32 v247, v247
    v_mul_f32 v160, v160, v240
    v_mul_f32 v161, v161, v241
    v_mul_f32 v162, v162, v242
    v_mul_f32 v163, v163, v243
    v_mul_f32 v164, v164, v244
    v_mul_f32 v165, v165, v245
    buffer_load_dwordx4 v[108:111], v2, s[16:19], s42 offen offset:1024 sc1
    s_add_u32 s42, s42, 2048
    s_cmp_eq_u32 s42, s5
    s_cselect_b32 s42, s4, s42
    v_mul_f32 v166, v166, v246
    v_mul_f32 v167, v167, v247
    v_cvt_pk_bf16_f32 v168, v160, v161
    v_cvt_pk_bf16_f32 v169, v162, v163
    v_cvt_pk_bf16_f32 v170, v164, v165
    v_cvt_pk_bf16_f32 v171, v166, v167
    s_add_u32 s44, s40, 229376
    buffer_store_dwordx4 v[168:171], v2, s[16:19], s44 offen sc1
    v_and_b32 v254, 0xffff0000, v251
    v_rcp_f32 v253, v254
    v_mul_f32 v254, v254, v254
    v_mul_f32 v253, 0xbfb8aa3b, v253
    v_mul_f32 v240, v176, v253
    v_mul_f32 v241, v177, v253
    v_mul_f32 v242, v178, v253
    v_mul_f32 v243, v179, v253
    buffer_load_dwordx4 v[112:115], v2, s[16:19], s42 offen offset:0 sc1
    v_mul_f32 v244, v180, v253
    v_mul_f32 v245, v181, v253
    v_mul_f32 v246, v182, v253
    v_mul_f32 v247, v183, v253
    v_exp_f32 v240, v240
    v_mul_f32 v176, v176, v184
    v_exp_f32 v241, v241
    v_mul_f32 v177, v177, v185
    v_exp_f32 v242, v242
    v_mul_f32 v178, v178, v186
    v_exp_f32 v243, v243
    v_mul_f32 v179, v179, v187
    v_exp_f32 v244, v244
    v_mul_f32 v180, v180, v188
    buffer_load_dwordx4 v[116:119], v2, s[16:19], s42 offen offset:1024 sc1
    s_add_u32 s42, s42, 2048
    s_cmp_eq_u32 s42, s5
    s_cselect_b32 s42, s4, s42
    v_exp_f32 v245, v245
    v_mul_f32 v181, v181, v189
    v_exp_f32 v246, v246
    v_mul_f32 v182, v182, v190
    v_exp_f32 v247, v247
    v_mul_f32 v183, v183, v191
    v_fma_f32 v240, v240, v254, v254
    v_fma_f32 v241, v241, v254, v254
    v_fma_f32 v242, v242, v254, v254
    s_waitcnt vmcnt(7)
    s_mov_b64 exec, 1
    v_mov_b32 v14, 256
    buffer_atomic_add v14, off, s[16:19], s41 sc1
    s_mov_b64 exec, -1
    v_fma_f32 v243, v243, v254, v254
    v_fma_f32 v244, v244, v254, v254
    v_fma_f32 v245, v245, v254, v254
    v_fma_f32 v246, v246, v254, v254
    v_fma_f32 v247, v247, v254, v254
    buffer_load_dwordx4 v[120:123], v2, s[16:19], s42 offen offset:0 sc1
    v_rcp_f32 v240, v240
    v_rcp_f32 v241, v241
    v_rcp_f32 v242, v242
    v_rcp_f32 v243, v243
    v_rcp_f32 v244, v244
    v_rcp_f32 v245, v245
    v_rcp_f32 v246, v246
    v_rcp_f32 v247, v247
    v_mul_f32 v176, v176, v240
    v_mul_f32 v177, v177, v241
    v_mul_f32 v178, v178, v242
    v_mul_f32 v179, v179, v243
    v_mul_f32 v180, v180, v244
    v_mul_f32 v181, v181, v245
    buffer_load_dwordx4 v[124:127], v2, s[16:19], s42 offen offset:1024 sc1
    v_mul_f32 v182, v182, v246
    v_mul_f32 v183, v183, v247
    v_cvt_pk_bf16_f32 v184, v176, v177
    v_cvt_pk_bf16_f32 v185, v178, v179
    v_cvt_pk_bf16_f32 v186, v180, v181
    v_cvt_pk_bf16_f32 v187, v182, v183
    s_add_u32 s44, s40, 344064
    buffer_store_dwordx4 v[184:187], v2, s[16:19], s44 offen sc1
    s_lshl_b32 s44, s39, 3
    s_add_u32 s44, s44, 114688
    v_add_u32 v12, s44, v2
    s_lshr_b32 s44, s39, 8
    s_add_u32 s44, s44, 160768
    v_mov_b32 v13, s44
    s_xor_b32 s40, s40, 4096
    s_xor_b32 s45, s41, 512
    s_mov_b32 s47, 0x8000
L17_sp:
    ds_read_b32 v14, v13 offset:80
    s_waitcnt lgkmcnt(0)
    v_readfirstlane_b32 s48, v14
    s_nop 0
    s_cmp_ge_u32 s48, 1
    s_cbranch_scc1 L18_ok
    s_sleep 1
    s_sub_u32 s47, s47, 1
    s_cbranch_scc0 L17_sp
L18_ok:
    ds_read_b128 v[128:131], v12 offset:0
    ds_read_b128 v[132:135], v12 offset:1024
    ds_read_b128 v[136:139], v12 offset:2048
    ds_read_b128 v[140:143], v12 offset:3072
    ds_read_b128 v[144:147], v12 offset:4096
    ds_read_b128 v[148:151], v12 offset:5120
    ds_read_b128 v[152:155], v12 offset:6144
    ds_read_b128 v[156:159], v12 offset:7168
    v_and_b32 v254, 0xffff0000, v248
    v_rcp_f32 v253, v254
    v_mul_f32 v254, v254, v254
    v_mul_f32 v253, 0xbfb8aa3b, v253
    s_waitcnt lgkmcnt(4)
    v_mul_f32 v240, v128, v253
    v_mul_f32 v241, v129, v253
    v_mul_f32 v242, v130, v253
    v_mul_f32 v243, v131, v253
    v_mul_f32 v244, v132, v253
    v_mul_f32 v245, v133, v253
    v_mul_f32 v246, v134, v253
    v_mul_f32 v247, v135, v253
    v_exp_f32 v240, v240
    v_mul_f32 v128, v128, v136
    v_exp_f32 v241, v241
    v_mul_f32 v129, v129, v137
    v_exp_f32 v242, v242
    v_mul_f32 v130, v130, v138
    v_exp_f32 v243, v243
    v_mul_f32 v131, v131, v139
    v_exp_f32 v244, v244
    v_mul_f32 v132, v132, v140
    v_exp_f32 v245, v245
    v_mul_f32 v133, v133, v141
    v_exp_f32 v246, v246
    v_mul_f32 v134, v134, v142
    v_exp_f32 v247, v247
    v_mul_f32 v135, v135, v143
    v_fma_f32 v240, v240, v254, v254
    v_fma_f32 v241, v241, v254, v254
    v_fma_f32 v242, v242, v254, v254
    v_fma_f32 v243, v243, v254, v254
    v_fma_f32 v244, v244, v254, v254
    v_fma_f32 v245, v245, v254, v254
    v_fma_f32 v246, v246, v254, v254
    v_fma_f32 v247, v247, v254, v254
    v_rcp_f32 v240, v240
    v_rcp_f32 v241, v241
    v_rcp_f32 v242, v242
    v_rcp_f32 v243, v243
    v_rcp_f32 v244, v244
    v_rcp_f32 v245, v245
    v_rcp_f32 v246, v246
    v_rcp_f32 v247, v247
    v_mul_f32 v128, v128, v240
    v_mul_f32 v129, v129, v241
    v_mul_f32 v130, v130, v242
    v_mul_f32 v131, v131, v243
    v_mul_f32 v132, v132, v244
    v_mul_f32 v133, v133, v245
    v_mul_f32 v134, v134, v246
    v_mul_f32 v135, v135, v247
    v_cvt_pk_bf16_f32 v136, v128, v129
    v_cvt_pk_bf16_f32 v137, v130, v131
    v_cvt_pk_bf16_f32 v138, v132, v133
    v_cvt_pk_bf16_f32 v139, v134, v135
    s_add_u32 s44, s40, 0
    buffer_store_dwordx4 v[136:139], v2, s[16:19], s44 offen sc1
    s_waitcnt vmcnt(1)
    s_mov_b64 exec, 1
    v_mov_b32 v14, 1
    buffer_atomic_add v14, off, s[16:19], s41 sc1
    s_mov_b64 exec, -1
    v_and_b32 v254, 0xffff0000, v249
    v_rcp_f32 v253, v254
    v_mul_f32 v254, v254, v254
    v_mul_f32 v253, 0xbfb8aa3b, v253
    s_waitcnt lgkmcnt(0)
    v_mul_f32 v240, v144, v253
    v_mul_f32 v241, v145, v253
    v_mul_f32 v242, v146, v253
    v_mul_f32 v243, v147, v253
    v_mul_f32 v244, v148, v253
    v_mul_f32 v245, v149, v253
    v_mul_f32 v246, v150, v253
    v_mul_f32 v247, v151, v253
    v_exp_f32 v240, v240
    v_mul_f32 v144, v144, v152
    v_exp_f32 v241, v241
    v_mul_f32 v145, v145, v153
    v_exp_f32 v242, v242
    v_mul_f32 v146, v146, v154
    v_exp_f32 v243, v243
    v_mul_f32 v147, v147, v155
    v_exp_f32 v244, v244
    v_mul_f32 v148, v148, v156
    v_exp_f32 v245, v245
    v_mul_f32 v149, v149, v157
    v_exp_f32 v246, v246
    v_mul_f32 v150, v150, v158
    v_exp_f32 v247, v247
    v_mul_f32 v151, v151, v159
    v_fma_f32 v240, v240, v254, v254
    v_fma_f32 v241, v241, v254, v254
    v_fma_f32 v242, v242, v254, v254
    v_fma_f32 v243, v243, v254, v254
    v_fma_f32 v244, v244, v254, v254
    v_fma_f32 v245, v245, v254, v254
    v_fma_f32 v246, v246, v254, v254
    v_fma_f32 v247, v247, v254, v254
    v_rcp_f32 v240, v240
    v_rcp_f32 v241, v241
    v_rcp_f32 v242, v242
    v_rcp_f32 v243, v243
    v_rcp_f32 v244, v244
    v_rcp_f32 v245, v245
    v_rcp_f32 v246, v246
    v_rcp_f32 v247, v247
    v_mul_f32 v144, v144, v240
    v_mul_f32 v145, v145, v241
    v_mul_f32 v146, v146, v242
    v_mul_f32 v147, v147, v243
    v_mul_f32 v148, v148, v244
    v_mul_f32 v149, v149, v245
    v_mul_f32 v150, v150, v246
    v_mul_f32 v151, v151, v247
    v_cvt_pk_bf16_f32 v152, v144, v145
    v_cvt_pk_bf16_f32 v153, v146, v147
    v_cvt_pk_bf16_f32 v154, v148, v149
    v_cvt_pk_bf16_f32 v155, v150, v151
    s_add_u32 s44, s40, 114688
    buffer_store_dwordx4 v[152:155], v2, s[16:19], s44 offen sc1
    v_and_b32 v12, 31, v1
    v_lshrrev_b32 v13, 5, v1
    v_lshlrev_b32 v13, 3, v13
    v_sub_u32 v12, v12, v13
    s_lshl_b32 s44, s30, 4
    v_subrev_u32 v12, s44, v12
    v_mov_b32 v13, 0x3f80
    v_mov_b32 v14, 0x3f800000
    v_cmp_eq_u32 vcc, 0, v12
    s_nop 1
    v_cndmask_b32 v240, 0, v13, vcc
    v_cmp_eq_u32 vcc, 1, v12
    s_nop 1
    v_cndmask_b32 v240, v240, v14, vcc
    v_cmp_eq_u32 vcc, 2, v12
    s_nop 1
    v_cndmask_b32 v241, 0, v13, vcc
    v_cmp_eq_u32 vcc, 3, v12
    s_nop 1
    v_cndmask_b32 v241, v241, v14, vcc
    v_cmp_eq_u32 vcc, 4, v12
    s_nop 1
    v_cndmask_b32 v242, 0, v13, vcc
    v_cmp_eq_u32 vcc, 5, v12
    s_nop 1
    v_cndmask_b32 v242, v242, v14, vcc
    v_cmp_eq_u32 vcc, 6, v12
    s_nop 1
    v_cndmask_b32 v243, 0, v13, vcc
    v_cmp_eq_u32 vcc, 7, v12
    s_nop 1
    v_cndmask_b32 v243, v243, v14, vcc
    v_cmp_eq_u32 vcc, -32, v12
    s_nop 1
    v_cndmask_b32 v244, 0, v13, vcc
    v_cmp_eq_u32 vcc, -31, v12
    s_nop 1
    v_cndmask_b32 v244, v244, v14, vcc
    v_cmp_eq_u32 vcc, -30, v12
    s_nop 1
    v_cndmask_b32 v245, 0, v13, vcc
    v_cmp_eq_u32 vcc, -29, v12
    s_nop 1
    v_cndmask_b32 v245, v245, v14, vcc
    v_cmp_eq_u32 vcc, -28, v12
    s_nop 1
    v_cndmask_b32 v246, 0, v13, vcc
    v_cmp_eq_u32 vcc, -27, v12
    s_nop 1
    v_cndmask_b32 v246, v246, v14, vcc
    v_cmp_eq_u32 vcc, -26, v12
    s_nop 1
    v_cndmask_b32 v247, 0, v13, vcc
    v_cmp_eq_u32 vcc, -25, v12
    s_nop 1
    v_cndmask_b32 v247, v247, v14, vcc
    s_setprio 0
    s_buffer_load_dword s58, s[16:19], s41 glc
    s_waitcnt vmcnt(0)
    s_mov_b64 exec, 1
    v_mov_b32 v14, 256
    buffer_atomic_add v14, off, s[16:19], s45 sc1
    s_mov_b64 exec, -1
    s_waitcnt lgkmcnt(0)
    v_mfma_f32_32x32x16_bf16 v[128:143], v[240:243], v[4:7], 0
    v_mfma_f32_32x32x16_bf16 v[144:159], v[244:247], v[4:7], 0
    v_mfma_f32_32x32x16_bf16 v[160:175], v[240:243], v[8:11], 0
    v_mfma_f32_32x32x16_bf16 v[176:191], v[244:247], v[8:11], 0
    v_mov_b32 v12, 160768
    s_mov_b32 s47, 0x8000
L19_sp:
    ds_read_b32 v14, v12 offset:28
    s_waitcnt lgkmcnt(0)
    v_readfirstlane_b32 s48, v14
    s_nop 0
    s_cmp_ge_u32 s48, 4
    s_cbranch_scc1 L20_ok
    s_sleep 2
    s_sub_u32 s47, s47, 1
    s_cbranch_scc0 L19_sp
L20_ok:
    s_waitcnt lgkmcnt(0)
    s_cmp_lt_u32 s58, 3584
    s_cbranch_scc1 L21_poll
L22_pok:
    v_and_b32 v12, 31, v1
    v_lshrrev_b32 v13, 5, v1
    v_lshlrev_b32 v12, 4, v12
    v_lshl_add_u32 v12, v13, 9, v12
    s_lshl_b32 s44, s39, 3
    s_add_u32 s44, s44, 65536
    v_add_u32 v12, s44, v12
    v_add_u32 v15, 229376, v2
    buffer_load_dwordx4 v[192:195], v2, s[16:19], s43 offen sc1
    s_add_u32 s43, s43, 8192
    s_cmp_eq_u32 s43, s7
    s_cselect_b32 s43, s6, s43
    buffer_load_dwordx4 v[196:199], v2, s[16:19], s43 offen sc1
    s_add_u32 s43, s43, 8192
    s_cmp_eq_u32 s43, s7
    s_cselect_b32 s43, s6, s43
    s_buffer_load_dword s58, s[16:19], s41 glc
    s_waitcnt vmcnt(1)
    s_waitcnt lgkmcnt(0)
    s_cmp_lt_u32 s58, 3598
    s_cbranch_scc1 L23_poll
L24_pok:
    buffer_load_dwordx4 v[200:203], v15, s[16:19], s8 offen sc1
    s_add_u32 s8, s8, 8192
    s_cmp_eq_u32 s8, s7
    s_cselect_b32 s8, s6, s8
    buffer_load_dwordx4 v[204:207], v15, s[16:19], s8 offen sc1
    s_add_u32 s8, s8, 8192
    s_cmp_eq_u32 s8, s7
    s_cselect_b32 s8, s6, s8
    buffer_load_dwordx4 v[208:211], v2, s[16:19], s43 offen sc1
    s_add_u32 s43, s43, 8192
    s_cmp_eq_u32 s43, s7
    s_cselect_b32 s43, s6, s43
    buffer_load_dwordx4 v[212:215], v2, s[16:19], s43 offen sc1
    s_add_u32 s43, s43, 8192
    s_cmp_eq_u32 s43, s7
    s_cselect_b32 s43, s6, s43
    buffer_load_dwordx4 v[216:219], v2, s[16:19], s43 offen sc1
    s_add_u32 s43, s43, 8192
    s_cmp_eq_u32 s43, s7
    s_cselect_b32 s43, s6, s43
    buffer_load_dwordx4 v[220:223], v2, s[16:19], s43 offen sc1
    s_add_u32 s43, s43, 8192
    s_cmp_eq_u32 s43, s7
    s_cselect_b32 s43, s6, s43
    buffer_load_dwordx4 v[224:227], v2, s[16:19], s43 offen sc1
    s_add_u32 s43, s43, 8192
    s_cmp_eq_u32 s43, s7
    s_cselect_b32 s43, s6, s43
    buffer_load_dwordx4 v[228:231], v2, s[16:19], s43 offen sc1
    s_add_u32 s43, s43, 8192
    s_cmp_eq_u32 s43, s7
    s_cselect_b32 s43, s6, s43
    buffer_load_dwordx4 v[232:235], v2, s[16:19], s43 offen sc1
    s_add_u32 s43, s43, 8192
    s_cmp_eq_u32 s43, s7
    s_cselect_b32 s43, s6, s43
    buffer_load_dwordx4 v[236:239], v2, s[16:19], s43 offen sc1
    s_add_u32 s43, s43, 8192
    s_cmp_eq_u32 s43, s7
    s_cselect_b32 s43, s6, s43
    v_mfma_f32_32x32x16_bf16 v[128:143], v[16:19], v[192:195], v[128:143]
    v_mfma_f32_32x32x16_bf16 v[144:159], v[20:23], v[192:195], v[144:159]
    buffer_load_dwordx4 v[192:195], v2, s[16:19], s43 offen sc1
    s_add_u32 s43, s43, 8192
    s_cmp_eq_u32 s43, s7
    s_cselect_b32 s43, s6, s43
    s_waitcnt vmcnt(11)
    v_mfma_f32_32x32x16_bf16 v[128:143], v[24:27], v[196:199], v[128:143]
    v_mfma_f32_32x32x16_bf16 v[144:159], v[28:31], v[196:199], v[144:159]
    buffer_load_dwordx4 v[196:199], v2, s[16:19], s43 offen sc1
    s_add_u32 s43, s43, 8192
    s_cmp_eq_u32 s43, s7
    s_cselect_b32 s43, s6, s43
    s_waitcnt vmcnt(11)
    v_mfma_f32_32x32x16_bf16 v[160:175], v[16:19], v[200:203], v[160:175]
    v_mfma_f32_32x32x16_bf16 v[176:191], v[20:23], v[200:203], v[176:191]
    buffer_load_dwordx4 v[200:203], v2, s[16:19], s43 offen sc1
    s_add_u32 s43, s43, 8192
    s_cmp_eq_u32 s43, s7
    s_cselect_b32 s43, s6, s43
    s_waitcnt vmcnt(11)
    v_mfma_f32_32x32x16_bf16 v[160:175], v[24:27], v[204:207], v[160:175]
    v_mfma_f32_32x32x16_bf16 v[176:191], v[28:31], v[204:207], v[176:191]
    buffer_load_dwordx4 v[204:207], v2, s[16:19], s43 offen sc1
    v_mov_b32 v240, 160768
    v_mov_b32 v241, 1
    s_mov_b64 exec, 1
    ds_add_u32 v240, v241 offset:44
    s_mov_b64 exec, -1
    s_waitcnt vmcnt(11)
    v_mfma_f32_32x32x16_bf16 v[128:143], v[32:35], v[208:211], v[128:143]
    v_mfma_f32_32x32x16_bf16 v[144:159], v[36:39], v[208:211], v[144:159]
    buffer_load_dwordx4 v[208:211], v15, s[16:19], s8 offen sc1
    s_add_u32 s8, s8, 8192
    s_cmp_eq_u32 s8, s7
    s_cselect_b32 s8, s6, s8
    s_waitcnt vmcnt(11)
    v_mfma_f32_32x32x16_bf16 v[128:143], v[40:43], v[212:215], v[128:143]
    v_mfma_f32_32x32x16_bf16 v[144:159], v[44:47], v[212:215], v[144:159]
    buffer_load_dwordx4 v[212:215], v15, s[16:19], s8 offen sc1
    s_add_u32 s8, s8, 8192
    s_cmp_eq_u32 s8, s7
    s_cselect_b32 s8, s6, s8
    s_waitcnt vmcnt(11)
    v_mfma_f32_32x32x16_bf16 v[128:143], v[48:51], v[216:219], v[128:143]
    v_mfma_f32_32x32x16_bf16 v[144:159], v[52:55], v[216:219], v[144:159]
    buffer_load_dwordx4 v[216:219], v15, s[16:19], s8 offen sc1
    s_add_u32 s8, s8, 8192
    s_cmp_eq_u32 s8, s7
    s_cselect_b32 s8, s6, s8
    s_waitcnt vmcnt(11)
    v_mfma_f32_32x32x16_bf16 v[128:143], v[56:59], v[220:223], v[128:143]
    v_mfma_f32_32x32x16_bf16 v[144:159], v[60:63], v[220:223], v[144:159]
    buffer_load_dwordx4 v[220:223], v15, s[16:19], s8 offen sc1
    s_add_u32 s8, s8, 8192
    s_cmp_eq_u32 s8, s7
    s_cselect_b32 s8, s6, s8
    s_waitcnt vmcnt(11)
    v_mfma_f32_32x32x16_bf16 v[128:143], v[64:67], v[224:227], v[128:143]
    v_mfma_f32_32x32x16_bf16 v[144:159], v[68:71], v[224:227], v[144:159]
    buffer_load_dwordx4 v[224:227], v15, s[16:19], s8 offen sc1
    s_add_u32 s8, s8, 8192
    s_cmp_eq_u32 s8, s7
    s_cselect_b32 s8, s6, s8
    s_waitcnt vmcnt(11)
    v_mfma_f32_32x32x16_bf16 v[128:143], v[72:75], v[228:231], v[128:143]
    v_mfma_f32_32x32x16_bf16 v[144:159], v[76:79], v[228:231], v[144:159]
    buffer_load_dwordx4 v[228:231], v15, s[16:19], s8 offen sc1
    s_add_u32 s8, s8, 8192
    s_cmp_eq_u32 s8, s7
    s_cselect_b32 s8, s6, s8
    s_waitcnt vmcnt(11)
    v_mfma_f32_32x32x16_bf16 v[128:143], v[80:83], v[232:235], v[128:143]
    v_mfma_f32_32x32x16_bf16 v[144:159], v[84:87], v[232:235], v[144:159]
    buffer_load_dwordx4 v[232:235], v15, s[16:19], s8 offen sc1
    s_add_u32 s8, s8, 8192
    s_cmp_eq_u32 s8, s7
    s_cselect_b32 s8, s6, s8
    s_waitcnt vmcnt(11)
    v_mfma_f32_32x32x16_bf16 v[128:143], v[88:91], v[236:239], v[128:143]
    v_mfma_f32_32x32x16_bf16 v[144:159], v[92:95], v[236:239], v[144:159]
    buffer_load_dwordx4 v[236:239], v15, s[16:19], s8 offen sc1
    s_add_u32 s8, s8, 8192
    s_cmp_eq_u32 s8, s7
    s_cselect_b32 s8, s6, s8
    s_waitcnt vmcnt(11)
    v_mfma_f32_32x32x16_bf16 v[128:143], v[96:99], v[192:195], v[128:143]
    v_mfma_f32_32x32x16_bf16 v[144:159], v[100:103], v[192:195], v[144:159]
    buffer_load_dwordx4 v[192:195], v15, s[16:19], s8 offen sc1
    s_add_u32 s8, s8, 8192
    s_cmp_eq_u32 s8, s7
    s_cselect_b32 s8, s6, s8
    s_waitcnt vmcnt(11)
    v_mfma_f32_32x32x16_bf16 v[128:143], v[104:107], v[196:199], v[128:143]
    v_mfma_f32_32x32x16_bf16 v[144:159], v[108:111], v[196:199], v[144:159]
    buffer_load_dwordx4 v[196:199], v15, s[16:19], s8 offen sc1
    s_add_u32 s8, s8, 8192
    s_cmp_eq_u32 s8, s7
    s_cselect_b32 s8, s6, s8
    s_waitcnt vmcnt(11)
    v_mfma_f32_32x32x16_bf16 v[128:143], v[112:115], v[200:203], v[128:143]
    v_mfma_f32_32x32x16_bf16 v[144:159], v[116:119], v[200:203], v[144:159]
    buffer_load_dwordx4 v[200:203], v15, s[16:19], s8 offen sc1
    s_add_u32 s8, s8, 8192
    s_cmp_eq_u32 s8, s7
    s_cselect_b32 s8, s6, s8
    s_waitcnt vmcnt(11)
    v_mfma_f32_32x32x16_bf16 v[128:143], v[120:123], v[204:207], v[128:143]
    v_mfma_f32_32x32x16_bf16 v[144:159], v[124:127], v[204:207], v[144:159]
    buffer_load_dwordx4 v[204:207], v15, s[16:19], s8 offen sc1
    s_waitcnt vmcnt(11)
    v_mfma_f32_32x32x16_bf16 v[160:175], v[32:35], v[208:211], v[160:175]
    v_mfma_f32_32x32x16_bf16 v[176:191], v[36:39], v[208:211], v[176:191]
    s_waitcnt vmcnt(10)
    v_mfma_f32_32x32x16_bf16 v[160:175], v[40:43], v[212:215], v[160:175]
    v_xor_b32 v13, 0, v12
    s_nop 3
    ds_write_b128 v13, v[128:131] offset:49152
    v_mfma_f32_32x32x16_bf16 v[176:191], v[44:47], v[212:215], v[176:191]
    v_xor_b32 v14, 32, v12
    ds_write_b128 v14, v[132:135] offset:50176
    s_waitcnt vmcnt(9)
    v_mfma_f32_32x32x16_bf16 v[160:175], v[48:51], v[216:219], v[160:175]
    v_xor_b32 v13, 64, v12
    ds_write_b128 v13, v[136:139] offset:51200
    v_mfma_f32_32x32x16_bf16 v[176:191], v[52:55], v[216:219], v[176:191]
    v_xor_b32 v14, 96, v12
    ds_write_b128 v14, v[140:143] offset:52224
    s_waitcnt vmcnt(8)
    v_mfma_f32_32x32x16_bf16 v[160:175], v[56:59], v[220:223], v[160:175]
    v_xor_b32 v13, 128, v12
    ds_write_b128 v13, v[144:147] offset:53248
    v_mfma_f32_32x32x16_bf16 v[176:191], v[60:63], v[220:223], v[176:191]
    v_xor_b32 v14, 160, v12
    ds_write_b128 v14, v[148:151] offset:54272
    s_waitcnt vmcnt(7)
    v_mfma_f32_32x32x16_bf16 v[160:175], v[64:67], v[224:227], v[160:175]
    v_xor_b32 v13, 192, v12
    ds_write_b128 v13, v[152:155] offset:55296
    v_mfma_f32_32x32x16_bf16 v[176:191], v[68:71], v[224:227], v[176:191]
    v_xor_b32 v14, 224, v12
    ds_write_b128 v14, v[156:159] offset:56320
    s_waitcnt vmcnt(6)
    v_mfma_f32_32x32x16_bf16 v[160:175], v[72:75], v[228:231], v[160:175]
    v_mfma_f32_32x32x16_bf16 v[176:191], v[76:79], v[228:231], v[176:191]
    s_waitcnt vmcnt(5)
    v_mfma_f32_32x32x16_bf16 v[160:175], v[80:83], v[232:235], v[160:175]
    v_mfma_f32_32x32x16_bf16 v[176:191], v[84:87], v[232:235], v[176:191]
    s_waitcnt vmcnt(4)
    v_mfma_f32_32x32x16_bf16 v[160:175], v[88:91], v[236:239], v[160:175]
    v_mfma_f32_32x32x16_bf16 v[176:191], v[92:95], v[236:239], v[176:191]
    s_waitcnt vmcnt(3)
    v_mfma_f32_32x32x16_bf16 v[160:175], v[96:99], v[192:195], v[160:175]
    v_mfma_f32_32x32x16_bf16 v[176:191], v[100:103], v[192:195], v[176:191]
    s_waitcnt vmcnt(2)
    v_mfma_f32_32x32x16_bf16 v[160:175], v[104:107], v[196:199], v[160:175]
    v_mfma_f32_32x32x16_bf16 v[176:191], v[108:111], v[196:199], v[176:191]
    s_waitcnt vmcnt(1)
    v_mfma_f32_32x32x16_bf16 v[160:175], v[112:115], v[200:203], v[160:175]
    v_mfma_f32_32x32x16_bf16 v[176:191], v[116:119], v[200:203], v[176:191]
    v_mov_b32 v242, 160768
    s_mov_b32 s47, 0x8000
L25_sp:
    ds_read_b32 v243, v242 offset:28
    s_waitcnt lgkmcnt(0)
    v_readfirstlane_b32 s48, v243
    s_nop 0
    s_cmp_ge_u32 s48, 8
    s_cbranch_scc1 L26_ok
    s_sleep 1
    s_sub_u32 s47, s47, 1
    s_cbranch_scc0 L25_sp
L26_ok:
    s_mov_b32 s47, 0x8000
L27_sp:
    ds_read_b32 v243, v242 offset:44
    s_waitcnt lgkmcnt(0)
    v_readfirstlane_b32 s48, v243
    s_nop 0
    s_cmp_ge_u32 s48, 4
    s_cbranch_scc1 L28_ok
    s_sleep 1
    s_sub_u32 s47, s47, 1
    s_cbranch_scc0 L27_sp
L28_ok:
    s_waitcnt vmcnt(0)
    v_mfma_f32_32x32x16_bf16 v[160:175], v[120:123], v[204:207], v[160:175]
    v_mfma_f32_32x32x16_bf16 v[176:191], v[124:127], v[204:207], v[176:191]
    v_xor_b32 v13, 0, v12
    s_nop 9
    ds_write_b128 v13, v[160:163] offset:0
    v_xor_b32 v14, 32, v12
    ds_write_b128 v14, v[164:167] offset:1024
    v_xor_b32 v13, 64, v12
    ds_write_b128 v13, v[168:171] offset:2048
    v_xor_b32 v14, 96, v12
    ds_write_b128 v14, v[172:175] offset:3072
    v_xor_b32 v13, 128, v12
    ds_write_b128 v13, v[176:179] offset:4096
    v_xor_b32 v14, 160, v12
    ds_write_b128 v14, v[180:183] offset:5120
    v_xor_b32 v13, 192, v12
    ds_write_b128 v13, v[184:187] offset:6144
    v_xor_b32 v14, 224, v12
    ds_write_b128 v14, v[188:191] offset:7168
    s_waitcnt lgkmcnt(0)
    v_and_b32 v12, 7, v1
    v_lshrrev_b32 v13, 3, v1
    s_lshl_b32 s44, s30, 3
    v_add_u32 v13, s44, v13
    v_lshlrev_b32 v14, 1, v12
    v_xor_b32 v14, v14, v13
    v_lshlrev_b32 v14, 4, v14
    v_lshl_add_u32 v14, v12, 10, v14
    v_add_u32 v15, 0x10000, v14
    s_lshl_b32 s44, s33, 7
    s_lshl_b32 s48, s35, 4
    s_add_u32 s44, s44, s48
    s_mul_i32 s48, s30, 24
    s_add_u32 s44, s44, s48
    v_add_u32 v13, s44, v13
    v_mul_u32_u24 v13, 896, v13
    v_lshl_add_u32 v13, v12, 4, v13
    v_add_u32 v12, 114688, v14
    s_lshl_b32 s44, s34, 7
    s_add_u32 s48, s44, 7168
    s_barrier
    ds_read_b128 v[112:115], v12 offset:0
    ds_read_b128 v[116:119], v12 offset:512
    ds_read_b128 v[120:123], v12 offset:8192
    ds_read_b128 v[124:127], v12 offset:8704
    ds_read_b128 v[128:131], v12 offset:16384
    ds_read_b128 v[132:135], v12 offset:16896
    ds_read_b128 v[136:139], v12 offset:24576
    ds_read_b128 v[140:143], v12 offset:25088
    s_waitcnt lgkmcnt(6)
    s_waitcnt lgkmcnt(4)
    v_pk_add_f32 v[112:113], v[112:113], v[120:121]
    v_pk_add_f32 v[114:115], v[114:115], v[122:123]
    v_pk_add_f32 v[116:117], v[116:117], v[124:125]
    v_pk_add_f32 v[118:119], v[118:119], v[126:127]
    s_waitcnt lgkmcnt(2)
    v_pk_add_f32 v[112:113], v[112:113], v[128:129]
    v_pk_add_f32 v[114:115], v[114:115], v[130:131]
    v_pk_add_f32 v[116:117], v[116:117], v[132:133]
    v_pk_add_f32 v[118:119], v[118:119], v[134:135]
    s_waitcnt lgkmcnt(0)
    v_pk_add_f32 v[112:113], v[112:113], v[136:137]
    v_pk_add_f32 v[114:115], v[114:115], v[138:139]
    v_pk_add_f32 v[116:117], v[116:117], v[140:141]
    v_pk_add_f32 v[118:119], v[118:119], v[142:143]
    ds_read_b128 v[48:51], v14 offset:0
    ds_read_b128 v[52:55], v14 offset:512
    ds_read_b128 v[56:59], v14 offset:16384
    ds_read_b128 v[60:63], v14 offset:16896
    ds_read_b128 v[64:67], v14 offset:32768
    ds_read_b128 v[68:71], v14 offset:33280
    ds_read_b128 v[72:75], v14 offset:49152
    ds_read_b128 v[76:79], v14 offset:49664
    s_waitcnt lgkmcnt(6)
    v_pk_add_f32 v[112:113], v[112:113], v[48:49]
    v_pk_add_f32 v[114:115], v[114:115], v[50:51]
    v_pk_add_f32 v[116:117], v[116:117], v[52:53]
    v_pk_add_f32 v[118:119], v[118:119], v[54:55]
    s_waitcnt lgkmcnt(4)
    v_pk_add_f32 v[112:113], v[112:113], v[56:57]
    v_pk_add_f32 v[114:115], v[114:115], v[58:59]
    v_pk_add_f32 v[116:117], v[116:117], v[60:61]
    v_pk_add_f32 v[118:119], v[118:119], v[62:63]
    s_waitcnt lgkmcnt(2)
    v_pk_add_f32 v[112:113], v[112:113], v[64:65]
    v_pk_add_f32 v[114:115], v[114:115], v[66:67]
    v_pk_add_f32 v[116:117], v[116:117], v[68:69]
    v_pk_add_f32 v[118:119], v[118:119], v[70:71]
    s_waitcnt lgkmcnt(0)
    v_pk_add_f32 v[112:113], v[112:113], v[72:73]
    v_pk_add_f32 v[114:115], v[114:115], v[74:75]
    v_pk_add_f32 v[116:117], v[116:117], v[76:77]
    v_pk_add_f32 v[118:119], v[118:119], v[78:79]
    v_cvt_pk_bf16_f32 v4, v112, v113
    v_cvt_pk_bf16_f32 v5, v114, v115
    v_cvt_pk_bf16_f32 v6, v116, v117
    v_cvt_pk_bf16_f32 v7, v118, v119
    buffer_store_dwordx4 v[4:7], v13, s[20:23], s44 offen
    ds_read_b128 v[80:83], v15 offset:0
    ds_read_b128 v[84:87], v15 offset:512
    ds_read_b128 v[88:91], v15 offset:8192
    ds_read_b128 v[92:95], v15 offset:8704
    ds_read_b128 v[96:99], v15 offset:16384
    ds_read_b128 v[100:103], v15 offset:16896
    ds_read_b128 v[104:107], v15 offset:24576
    ds_read_b128 v[108:111], v15 offset:25088
    s_waitcnt lgkmcnt(6)
    s_waitcnt lgkmcnt(4)
    v_pk_add_f32 v[80:81], v[80:81], v[88:89]
    v_pk_add_f32 v[82:83], v[82:83], v[90:91]
    v_pk_add_f32 v[84:85], v[84:85], v[92:93]
    v_pk_add_f32 v[86:87], v[86:87], v[94:95]
    s_waitcnt lgkmcnt(2)
    v_pk_add_f32 v[80:81], v[80:81], v[96:97]
    v_pk_add_f32 v[82:83], v[82:83], v[98:99]
    v_pk_add_f32 v[84:85], v[84:85], v[100:101]
    v_pk_add_f32 v[86:87], v[86:87], v[102:103]
    s_waitcnt lgkmcnt(0)
    v_pk_add_f32 v[80:81], v[80:81], v[104:105]
    v_pk_add_f32 v[82:83], v[82:83], v[106:107]
    v_pk_add_f32 v[84:85], v[84:85], v[108:109]
    v_pk_add_f32 v[86:87], v[86:87], v[110:111]
    s_setprio 3
    s_barrier
    ds_read_b128 v[16:19], v14 offset:8192
    ds_read_b128 v[20:23], v14 offset:8704
    ds_read_b128 v[24:27], v14 offset:24576
    ds_read_b128 v[28:31], v14 offset:25088
    ds_read_b128 v[32:35], v14 offset:40960
    ds_read_b128 v[36:39], v14 offset:41472
    ds_read_b128 v[40:43], v14 offset:57344
    ds_read_b128 v[44:47], v14 offset:57856
    s_waitcnt lgkmcnt(6)
    v_pk_add_f32 v[80:81], v[80:81], v[16:17]
    v_pk_add_f32 v[82:83], v[82:83], v[18:19]
    v_pk_add_f32 v[84:85], v[84:85], v[20:21]
    v_pk_add_f32 v[86:87], v[86:87], v[22:23]
    s_waitcnt lgkmcnt(4)
    v_pk_add_f32 v[80:81], v[80:81], v[24:25]
    v_pk_add_f32 v[82:83], v[82:83], v[26:27]
    v_pk_add_f32 v[84:85], v[84:85], v[28:29]
    v_pk_add_f32 v[86:87], v[86:87], v[30:31]
    s_waitcnt lgkmcnt(2)
    v_pk_add_f32 v[80:81], v[80:81], v[32:33]
    v_pk_add_f32 v[82:83], v[82:83], v[34:35]
    v_pk_add_f32 v[84:85], v[84:85], v[36:37]
    v_pk_add_f32 v[86:87], v[86:87], v[38:39]
    s_waitcnt lgkmcnt(0)
    v_pk_add_f32 v[80:81], v[80:81], v[40:41]
    v_pk_add_f32 v[82:83], v[82:83], v[42:43]
    v_pk_add_f32 v[84:85], v[84:85], v[44:45]
    v_pk_add_f32 v[86:87], v[86:87], v[46:47]
    v_cvt_pk_bf16_f32 v8, v80, v81
    v_cvt_pk_bf16_f32 v9, v82, v83
    v_cvt_pk_bf16_f32 v10, v84, v85
    v_cvt_pk_bf16_f32 v11, v86, v87
    buffer_store_dwordx4 v[8:11], v13, s[20:23], s48 offen
    s_endpgm
k_statX:
    s_lshr_b32 s44, s31, 3
    s_and_b32 s45, s31, 1
    s_lshl_b32 s45, s45, 3
    s_bfe_u32 s48, s31, 0x10001
    s_bfe_u32 s49, s31, 0x10002
    s_lshl_b32 s50, s48, 1
    s_add_u32 s50, s50, s49
    s_lshl_b32 s46, s44, 4
    s_add_u32 s46, s46, s45
    s_add_u32 s46, s46, s30
    s_lshl_b32 s46, s46, 2
    s_add_u32 s46, s46, s50
    s_mul_i32 s46, s46, 7168
    s_waitcnt lgkmcnt(0)
    buffer_load_dwordx4 v[128:131], v3, s[12:15], s46 offen offset:0 nt
    buffer_load_dwordx4 v[132:135], v3, s[12:15], s46 offen offset:128 nt
    buffer_load_dwordx4 v[136:139], v3, s[12:15], s46 offen offset:256 nt
    buffer_load_dwordx4 v[140:143], v3, s[12:15], s46 offen offset:384 nt
    buffer_load_dwordx4 v[144:147], v3, s[12:15], s46 offen offset:512 nt
    buffer_load_dwordx4 v[148:151], v3, s[12:15], s46 offen offset:640 nt
    buffer_load_dwordx4 v[152:155], v3, s[12:15], s46 offen offset:768 nt
    s_barrier
    s_bfe_u32 s48, s31, 0x20001
    s_lshl_b32 s48, s48, 4
    s_add_u32 s45, s45, s48
    s_lshl_b32 s45, s45, 4
    s_lshl_b32 s44, s44, 11
    s_add_u32 s45, s45, s44
    s_add_u32 s45, s45, 20971520
    s_lshl_b32 s48, s30, 4
    s_add_u32 s48, s48, 29504
    v_lshrrev_b32 v164, 5, v1
    v_lshl_add_u32 v164, v164, 7, s48
    v_bfe_u32 v165, v1, 3, 2
    v_lshl_add_u32 v164, v165, 2, v164
    s_mov_b32 s49, 0x3f803f80
    v_mov_b32 v160, 0
    v_mov_b32 v161, 0
    v_mov_b32 v162, 0
    v_mov_b32 v163, 0
    s_cmp_lg_u32 s30, 0
    s_cbranch_scc1 k_sx1
    s_waitcnt vmcnt(4)
    buffer_load_dwordx2 v[170:171], v250, s[96:99], 0 offen offset:200 sc1
k_sx1:
    s_waitcnt vmcnt(6)
    v_dot2c_f32_bf16 v160, s49, v128
    v_dot2c_f32_bf16 v162, v128, v128
    v_dot2c_f32_bf16 v161, s49, v129
    v_dot2c_f32_bf16 v163, v129, v129
    v_dot2c_f32_bf16 v160, s49, v130
    v_dot2c_f32_bf16 v162, v130, v130
    v_dot2c_f32_bf16 v161, s49, v131
    v_dot2c_f32_bf16 v163, v131, v131
    s_waitcnt vmcnt(5)
    v_dot2c_f32_bf16 v160, s49, v132
    v_dot2c_f32_bf16 v162, v132, v132
    v_dot2c_f32_bf16 v161, s49, v133
    v_dot2c_f32_bf16 v163, v133, v133
    v_dot2c_f32_bf16 v160, s49, v134
    v_dot2c_f32_bf16 v162, v134, v134
    v_dot2c_f32_bf16 v161, s49, v135
    v_dot2c_f32_bf16 v163, v135, v135
    s_waitcnt vmcnt(4)
    v_dot2c_f32_bf16 v160, s49, v136
    v_dot2c_f32_bf16 v162, v136, v136
    v_dot2c_f32_bf16 v161, s49, v137
    v_dot2c_f32_bf16 v163, v137, v137
    v_dot2c_f32_bf16 v160, s49, v138
    v_dot2c_f32_bf16 v162, v138, v138
    v_dot2c_f32_bf16 v161, s49, v139
    v_dot2c_f32_bf16 v163, v139, v139
    s_waitcnt vmcnt(3)
    v_dot2c_f32_bf16 v160, s49, v140
    v_dot2c_f32_bf16 v162, v140, v140
    v_dot2c_f32_bf16 v161, s49, v141
    v_dot2c_f32_bf16 v163, v141, v141
    v_dot2c_f32_bf16 v160, s49, v142
    v_dot2c_f32_bf16 v162, v142, v142
    v_dot2c_f32_bf16 v161, s49, v143
    v_dot2c_f32_bf16 v163, v143, v143
    s_waitcnt vmcnt(2)
    v_dot2c_f32_bf16 v160, s49, v144
    v_dot2c_f32_bf16 v162, v144, v144
    v_dot2c_f32_bf16 v161, s49, v145
    v_dot2c_f32_bf16 v163, v145, v145
    v_dot2c_f32_bf16 v160, s49, v146
    v_dot2c_f32_bf16 v162, v146, v146
    v_dot2c_f32_bf16 v161, s49, v147
    v_dot2c_f32_bf16 v163, v147, v147
    s_waitcnt vmcnt(1)
    v_dot2c_f32_bf16 v160, s49, v148
    v_dot2c_f32_bf16 v162, v148, v148
    v_dot2c_f32_bf16 v161, s49, v149
    v_dot2c_f32_bf16 v163, v149, v149
    v_dot2c_f32_bf16 v160, s49, v150
    v_dot2c_f32_bf16 v162, v150, v150
    v_dot2c_f32_bf16 v161, s49, v151
    v_dot2c_f32_bf16 v163, v151, v151
    s_waitcnt vmcnt(0)
    v_dot2c_f32_bf16 v160, s49, v152
    v_dot2c_f32_bf16 v162, v152, v152
    v_dot2c_f32_bf16 v161, s49, v153
    v_dot2c_f32_bf16 v163, v153, v153
    v_dot2c_f32_bf16 v160, s49, v154
    v_dot2c_f32_bf16 v162, v154, v154
    v_dot2c_f32_bf16 v161, s49, v155
    v_dot2c_f32_bf16 v163, v155, v155
    s_nop 1
    v_add_f32 v160, v160, v161
    v_add_f32 v162, v162, v163
    s_nop 0
    v_add_f32_dpp v160, v160, v160 quad_perm:[1,0,3,2] row_mask:0xf bank_mask:0xf
    v_add_f32_dpp v162, v162, v162 quad_perm:[1,0,3,2] row_mask:0xf bank_mask:0xf
    s_nop 0
    v_add_f32_dpp v160, v160, v160 quad_perm:[2,3,0,1] row_mask:0xf bank_mask:0xf
    v_add_f32_dpp v162, v162, v162 quad_perm:[2,3,0,1] row_mask:0xf bank_mask:0xf
    s_nop 0
    v_add_f32_dpp v160, v160, v160 row_half_mirror row_mask:0xf bank_mask:0xf
    v_add_f32_dpp v162, v162, v162 row_half_mirror row_mask:0xf bank_mask:0xf
    v_mul_f32 v163, 0x3b124925, v160
    v_mul_f32 v160, 0x3b124925, v162
    v_fma_f32 v160, -v163, v163, v160
    v_max_f32 v160, 0, v160
    v_cvt_pk_bf16_f32 v160, v160, v160
    v_lshlrev_b32 v160, 16, v160
    v_add_f32 v160, 0x3727c5ac, v160
    v_cvt_pk_bf16_f32 v160, v160, v160
    v_lshlrev_b32 v160, 16, v160
    v_sqrt_f32 v160, v160
    s_mov_b32 exec_lo, 0x01010101
    s_mov_b32 exec_hi, 0x01010101
    v_cvt_pk_bf16_f32 v160, v163, v160
    ds_write_b32 v164, v160
    s_mov_b64 exec, 1
    ds_add_u32 v31, v15 offset:48
    s_mov_b64 exec, -1
    s_cmp_lg_u32 s30, 0
    s_cbranch_scc1 k_so3
    v_and_b32 v172, 15, v1
    v_lshlrev_b32 v172, 4, v172
    v_lshrrev_b32 v173, 4, v1
    v_lshlrev_b32 v174, 13, v173
    v_lshlrev_b32 v173, 3, v173
    v_and_b32 v175, 7, v1
    v_lshl_add_u32 v174, v175, 4, v174
    v_and_b32 v175, 8, v1
    v_lshl_add_u32 v174, v175, 7, v174
    s_add_u32 s46, s45, 32768
    s_mov_b64 s[52:53], 0
    s_mov_b32 s54, 0
    s_mov_b32 s55, 0xffff0000
    s_mov_b32 s47, 0x8000
L29_sp:
    ds_read_b32 v14, v31 offset:48
    s_waitcnt lgkmcnt(0)
    v_readfirstlane_b32 s48, v14
    s_nop 0
    s_cmp_ge_u32 s48, 8
    s_cbranch_scc1 L30_ok
    s_sleep 0
    s_sub_u32 s47, s47, 1
    s_cbranch_scc0 L29_sp
L30_ok:
    ds_read_b128 v[176:179], v172 offset:29504
    s_mov_b32 s47, 4096
k_so:
    s_waitcnt vmcnt(0) lgkmcnt(0)
    v_bfe_u32 v170, v170, v173, 1
    v_bfe_u32 v171, v171, v173, 1
    v_cmp_ne_u32 s[50:51], 0, v170
    v_cmp_ne_u32 s[56:57], 0, v171
    s_andn2_b64 exec, s[50:51], s[52:53]
    s_cbranch_scc0 k_so1
    buffer_store_dwordx4 v[176:179], v174, s[16:19], s45 offen sc1
k_so1:
    s_andn2_b64 exec, s[56:57], s[54:55]
    s_cbranch_scc0 k_so2
    buffer_store_dwordx4 v[176:179], v174, s[16:19], s46 offen sc1
k_so2:
    s_mov_b64 exec, -1
    s_or_b64 s[52:53], s[52:53], s[50:51]
    s_or_b64 s[54:55], s[54:55], s[56:57]
    s_and_b64 s[50:51], s[52:53], s[54:55]
    s_not_b64 s[50:51], s[50:51]
    s_cbranch_scc0 k_so3
    s_sleep 4
    buffer_load_dwordx2 v[170:171], v250, s[96:99], 0 offen offset:200 sc1
    s_sub_u32 s47, s47, 1
    s_cbranch_scc0 k_so
k_so3:
    s_mov_b64 exec, 1
    ds_add_u32 v31, v15 offset:24
    s_mov_b64 exec, -1
    s_setprio 0
    s_cmp_lt_u32 s2, 224
    s_cbranch_scc1 k_xw
    s_sleep 100
    v_mov_b32 v251, 0
    s_branch k_s2
k_w31:
    s_mov_b32 s47, 0x8000
L31_sp:
    ds_read_b32 v14, v31 offset:0
    s_waitcnt lgkmcnt(0)
    v_readfirstlane_b32 s48, v14
    s_nop 0
    s_cmp_ge_u32 s48, 4
    s_cbranch_scc1 L32_ok
    s_sleep 1
    s_sub_u32 s47, s47, 1
    s_cbranch_scc0 L31_sp
L32_ok:
    s_branch k_w31r
k_fl31:
    ds_add_rtn_u32 v14, v31, v15 offset:48
    s_waitcnt lgkmcnt(0)
    v_readfirstlane_b32 s48, v14
    s_nop 0
    s_cmp_lg_u32 s48, 3
    s_cbranch_scc1 k_fl31r
    buffer_store_byte v247, v250, s[96:99], 0 offen offset:124
    s_branch k_fl31r
k_plr:
    s_sub_u32 s47, s47, 1
    s_cbranch_scc1 k_plok
    s_cmp_gt_u32 s47, 16360
    s_cbranch_scc1 k_pls
    s_cmp_lg_u32 s47, 16360
    s_cbranch_scc1 k_plf
    s_mov_b64 exec, -1
    s_xor_b32 s51, s51, 33554432
    buffer_store_dwordx4 v[224:227], v11, s[16:19], s51 offen sc1
    s_xor_b32 s53, s53, 33554432
    buffer_store_dwordx4 v[232:235], v11, s[16:19], s53 offen sc1
    s_xor_b32 s52, s52, 33554432
    buffer_store_dwordx4 v[228:231], v11, s[16:19], s52 offen sc1
    s_xor_b32 s54, s54, 33554432
    buffer_store_dwordx4 v[236:239], v11, s[16:19], s54 offen sc1
    s_lshl_b32 s48, s35, 2
    s_add_u32 s49, s48, 128
    v_writelane_b32 v249, s49, 32
    s_mov_b64 exec, 1
    s_waitcnt vmcnt(0)
    buffer_atomic_add v15, v250, s[96:99], s48 offen offset:128 sc1
    s_mov_b32 exec_lo, -1
    s_mov_b32 exec_hi, 1
    s_branch k_pl
k_plf:
    v_readlane_b32 s48, v251, 32
    s_sleep 8
    s_cmp_lt_u32 s48, 128
    s_cbranch_scc1 k_pl
    s_xor_b32 s55, s55, 33554432
    s_xor_b32 s56, s56, 33554432
    s_branch k_plok
k_pls:
    s_sleep 1
    s_branch k_pl
k_sf:
    s_mov_b32 s47, 0x2000
k_sf1:
    s_sub_u32 s47, s47, 1
    s_cbranch_scc1 k_sfr
    s_sleep 2
    s_cmp_lt_u32 s47, 8180
    s_cbranch_scc1 k_sf2
    ds_read_b128 v[216:219], v248 offset:0
    ds_read_b128 v[220:223], v248 offset:4096
    ds_read_b128 v[224:227], v248 offset:1024
    ds_read_b128 v[228:231], v248 offset:5120
    s_waitcnt lgkmcnt(0)
k_sf3:
    v_max3_u32 v144, v216, v217, v218
    v_max3_u32 v145, v219, v220, v221
    v_max3_u32 v144, v144, v222, v223
    v_max3_u32 v145, v145, v224, v225
    v_max3_u32 v144, v144, v226, v227
    v_max3_u32 v145, v145, v228, v229
    v_max3_u32 v144, v144, v230, v231
    v_max_u32 v144, v144, v145
    v_cmp_eq_u32 vcc, -1, v144
    s_nop 1
    s_cbranch_vccnz k_sf1
    s_branch k_sfr
k_sf2:
    s_sleep 4
    buffer_load_dwordx4 v[216:219], v30, s[16:19], s46 offen offset:0 sc1
    buffer_load_dwordx4 v[220:223], v30, s[16:19], s46 offen offset:1024 sc1
    buffer_load_dwordx4 v[224:227], v30, s[16:19], s46 offen offset:2048 sc1
    buffer_load_dwordx4 v[228:231], v30, s[16:19], s46 offen offset:3072 sc1
    s_waitcnt vmcnt(0)
    s_branch k_sf3
k_s2f:
    s_mov_b64 exec, 1
    buffer_load_dword v251, v250, s[96:99], 0 offen offset:124 sc1
    s_mov_b64 exec, -1
    s_branch k_s2fr
k_cso:
    s_mov_b32 s47, 0x8000
L33_sp:
    ds_read_b32 v14, v210 offset:0
    s_waitcnt lgkmcnt(0)
    v_readfirstlane_b32 s48, v14
    s_nop 0
    s_cmp_ge_u32 s48, 1
    s_cbranch_scc1 L34_ok
    s_sleep 4
    s_sub_u32 s47, s47, 1
    s_cbranch_scc0 L33_sp
L34_ok:
    v_lshrrev_b32 v12, 2, v2
    s_nop 7
    s_mov_b32 exec_hi, 0
    buffer_store_dword v252, v12, s[16:19], s10 offen sc1
    s_mov_b32 exec_hi, -1
    s_nop 1
    s_branch k_csr
k_can:
    s_mov_b32 s47, 0x8000
L35_sp:
    ds_read_b32 v14, v210 offset:0
    s_waitcnt lgkmcnt(0)
    v_readfirstlane_b32 s48, v14
    s_nop 0
    s_cmp_ge_u32 s48, 1
    s_cbranch_scc1 L36_ok
    s_sleep 4
    s_sub_u32 s47, s47, 1
    s_cbranch_scc0 L35_sp
L36_ok:
    s_mov_b32 s47, 0x4000
    v_mov_b32 v15, 0
    s_mov_b64 exec, 1
k_can1:
    buffer_load_dword v14, v15, s[16:19], s52 offen sc1
    s_waitcnt vmcnt(0)
    v_readfirstlane_b32 s48, v14
    s_nop 0
    s_cmp_lg_u32 s48, -1
    s_cbranch_scc1 k_can2
    s_sleep 4
    s_sub_u32 s47, s47, 1
    s_cbranch_scc0 k_can1
k_can2:
    v_mov_b32 v15, 4
    ds_add_u32 v210, v15 offset:32
    s_mov_b64 exec, -1
    s_branch k_canr
L15_str:
    s_cmp_eq_u32 s47, 0
    s_cbranch_scc1 L16_stok
    s_sub_u32 s47, s47, 1
    ds_read_b128 v[248:251], v13
    s_waitcnt lgkmcnt(0)
    s_branch L15_st
L21_poll:
    s_mov_b32 s47, 40
L37_rt:
    s_sleep 2
    s_buffer_load_dword s58, s[16:19], s41 glc
    s_waitcnt lgkmcnt(0)
    s_cmp_ge_u32 s58, 3584
    s_cbranch_scc1 L22_pok
    s_sub_u32 s47, s47, 1
    s_cbranch_scc0 L37_rt
    s_mov_b32 s47, 0x4000
L37_rtv:
    buffer_load_dword v14, off, s[16:19], s41 sc1
    s_waitcnt vmcnt(0)
    v_readfirstlane_b32 s58, v14
    s_nop 0
    s_cmp_ge_u32 s58, 3584
    s_cbranch_scc1 L22_pok
    s_sleep 8
    s_sub_u32 s47, s47, 1
    s_cbranch_scc0 L37_rtv
    s_branch L22_pok
L23_poll:
    s_mov_b32 s47, 40
L38_rt:
    s_sleep 2
    s_buffer_load_dword s58, s[16:19], s41 glc
    s_waitcnt lgkmcnt(0)
    s_cmp_ge_u32 s58, 3598
    s_cbranch_scc1 L24_pok
    s_sub_u32 s47, s47, 1
    s_cbranch_scc0 L38_rt
    s_mov_b32 s47, 0x4000
L38_rtv:
    buffer_load_dword v13, off, s[16:19], s41 sc1
    s_waitcnt vmcnt(0)
    v_readfirstlane_b32 s58, v13
    s_nop 0
    s_cmp_ge_u32 s58, 3598
    s_cbranch_scc1 L24_pok
    s_sleep 8
    s_sub_u32 s47, s47, 1
    s_cbranch_scc0 L38_rtv
    s_branch L24_pok
k_roleY:
    s_load_dwordx2 s[8:9], s[0:1], 32
    s_mov_b32 s10, 1835008
    s_mov_b32 s11, 0x00020000
    s_load_dwordx2 s[20:21], s[0:1], 0
    s_mov_b32 s22, 1835008
    s_mov_b32 s23, 0x00020000
    s_load_dwordx2 s[24:25], s[0:1], 88
    s_mov_b32 s26, 256
    s_mov_b32 s27, 0x00020000
    s_lshr_b32 s48, s30, 1
    s_lshl_b32 s48, s48, 3
    s_add_u32 s48, s48, 40
    s_cmp_ge_u32 s2, 224
    s_cselect_b32 s48, 72, s48
    s_load_dwordx2 s[12:13], s[0:1], s48
    s_mov_b32 s14, 1605632
    s_mov_b32 s15, 0x00020000
    s_sub_u32 s37, s30, 4
    v_mov_b32 v13, 160768
    v_mov_b32 v14, 0
    v_mov_b32 v15, 0
    v_mov_b32 v246, 0
    v_lshlrev_b32 v2, 4, v1
    s_lshl_b32 s48, s37, 9
    v_lshl_add_u32 v4, v1, 3, s48
    v_add_u32 v4, v4, v13
    ds_write_b64 v4, v[14:15]
    s_lshr_b32 s32, s37, 1
    s_and_b32 s33, s37, 1
    s_cmp_eq_u32 s37, 0
    s_cselect_b32 s56, 0, 1
    s_lshl_b32 s62, s37, 8
    s_sub_u32 s62, s2, s62
    v_lshlrev_b32 v247, 2, v1
    s_mov_b32 s29, s35
    s_cmp_eq_u32 s35, 7
    s_cbranch_scc1 k_statY
    s_lshl_b32 s36, s35, 5
    s_add_u32 s36, s36, s31
    s_lshl_b32 s34, s36, 1
    s_add_u32 s34, s34, s32
    s_lshl_b32 s59, s34, 12
    s_lshl_b32 s48, s33, 11
    s_add_u32 s59, s59, s48
    s_mul_i32 s46, s32, 8320
    s_add_u32 s48, s48, s46
    s_add_u32 s48, s48, 64
    v_add_u32 v235, s48, v2
    s_sub_u32 s48, s59, 4
    s_cmp_eq_u32 s33, 0
    s_cselect_b32 s48, 1835008, s48
    v_mov_b32 v9, s48
    s_mul_i32 s46, s37, 4160
    s_mul_i32 s42, s32, 6432
    s_mul_i32 s48, s33, 640
    s_add_u32 s48, s48, s42
    s_add_u32 s48, s48, 21760
    v_lshl_add_u32 v7, v1, 3, s48
    ds_write_b64 v7, v[14:15]
    ds_write_b64 v7, v[14:15] offset:128
    v_and_b32 v7, 15, v1
    v_lshl_add_u32 v234, v7, 2, s46
    ds_write_b32 v234, v14
    s_mul_i32 s40, s36, 8320
    s_lshl_b32 s48, s37, 11
    s_add_u32 s40, s40, s48
    s_add_u32 s40, s40, 16777216
    s_add_u32 s41, s40, 2097152
    v_lshlrev_b32 v10, 7, v1
    s_lshl_b32 s39, s35, 2
    s_add_u32 s39, s39, s37
    s_lshl_b32 s39, s39, 11
    s_add_u32 s39, s39, 20971520
    s_waitcnt lgkmcnt(0)
    s_cmp_ge_u32 s2, 248
    s_cbranch_scc1 k_lp
k_lpr:
    buffer_load_dwordx4 v[16:19], v2, s[8:11], s59 offen nt
    buffer_load_dwordx4 v[20:23], v2, s[8:11], s59 offen offset:1024 nt
    s_mov_b64 exec, 1
    buffer_load_dword v24, v9, s[8:11], 0 offen
    s_mov_b64 exec, -1
    s_barrier
    s_mov_b64 exec, 0xffff
    buffer_load_dword v230, v10, s[16:19], s40 offen nt
    s_mov_b64 exec, -1
    s_cmp_ge_u32 s2, 248
    s_cbranch_scc1 k_le
k_ler:
k_yj:
    v_mov_b32 v15, 1
    s_lshl_b32 s38, s37, 10
    s_add_u32 s38, s38, 103424
    v_add_u32 v233, s38, v2
    s_cmp_eq_u32 s29, 7
    s_cselect_b32 s28, 1, 0
    s_cmp_ge_u32 s2, 224
    s_cbranch_scc1 k_ys2
    s_lshl_b32 s51, s37, 10
    s_add_u32 s51, s51, 46080
    v_lshrrev_b32 v7, 3, v1
    v_and_b32 v6, 7, v1
    v_bfe_u32 v8, v1, 4, 1
    v_lshlrev_b32 v8, 1, v8
    v_xor_b32 v6, v6, v8
    s_lshl_b32 s48, s32, 2
    v_xor_b32 v6, s48, v6
    v_mul_u32_u24 v7, 3584, v7
    v_lshl_add_u32 v6, v6, 4, v7
    s_mul_i32 s50, s33, 28672
    s_and_b32 s31, s2, 7
    s_lshr_b32 s32, s2, 3
    s_mul_i32 s33, s32, 37
    s_lshr_b32 s33, s33, 8
    s_mul_i32 s34, s33, 7
    s_sub_u32 s34, s32, s34
    s_lshr_b32 s44, s31, 1
    s_lshl_b32 s44, s44, 2
    s_and_b32 s35, s31, 1
    s_mul_i32 s48, s35, 7
    s_add_u32 s48, s48, s34
    s_lshl_b32 s48, s48, 8
    s_add_u32 s50, s50, s48
    s_and_b32 s48, s33, 1
    s_lshl_b32 s48, s48, 7
    v_add_u32 v6, s48, v6
    v_xor_b32 v11, 128, v6
    s_add_u32 s48, s33, 0
    s_and_b32 s48, s48, 3
    s_mul_i32 s48, s48, 401408
    s_add_u32 s52, s50, s48
    s_add_u32 s48, s33, 1
    s_and_b32 s48, s48, 3
    s_mul_i32 s48, s48, 401408
    s_add_u32 s53, s50, s48
    s_add_u32 s48, s33, 2
    s_and_b32 s48, s48, 3
    s_mul_i32 s48, s48, 401408
    s_add_u32 s54, s50, s48
    s_add_u32 s48, s33, 3
    s_and_b32 s48, s48, 3
    s_mul_i32 s48, s48, 401408
    s_add_u32 s55, s50, s48
    s_lshr_b32 s48, s44, 2
    s_mul_i32 s48, s48, 2
    s_mul_i32 s92, s48, 57344
    s_sub_u32 s48, s48, s34
    s_cselect_b32 s49, 7, 0
    s_add_u32 s48, s48, s49
    s_lshl_b32 s48, s48, 12
    s_add_u32 s57, s48, s51
    s_add_u32 s49, s51, 28672
    s_add_u32 s93, s92, 57344
    s_cmp_eq_u32 s93, 401408
    s_cselect_b32 s93, 0, s93
    s_add_u32 s58, s57, 4096
    s_cmp_eq_u32 s58, s49
    s_cselect_b32 s58, s51, s58
    s_add_u32 s94, s93, 57344
    s_cmp_eq_u32 s94, 401408
    s_cselect_b32 s94, 0, s94
    s_add_u32 s59, s58, 4096
    s_cmp_eq_u32 s59, s49
    s_cselect_b32 s59, s51, s59
    s_add_u32 s95, s94, 57344
    s_cmp_eq_u32 s95, 401408
    s_cselect_b32 s95, 0, s95
    s_add_u32 s60, s59, 4096
    s_cmp_eq_u32 s60, s49
    s_cselect_b32 s60, s51, s60
    s_add_u32 s96, s95, 57344
    s_cmp_eq_u32 s96, 401408
    s_cselect_b32 s96, 0, s96
    s_add_u32 s61, s60, 4096
    s_cmp_eq_u32 s61, s49
    s_cselect_b32 s61, s51, s61
    s_add_u32 s97, s96, 57344
    s_cmp_eq_u32 s97, 401408
    s_cselect_b32 s97, 0, s97
    s_add_u32 s62, s61, 4096
    s_cmp_eq_u32 s62, s49
    s_cselect_b32 s62, s51, s62
    s_add_u32 s98, s97, 57344
    s_cmp_eq_u32 s98, 401408
    s_cselect_b32 s98, 0, s98
    s_add_u32 s63, s62, 4096
    s_cmp_eq_u32 s63, s49
    s_cselect_b32 s63, s51, s63
    v_bfe_u32 v14, v1, 4, 1
    v_bfe_u32 v5, v1, 3, 1
    v_lshl_or_b32 v5, v14, 1, v5
    v_xor_b32 v5, s37, v5
    v_lshlrev_b32 v7, 11, v14
    v_lshl_add_u32 v7, v5, 5, v7
    v_lshrrev_b32 v14, 5, v1
    v_lshl_add_u32 v7, v14, 10, v7
    v_bfe_u32 v14, v1, 2, 2
    v_lshl_add_u32 v7, v14, 7, v7
    v_and_b32 v14, 1, v1
    v_lshl_add_u32 v7, v14, 4, v7
    v_bfe_u32 v14, v1, 1, 1
    v_lshl_add_u32 v7, v14, 3, v7
    v_add_u32 v7, 46080, v7
    v_add_u32 v8, 57344, v7
    v_mov_b32 v204, v11
    v_add_u32 v205, 68608, v7
    s_waitcnt vmcnt(0)
    s_cmp_eq_u32 s29, 7
    s_cbranch_scc1 L39_ed
    ds_write_b128 v235, v[16:19] offset:4160
    ds_write_b128 v235, v[20:23] offset:5184
    v_readlane_b32 s48, v19, 63
    v_mov_b32_dpp v24, v19 wave_shr:1 row_mask:0xf bank_mask:0xf
    s_nop 0
    v_mov_b32 v25, s48
    v_alignbit_b32 v28, v16, v24, 16
    s_nop 0
    v_mov_b32_dpp v25, v23 wave_shr:1 row_mask:0xf bank_mask:0xf
    v_alignbit_b32 v29, v17, v16, 16
    v_alignbit_b32 v30, v18, v17, 16
    v_alignbit_b32 v31, v19, v18, 16
    ds_write_b128 v235, v[28:31]
    v_alignbit_b32 v32, v20, v25, 16
    v_alignbit_b32 v33, v21, v20, 16
    v_alignbit_b32 v34, v22, v21, 16
    v_alignbit_b32 v35, v23, v22, 16
    ds_write_b128 v235, v[32:35] offset:1024
    s_mov_b64 exec, 1
    ds_add_u32 v13, v15 offset:12
    s_mov_b64 exec, -1
L39_ed:
k_wy0:
    s_mov_b32 s47, 0x8000
L40_sp:
    ds_read_b32 v14, v13 offset:24
    s_waitcnt lgkmcnt(0)
    v_readfirstlane_b32 s48, v14
    s_nop 0
    s_cmp_ge_u32 s48, 4
    s_cbranch_scc1 L41_ok
    s_sleep 1
    s_sub_u32 s47, s47, 1
    s_cbranch_scc0 L40_sp
L41_ok:
    s_waitcnt vmcnt(0)
    s_cmp_lg_u32 s28, 0
    s_cbranch_scc1 L42_sd
    s_mov_b32 m0, s38
    s_nop 0
    buffer_load_dwordx4 v2, s[16:19], s39 offen sc1 lds
    s_add_u32 m0, s38, 3072
    s_nop 0
    buffer_load_dwordx4 v2, s[16:19], s39 offen offset:1024 sc1 lds
L42_sd:
    s_add_u32 s50, s52, s92
    s_add_u32 m0, s57, 86016
    s_nop 0
    buffer_load_dwordx4 v11, s[12:15], s50 offen  lds
    s_add_u32 s50, s52, s92
    s_add_u32 m0, s57, 0
    s_nop 0
    buffer_load_dwordx4 v6, s[12:15], s50 offen  lds
    s_add_u32 s50, s52, s93
    s_add_u32 m0, s58, 86016
    s_nop 0
    buffer_load_dwordx4 v11, s[12:15], s50 offen  lds
    s_add_u32 s50, s52, s93
    s_add_u32 m0, s58, 0
    s_nop 0
    buffer_load_dwordx4 v6, s[12:15], s50 offen  lds
    s_and_b32 s31, s2, 7
    s_lshr_b32 s32, s2, 3
    s_mul_i32 s33, s32, 37
    s_lshr_b32 s33, s33, 8
    s_mul_i32 s34, s33, 7
    s_sub_u32 s34, s32, s34
    s_lshr_b32 s44, s31, 1
    s_lshl_b32 s44, s44, 2
    s_and_b32 s35, s31, 1
    v_lshlrev_b32 v2, 4, v1
    s_and_b32 s9, s33, 1
    s_lshl_b32 s9, s9, 2
    s_xor_b32 s9, s9, s30
    s_add_u32 s33, s33, s44
    s_mul_i32 s36, s35, 7
    s_add_u32 s36, s36, s34
    s_lshl_b32 s36, s36, 3
    s_add_u32 s36, s36, s9
    s_and_b32 s45, s30, 3
    s_lshl_b32 s45, s45, 10
    s_mul_i32 s20, s33, 114688
    s_add_u32 s20, s20, s45
    s_add_u32 s20, s20, 5242880
    v_lshrrev_b32 v12, 4, v1
    v_and_b32 v137, 15, v1
    v_lshlrev_b32 v138, 2, v12
    v_xor_b32 v137, v137, v138
    s_and_b32 s48, s30, 2
    v_xor_b32 v137, s48, v137
    v_lshlrev_b32 v138, 8, v12
    v_lshl_add_u32 v3, v137, 4, v138
    v_bfe_u32 v137, v1, 2, 2
    v_and_b32 v138, 3, v1
    v_lshrrev_b32 v139, 1, v12
    v_xor_b32 v12, v12, v139
    v_and_b32 v12, 1, v12
    v_lshl_add_u32 v139, v139, 3, v137
    v_lshlrev_b32 v139, 8, v139
    v_lshl_add_u32 v139, v137, 6, v139
    v_lshl_add_u32 v139, v12, 5, v139
    v_lshl_add_u32 v4, v138, 3, v139
    v_xor_b32 v5, 64, v4
    v_xor_b32 v140, 128, v4
    v_xor_b32 v7, 192, v4
    v_add_u32 v141, 0x10000, v4
    v_add_u32 v9, 0x10000, v5
    v_add_u32 v10, 0x10000, v140
    v_add_u32 v142, 0x10000, v7
    s_mul_i32 s40, s33, 448
    s_add_u32 s40, s40, s36
    s_lshl_b32 s40, s40, 10
    s_add_u32 s40, s40, 8388608
    s_lshl_b32 s41, s33, 3
    s_add_u32 s41, s41, s9
    s_lshl_b32 s41, s41, 7
    s_add_u32 s41, s41, 27262976
    s_lshl_b32 s42, s34, 3
    s_add_u32 s42, s42, s9
    s_mul_i32 s42, s42, 28672
    s_add_u32 s42, s42, 25165824
    s_lshl_b32 s43, s33, 2
    s_add_u32 s43, s43, s35
    s_mul_i32 s43, s43, 112
    s_add_u32 s43, s43, s9
    s_lshl_b32 s43, s43, 10
    s_add_u32 s43, s43, 8388608
    v_and_b32 v137, 31, v1
    v_lshlrev_b32 v137, 4, v137
    v_add_u32 v137, 161792, v137
    v_mov_b32 v224, 0
    v_mov_b32 v225, 0
    v_mov_b32 v227, 0
    v_mov_b32 v228, 0
    v_mov_b32 v229, 0
    v_mov_b32 v230, 0
    v_mov_b32 v232, 0
    v_mov_b32 v143, 0
    s_mul_i32 s11, s34, 3
    s_lshr_b32 s11, s11, 3
    s_lshl_b32 s11, s11, 1
    s_add_u32 s10, s11, s35
    s_lshl_b32 s10, s10, 2
    s_and_b32 s48, s34, 3
    s_add_u32 s10, s10, s48
    s_lshl_b32 s10, s10, 3
    s_add_u32 s10, s10, s9
    s_lshl_b32 s10, s10, 7
    s_add_u32 s10, s10, 21037056
    v_and_b32 v243, 31, v1
    v_lshlrev_b32 v243, 2, v243
    s_lshl_b32 s11, s33, 9
    s_lshr_b32 s48, s45, 3
    s_add_u32 s11, s11, s48
    s_add_u32 s11, s11, 21069824
    s_lshr_b32 s48, s45, 8
    v_add_u32 v245, s48, v137
    s_add_u32 s48, s33, 1
    s_and_b32 s48, s48, 3
    s_mul_i32 s48, s48, 28672
    s_add_u32 s21, s20, s48
    s_add_u32 s48, s33, 2
    s_and_b32 s48, s48, 3
    s_mul_i32 s48, s48, 28672
    s_add_u32 s22, s20, s48
    s_add_u32 s48, s33, 3
    s_and_b32 s48, s48, 3
    s_mul_i32 s48, s48, 28672
    s_add_u32 s23, s20, s48
    s_add_u32 s48, s33, 0
    s_and_b32 s48, s48, 3
    s_mul_i32 s48, s48, 28672
    s_add_u32 s20, s20, s48
    s_mul_i32 s3, s34, 4096
    s_add_u32 s31, s3, 4096
    s_cmp_eq_u32 s31, 28672
    s_cselect_b32 s31, 0, s31
    s_add_u32 s32, s31, 4096
    s_cmp_eq_u32 s32, 28672
    s_cselect_b32 s32, 0, s32
    s_add_u32 s37, s32, 4096
    s_cmp_eq_u32 s37, 28672
    s_cselect_b32 s37, 0, s37
    s_add_u32 s46, s37, 4096
    s_cmp_eq_u32 s46, 28672
    s_cselect_b32 s46, 0, s46
    s_add_u32 s49, s46, 4096
    s_cmp_eq_u32 s49, 28672
    s_cselect_b32 s49, 0, s49
    s_add_u32 s51, s49, 4096
    s_cmp_eq_u32 s51, 28672
    s_cselect_b32 s51, 0, s51
    s_and_b32 s48, s33, 3
    s_mul_i32 s48, s48, 7
    s_add_u32 s48, s48, 1
    s_lshr_b32 s48, s48, 1
    s_mul_i32 s44, s34, 2
    s_add_u32 s48, s48, s44
    s_sub_u32 s44, s48, 14
    s_cselect_b32 s48, s48, s44
    s_mov_b32 s4, s42
    s_add_u32 s5, s42, 28672
    s_lshl_b32 s44, s48, 11
    s_add_u32 s42, s42, s44
    s_mov_b32 s6, s43
    s_add_u32 s7, s43, 114688
    s_lshl_b32 s44, s48, 13
    s_add_u32 s43, s43, s44
    s_mov_b32 s8, s43
    s_waitcnt vmcnt(4)
    s_cmp_lg_u32 s28, 0
    s_cbranch_scc1 L43_sd
    ds_read_b128 v[128:131], v233
    ds_read_b128 v[132:135], v233 offset:4096
    s_waitcnt lgkmcnt(0)
    v_max3_u32 v128, v128, v129, v130
    v_max3_u32 v131, v131, v132, v133
    v_max3_u32 v128, v128, v134, v135
    v_max_u32 v128, v128, v131
    v_cmp_eq_u32 vcc, -1, v128
    s_mov_b32 s28, 1
    s_nop 0
    s_cbranch_vccz L43_sd
    s_mov_b32 s28, 0
    s_mov_b32 m0, s38
    s_nop 0
    buffer_load_dwordx4 v2, s[16:19], s39 offen sc1 lds
    s_add_u32 m0, s38, 3072
    s_nop 0
    buffer_load_dwordx4 v2, s[16:19], s39 offen offset:1024 sc1 lds
L43_sd:
    s_waitcnt vmcnt(0)
    s_cmp_lg_u32 s28, 0
    s_cbranch_scc1 L44_sd
    ds_read_b128 v[128:131], v233
    ds_read_b128 v[132:135], v233 offset:4096
    s_waitcnt lgkmcnt(0)
    v_max3_u32 v128, v128, v129, v130
    v_max3_u32 v131, v131, v132, v133
    v_max3_u32 v128, v128, v134, v135
    v_max_u32 v128, v128, v131
    v_cmp_eq_u32 vcc, -1, v128
    s_mov_b32 s28, 1
    s_nop 0
    s_cbranch_vccz L44_sd
    s_mov_b32 s28, 0
    s_mov_b32 m0, s38
    s_nop 0
    buffer_load_dwordx4 v2, s[16:19], s39 offen sc1 lds
    s_add_u32 m0, s38, 3072
    s_nop 0
    buffer_load_dwordx4 v2, s[16:19], s39 offen offset:1024 sc1 lds
L44_sd:
    s_add_u32 s50, s52, s94
    s_add_u32 m0, s59, 86016
    s_nop 0
    buffer_load_dwordx4 v11, s[12:15], s50 offen  lds
    s_add_u32 s50, s52, s95
    s_add_u32 m0, s60, 86016
    s_nop 0
    buffer_load_dwordx4 v11, s[12:15], s50 offen  lds
    s_add_u32 s50, s52, s96
    s_add_u32 m0, s61, 86016
    s_nop 0
    buffer_load_dwordx4 v11, s[12:15], s50 offen  lds
    s_add_u32 s50, s52, s97
    s_add_u32 m0, s62, 86016
    s_nop 0
    buffer_load_dwordx4 v11, s[12:15], s50 offen  lds
    s_add_u32 s50, s52, s98
    s_add_u32 m0, s63, 86016
    s_nop 0
    buffer_load_dwordx4 v11, s[12:15], s50 offen  lds
    s_add_u32 s50, s52, s94
    s_add_u32 m0, s59, 0
    s_nop 0
    buffer_load_dwordx4 v6, s[12:15], s50 offen  lds
    s_add_u32 s50, s52, s95
    s_add_u32 m0, s60, 0
    s_nop 0
    buffer_load_dwordx4 v6, s[12:15], s50 offen  lds
    s_add_u32 s50, s52, s96
    s_add_u32 m0, s61, 0
    s_nop 0
    buffer_load_dwordx4 v6, s[12:15], s50 offen  lds
    s_cmp_lg_u32 s56, 0
    s_cbranch_scc1 L45_fi
    s_mov_b64 exec, 1
    buffer_load_dword v242, v246, s[24:27], 0 offen offset:124 sc1
    s_mov_b64 exec, -1
L45_fi:
    s_add_u32 s50, s52, s97
    s_add_u32 m0, s62, 0
    s_nop 0
    buffer_load_dwordx4 v6, s[12:15], s50 offen  lds
    s_add_u32 s50, s52, s98
    s_add_u32 m0, s63, 0
    s_nop 0
    buffer_load_dwordx4 v6, s[12:15], s50 offen  lds
    s_add_u32 s50, s53, s92
    s_add_u32 m0, s57, 28672
    s_nop 0
    buffer_load_dwordx4 v6, s[12:15], s50 offen  lds
    s_waitcnt vmcnt(10)
    s_cmp_lg_u32 s28, 0
    s_cbranch_scc1 L46_sd
    ds_read_b128 v[128:131], v233
    ds_read_b128 v[132:135], v233 offset:4096
    s_waitcnt lgkmcnt(0)
    v_max3_u32 v128, v128, v129, v130
    v_max3_u32 v131, v131, v132, v133
    v_max3_u32 v128, v128, v134, v135
    v_max_u32 v128, v128, v131
    v_cmp_eq_u32 vcc, -1, v128
    s_mov_b32 s28, 1
    s_nop 0
    s_cbranch_vccz L46_sd
    s_mov_b32 s28, 0
    s_mov_b32 m0, s38
    s_nop 0
    buffer_load_dwordx4 v2, s[16:19], s39 offen sc1 lds
    s_add_u32 m0, s38, 3072
    s_nop 0
    buffer_load_dwordx4 v2, s[16:19], s39 offen offset:1024 sc1 lds
L46_sd:
    s_add_u32 s50, s53, s93
    s_add_u32 m0, s58, 28672
    s_nop 0
    buffer_load_dwordx4 v6, s[12:15], s50 offen  lds
    s_waitcnt vmcnt(10)
    s_add_u32 s50, s53, s94
    s_add_u32 m0, s59, 28672
    s_nop 0
    buffer_load_dwordx4 v6, s[12:15], s50 offen  lds
    s_waitcnt vmcnt(10)
    s_add_u32 s50, s53, s95
    s_add_u32 m0, s60, 28672
    s_nop 0
    buffer_load_dwordx4 v6, s[12:15], s50 offen  lds
    s_waitcnt vmcnt(10)
    s_cmp_lg_u32 s56, 0
    s_cbranch_scc1 L47_fi
    s_mov_b64 exec, 1
    buffer_load_dword v240, v246, s[24:27], 0 offen offset:124 sc1
    s_mov_b64 exec, -1
L47_fi:
    s_add_u32 s50, s53, s96
    s_add_u32 m0, s61, 28672
    s_nop 0
    buffer_load_dwordx4 v6, s[12:15], s50 offen  lds
    s_waitcnt vmcnt(10)
    s_mov_b64 exec, 1
    ds_add_u32 v13, v15 offset:36
    s_mov_b64 exec, -1
    s_add_u32 s50, s53, s97
    s_add_u32 m0, s62, 28672
    s_nop 0
    buffer_load_dwordx4 v6, s[12:15], s50 offen  lds
    s_waitcnt vmcnt(10)
    s_add_u32 s50, s53, s98
    s_add_u32 m0, s63, 28672
    s_nop 0
    buffer_load_dwordx4 v6, s[12:15], s50 offen  lds
    s_waitcnt vmcnt(10)
    s_cmp_eq_u32 s29, 7
    s_cbranch_scc1 k_gd
    s_mov_b32 s47, 0x8000
L48_sp:
    ds_read_b32 v14, v13 offset:8
    s_waitcnt lgkmcnt(0)
    v_readfirstlane_b32 s48, v14
    s_nop 0
    s_cmp_ge_u32 s48, 4
    s_cbranch_scc1 L49_ok
    s_sleep 1
    s_sub_u32 s47, s47, 1
    s_cbranch_scc0 L48_sp
L49_ok:
k_gd:
    s_mov_b32 s47, 0x8000
L50_sp:
    ds_read_b32 v14, v13 offset:36
    s_waitcnt lgkmcnt(0)
    v_readfirstlane_b32 s48, v14
    s_nop 0
    s_cmp_ge_u32 s48, 4
    s_cbranch_scc1 L51_ok
    s_sleep 0
    s_sub_u32 s47, s47, 1
    s_cbranch_scc0 L50_sp
L51_ok:
    ds_read_b64_tr_b16 v[16:17], v8 offset:28672
    ds_read_b64_tr_b16 v[18:19], v8 offset:29184
    ds_read_b64_tr_b16 v[32:33], v8 offset:32768
    ds_read_b64_tr_b16 v[34:35], v8 offset:33280
    ds_read_b64_tr_b16 v[48:49], v8 offset:36864
    ds_read_b64_tr_b16 v[50:51], v8 offset:37376
    ds_read_b64_tr_b16 v[64:65], v8 offset:40960
    ds_read_b64_tr_b16 v[66:67], v8 offset:41472
    ds_read_b64_tr_b16 v[80:81], v8 offset:45056
    ds_read_b64_tr_b16 v[82:83], v8 offset:45568
    ds_read_b64_tr_b16 v[96:97], v8 offset:49152
    ds_read_b64_tr_b16 v[98:99], v8 offset:49664
    ds_read_b64_tr_b16 v[112:113], v8 offset:53248
    ds_read_b64_tr_b16 v[114:115], v8 offset:53760
    s_mov_b64 exec, 1
    ds_add_u32 v13, v15 offset:40
    s_mov_b64 exec, -1
    s_add_u32 s50, s54, s92
    s_add_u32 m0, s57, 57344
    s_nop 0
    buffer_load_dwordx4 v6, s[12:15], s50 offen  lds
    s_waitcnt vmcnt(10)
    s_add_u32 s50, s54, s93
    s_add_u32 m0, s58, 57344
    s_nop 0
    buffer_load_dwordx4 v6, s[12:15], s50 offen  lds
    s_waitcnt vmcnt(10)
    s_cmp_lg_u32 s56, 0
    s_cbranch_scc1 L52_fc
    v_readfirstlane_b32 s48, v242
    s_nop 0
    s_bitcmp1_b32 s48, 16
    s_cbranch_scc0 L52_fc
    s_mov_b32 s56, 1
    s_mov_b64 exec, 1
    ds_write_b32 v13, v15 offset:0
    ds_add_u32 v13, v15 offset:32
    s_mov_b64 exec, -1
L52_fc:
    s_add_u32 s50, s54, s94
    s_add_u32 m0, s59, 57344
    s_nop 0
    buffer_load_dwordx4 v6, s[12:15], s50 offen  lds
    s_waitcnt vmcnt(10)
    s_mov_b64 exec, 1
    ds_add_u32 v13, v15 offset:64
    s_mov_b64 exec, -1
    s_cmp_lg_u32 s56, 0
    s_cbranch_scc1 L53_fi
    s_mov_b64 exec, 1
    buffer_load_dword v238, v246, s[24:27], 0 offen offset:124 sc1
    s_mov_b64 exec, -1
L53_fi:
    s_add_u32 s50, s54, s95
    s_add_u32 m0, s60, 57344
    s_nop 0
    buffer_load_dwordx4 v6, s[12:15], s50 offen  lds
    s_waitcnt vmcnt(10)
    s_add_u32 s50, s54, s96
    s_add_u32 m0, s61, 57344
    s_nop 0
    buffer_load_dwordx4 v6, s[12:15], s50 offen  lds
    s_waitcnt vmcnt(10)
    s_add_u32 s50, s54, s97
    s_add_u32 m0, s62, 57344
    s_nop 0
    buffer_load_dwordx4 v6, s[12:15], s50 offen  lds
    s_waitcnt vmcnt(10)
    s_add_u32 s50, s54, s98
    s_add_u32 m0, s63, 57344
    s_nop 0
    buffer_load_dwordx4 v6, s[12:15], s50 offen  lds
    s_waitcnt vmcnt(10)
    s_mov_b32 s47, 0x8000
L54_sp:
    ds_read_b32 v14, v13 offset:40
    s_waitcnt lgkmcnt(0)
    v_readfirstlane_b32 s48, v14
    s_nop 0
    s_cmp_ge_u32 s48, 4
    s_cbranch_scc1 L55_ok
    s_sleep 0
    s_sub_u32 s47, s47, 1
    s_cbranch_scc0 L54_sp
L55_ok:
    s_add_u32 s50, s55, s92
    s_add_u32 m0, s57, 86016
    s_nop 0
    buffer_load_dwordx4 v6, s[12:15], s50 offen  lds
    s_waitcnt vmcnt(10)
    s_cmp_lg_u32 s56, 0
    s_cbranch_scc1 L56_fc
    v_readfirstlane_b32 s48, v240
    s_nop 0
    s_bitcmp1_b32 s48, 16
    s_cbranch_scc0 L56_fc
    s_mov_b32 s56, 1
    s_mov_b64 exec, 1
    ds_write_b32 v13, v15 offset:0
    ds_add_u32 v13, v15 offset:32
    s_mov_b64 exec, -1
L56_fc:
    s_add_u32 s50, s55, s93
    s_add_u32 m0, s58, 86016
    s_nop 0
    buffer_load_dwordx4 v6, s[12:15], s50 offen  lds
    s_waitcnt vmcnt(10)
    s_add_u32 s50, s55, s94
    s_add_u32 m0, s59, 86016
    s_nop 0
    buffer_load_dwordx4 v6, s[12:15], s50 offen  lds
    s_waitcnt vmcnt(10)
    s_mov_b64 exec, 1
    ds_add_u32 v13, v15 offset:68
    s_mov_b64 exec, -1
    s_add_u32 s50, s55, s95
    s_add_u32 m0, s60, 86016
    s_nop 0
    buffer_load_dwordx4 v6, s[12:15], s50 offen  lds
    s_waitcnt vmcnt(10)
    s_add_u32 s50, s55, s96
    s_add_u32 m0, s61, 86016
    s_nop 0
    buffer_load_dwordx4 v6, s[12:15], s50 offen  lds
    s_waitcnt vmcnt(10)
    s_add_u32 s50, s55, s97
    s_add_u32 m0, s62, 86016
    s_nop 0
    buffer_load_dwordx4 v6, s[12:15], s50 offen  lds
    s_waitcnt vmcnt(10)
    s_add_u32 s50, s55, s98
    s_add_u32 m0, s63, 86016
    s_nop 0
    buffer_load_dwordx4 v6, s[12:15], s50 offen  lds
    s_mov_b32 s61, s53
    s_mov_b32 s62, s54
    s_mov_b32 s63, s55
    s_waitcnt vmcnt(7)
    s_mov_b64 exec, 1
    ds_add_u32 v13, v15 offset:72
    s_mov_b64 exec, -1
    s_cmp_lg_u32 s56, 0
    s_cbranch_scc1 L57_fc
    v_readfirstlane_b32 s48, v238
    s_nop 0
    s_bitcmp1_b32 s48, 16
    s_cbranch_scc0 L57_fc
    s_mov_b32 s56, 1
    s_mov_b64 exec, 1
    ds_write_b32 v13, v15 offset:0
    ds_add_u32 v13, v15 offset:32
    s_mov_b64 exec, -1
L57_fc:
    v_mov_b32 v210, v13
    v_mov_b32 v211, 1
    s_cmp_lg_u32 s56, 0
    s_cbranch_scc1 L58_fi
    s_mov_b64 exec, 1
    buffer_load_dword v236, v246, s[24:27], 0 offen offset:124 sc1
    s_mov_b64 exec, -1
L58_fi:
    s_mov_b64 s[52:53], s[20:21]
    s_mov_b64 s[54:55], s[22:23]
    s_mov_b32 s39, s45
    v_mov_b32 v6, v140
    v_mov_b32 v8, v141
    v_mov_b32 v11, v142
    v_mov_b32 v13, v137
    v_mov_b32 v233, v143
    s_mov_b32 s92, s3
    s_mov_b32 s93, s31
    s_mov_b32 s94, s32
    s_mov_b32 s95, s37
    s_mov_b32 s96, s46
    s_mov_b32 s97, s49
    s_mov_b32 s98, s51
    v_mov_b32 v209, 1
    s_waitcnt vmcnt(4)
    s_cmp_eq_u32 s29, 7
    s_cselect_b32 s48, 0, s56
    s_cmp_lg_u32 s48, 0
    s_cbranch_scc1 k_he
    s_waitcnt vmcnt(0)
    s_mov_b64 exec, 1
    ds_add_u32 v210, v211 offset:76
    s_mov_b64 exec, -1
    v_mov_b32 v209, 0
k_he:
    s_cmp_lg_u32 s56, 0
    s_cbranch_scc1 L59_fc
    v_readfirstlane_b32 s48, v236
    s_nop 0
    s_bitcmp1_b32 s48, 16
    s_cbranch_scc0 L59_fc
    s_mov_b32 s56, 1
    s_mov_b64 exec, 1
    ds_write_b32 v210, v211 offset:0
    ds_add_u32 v210, v211 offset:32
    s_mov_b64 exec, -1
L59_fc:
    s_mov_b32 s47, 4096
L60_fl:
    s_cmp_lg_u32 s56, 0
    s_cbranch_scc1 L61_flok
    s_cmp_lt_u32 s47, 4072
    s_cbranch_scc1 L62_flg
    s_sleep 2
    s_mov_b64 exec, 1
    buffer_load_dword v236, v246, s[24:27], 0 offen offset:124 sc1
    s_mov_b64 exec, -1
    s_waitcnt vmcnt(0)
L63_flr:
    s_cmp_lg_u32 s56, 0
    s_cbranch_scc1 L64_fc
    v_readfirstlane_b32 s48, v236
    s_nop 0
    s_bitcmp1_b32 s48, 16
    s_cbranch_scc0 L64_fc
    s_mov_b32 s56, 1
    s_mov_b64 exec, 1
    ds_write_b32 v210, v211 offset:0
    ds_add_u32 v210, v211 offset:32
    s_mov_b64 exec, -1
L64_fc:
    s_sub_u32 s47, s47, 1
    s_cbranch_scc0 L60_fl
L61_flok:
    s_mov_b32 s47, 0x8000
L65_sp:
    ds_read_b32 v14, v210 offset:32
    s_waitcnt lgkmcnt(0)
    v_readfirstlane_b32 s48, v14
    s_nop 0
    s_cmp_ge_u32 s48, 5
    s_cbranch_scc1 L66_ok
    s_sleep 1
    s_sub_u32 s47, s47, 1
    s_cbranch_scc0 L65_sp
L66_ok:
    s_sleep 2
    s_mov_b32 s47, 0x1000
    s_setprio 3
    v_add_u32 v12, s39, v2
    v_bfe_u32 v15, v1, 3, 2
    v_lshl_add_u32 v12, v15, 2, v12
    v_add_u32 v15, 0x10000, v12
    s_add_u32 m0, s39, 0
    s_add_u32 s38, s52, s92
    buffer_load_dwordx4 v3, s[16:19], s38 offen sc1 lds
    s_add_u32 m0, s39, 4096
    s_add_u32 s38, s53, s92
    buffer_load_dwordx4 v3, s[16:19], s38 offen sc1 lds
    s_add_u32 m0, s39, 8192
    s_add_u32 s38, s54, s92
    buffer_load_dwordx4 v3, s[16:19], s38 offen sc1 lds
    s_add_u32 m0, s39, 12288
    s_add_u32 s38, s55, s92
    buffer_load_dwordx4 v3, s[16:19], s38 offen sc1 lds
    s_waitcnt vmcnt(4)
    s_mov_b64 exec, 1
    ds_add_u32 v210, v209 offset:76
    s_mov_b64 exec, -1
    s_waitcnt vmcnt(3)
    s_add_u32 m0, s39, 16384
    s_add_u32 s38, s52, s93
    buffer_load_dwordx4 v3, s[16:19], s38 offen sc1 lds
    s_add_u32 m0, s39, 20480
    s_add_u32 s38, s53, s93
    buffer_load_dwordx4 v3, s[16:19], s38 offen sc1 lds
    s_add_u32 m0, s39, 24576
    s_add_u32 s38, s54, s93
    buffer_load_dwordx4 v3, s[16:19], s38 offen sc1 lds
    s_add_u32 m0, s39, 28672
    s_add_u32 s38, s55, s93
    buffer_load_dwordx4 v3, s[16:19], s38 offen sc1 lds
    s_add_u32 m0, s39, 32768
    s_add_u32 s38, s52, s94
    buffer_load_dwordx4 v3, s[16:19], s38 offen sc1 lds
    s_add_u32 m0, s39, 36864
    s_add_u32 s38, s53, s94
    buffer_load_dwordx4 v3, s[16:19], s38 offen sc1 lds
    ds_read_b32 v240, v12 offset:0
L67_hc:
    s_waitcnt lgkmcnt(0)
    v_cmp_eq_u32 vcc, -1, v240
    s_nop 1
    s_cbranch_vccnz L67_hcr
L68_hok:
    s_barrier
    s_add_u32 m0, s39, 40960
    s_add_u32 s38, s54, s94
    buffer_load_dwordx4 v3, s[16:19], s38 offen sc1 lds
    s_add_u32 m0, s39, 45056
    s_add_u32 s38, s55, s94
    buffer_load_dwordx4 v3, s[16:19], s38 offen sc1 lds
    s_add_u32 m0, s39, 49152
    s_add_u32 s38, s52, s95
    buffer_load_dwordx4 v3, s[16:19], s38 offen sc1 lds
    s_add_u32 m0, s39, 53248
    s_add_u32 s38, s53, s95
    buffer_load_dwordx4 v3, s[16:19], s38 offen sc1 lds
    s_waitcnt vmcnt(12)
    ds_read_b32 v240, v12 offset:4096
L69_hc:
    s_waitcnt lgkmcnt(0)
    v_cmp_eq_u32 vcc, -1, v240
    s_nop 1
    s_cbranch_vccnz L69_hcr
L70_hok:
    s_barrier
    s_add_u32 m0, s39, 57344
    s_add_u32 s38, s54, s95
    buffer_load_dwordx4 v3, s[16:19], s38 offen sc1 lds
    s_add_u32 m0, s39, 61440
    s_add_u32 s38, s55, s95
    buffer_load_dwordx4 v3, s[16:19], s38 offen sc1 lds
    s_waitcnt vmcnt(12)
    ds_read_b32 v240, v12 offset:8192
    ds_read_b32 v241, v12 offset:12288
L71_hc:
    s_waitcnt lgkmcnt(0)
    v_max_u32 v240, v240, v241
    v_cmp_eq_u32 vcc, -1, v240
    s_nop 1
    s_cbranch_vccnz L71_hcr
L72_hok:
    s_barrier
    s_add_u32 m0, s39, 65536
    s_add_u32 s38, s52, s96
    buffer_load_dwordx4 v3, s[16:19], s38 offen sc1 lds
    s_add_u32 m0, s39, 69632
    s_add_u32 s38, s53, s96
    buffer_load_dwordx4 v3, s[16:19], s38 offen sc1 lds
    s_mul_i32 s50, s92, 14
    s_add_u32 m0, s39, 114688
    s_add_u32 s50, s50, s61
    buffer_load_dwordx4 v204, s[12:15], s50 offen  lds
    s_mul_i32 s50, s92, 14
    s_add_u32 m0, s39, 118784
    s_add_u32 s50, s50, s62
    buffer_load_dwordx4 v204, s[12:15], s50 offen  lds
    s_waitcnt vmcnt(14)
    ds_read_b32 v240, v12 offset:16384
    ds_read_b32 v241, v12 offset:20480
L73_hc:
    s_waitcnt lgkmcnt(0)
    v_max_u32 v240, v240, v241
    v_cmp_eq_u32 vcc, -1, v240
    s_nop 1
    s_cbranch_vccnz L73_hcr
L74_hok:
    s_barrier
    s_add_u32 m0, s39, 73728
    s_add_u32 s38, s54, s96
    buffer_load_dwordx4 v3, s[16:19], s38 offen sc1 lds
    s_add_u32 m0, s39, 77824
    s_add_u32 s38, s55, s96
    buffer_load_dwordx4 v3, s[16:19], s38 offen sc1 lds
    s_mul_i32 s50, s92, 14
    s_add_u32 m0, s39, 122880
    s_add_u32 s50, s50, s63
    buffer_load_dwordx4 v204, s[12:15], s50 offen  lds
    s_mul_i32 s50, s93, 14
    s_add_u32 m0, s39, 126976
    s_add_u32 s50, s50, s61
    buffer_load_dwordx4 v204, s[12:15], s50 offen  lds
    s_waitcnt vmcnt(16)
    ds_read_b32 v240, v12 offset:24576
    ds_read_b32 v241, v12 offset:28672
L75_hc:
    s_waitcnt lgkmcnt(0)
    v_max_u32 v240, v240, v241
    v_cmp_eq_u32 vcc, -1, v240
    s_nop 1
    s_cbranch_vccnz L75_hcr
L76_hok:
    s_barrier
    s_add_u32 m0, s39, 81920
    s_add_u32 s38, s52, s97
    buffer_load_dwordx4 v3, s[16:19], s38 offen sc1 lds
    s_add_u32 m0, s39, 86016
    s_add_u32 s38, s53, s97
    buffer_load_dwordx4 v3, s[16:19], s38 offen sc1 lds
    s_mul_i32 s50, s93, 14
    s_add_u32 m0, s39, 131072
    s_add_u32 s50, s50, s62
    buffer_load_dwordx4 v204, s[12:15], s50 offen  lds
    s_mul_i32 s50, s93, 14
    s_add_u32 m0, s39, 135168
    s_add_u32 s50, s50, s63
    buffer_load_dwordx4 v204, s[12:15], s50 offen  lds
    s_waitcnt vmcnt(18)
    s_waitcnt vmcnt(8)
    ds_read_b32 v240, v12 offset:32768
    ds_read_b32 v241, v12 offset:36864
L77_hc:
    s_waitcnt lgkmcnt(0)
    v_max_u32 v240, v240, v241
    v_cmp_eq_u32 vcc, -1, v240
    s_nop 1
    s_cbranch_vccnz L77_hcr
L78_hok:
    s_barrier
    s_add_u32 m0, s39, 90112
    s_add_u32 s38, s54, s97
    buffer_load_dwordx4 v3, s[16:19], s38 offen sc1 lds
    s_add_u32 m0, s39, 94208
    s_add_u32 s38, s55, s97
    buffer_load_dwordx4 v3, s[16:19], s38 offen sc1 lds
    s_mul_i32 s50, s94, 14
    s_add_u32 m0, s39, 139264
    s_add_u32 s50, s50, s61
    buffer_load_dwordx4 v204, s[12:15], s50 offen  lds
    s_mul_i32 s50, s94, 14
    s_add_u32 m0, s39, 143360
    s_add_u32 s50, s50, s62
    buffer_load_dwordx4 v204, s[12:15], s50 offen  lds
    s_waitcnt vmcnt(8)
    ds_read_b32 v240, v12 offset:40960
    ds_read_b32 v241, v12 offset:45056
    ds_read_b64_tr_b16 v[20:21], v205 offset:0
    ds_read_b64_tr_b16 v[22:23], v205 offset:512
    ds_read_b64_tr_b16 v[24:25], v205 offset:4096
    ds_read_b64_tr_b16 v[26:27], v205 offset:4608
L79_hc:
    s_waitcnt lgkmcnt(0)
    v_max_u32 v240, v240, v241
    v_cmp_eq_u32 vcc, -1, v240
    s_nop 1
    s_cbranch_vccnz L79_hcr
L80_hok:
    s_barrier
    s_add_u32 m0, s39, 98304
    s_add_u32 s38, s52, s98
    buffer_load_dwordx4 v3, s[16:19], s38 offen sc1 lds
    s_add_u32 m0, s39, 102400
    s_add_u32 s38, s53, s98
    buffer_load_dwordx4 v3, s[16:19], s38 offen sc1 lds
    s_mul_i32 s50, s94, 14
    s_add_u32 m0, s39, 147456
    s_add_u32 s50, s50, s63
    buffer_load_dwordx4 v204, s[12:15], s50 offen  lds
    s_mul_i32 s50, s95, 14
    s_add_u32 m0, s39, 151552
    s_add_u32 s50, s50, s61
    buffer_load_dwordx4 v204, s[12:15], s50 offen  lds
    s_waitcnt vmcnt(8)
    ds_read_b32 v240, v12 offset:49152
    ds_read_b32 v241, v12 offset:53248
    ds_read_b64_tr_b16 v[28:29], v205 offset:8192
    ds_read_b64_tr_b16 v[30:31], v205 offset:8704
    ds_read_b64_tr_b16 v[36:37], v205 offset:12288
    ds_read_b64_tr_b16 v[38:39], v205 offset:12800
L81_hc:
    s_waitcnt lgkmcnt(0)
    v_max_u32 v240, v240, v241
    v_cmp_eq_u32 vcc, -1, v240
    s_nop 1
    s_cbranch_vccnz L81_hcr
L82_hok:
    s_barrier
    s_cmp_lg_u32 s30, 4
    s_cbranch_scc1 k_f2a
    s_mov_b64 exec, 1
    buffer_load_dword v236, v247, s[24:27], 0 offen offset:124 sc1
    s_mov_b64 exec, -1
k_f2a:
    s_add_u32 m0, s39, 106496
    s_add_u32 s38, s54, s98
    buffer_load_dwordx4 v3, s[16:19], s38 offen sc1 lds
    s_add_u32 m0, s39, 110592
    s_add_u32 s38, s55, s98
    buffer_load_dwordx4 v3, s[16:19], s38 offen sc1 lds
    s_mul_i32 s50, s95, 14
    s_add_u32 m0, s39, 155648
    s_add_u32 s50, s50, s62
    buffer_load_dwordx4 v204, s[12:15], s50 offen  lds
    s_mul_i32 s50, s95, 14
    s_add_u32 m0, s39, 114688
    s_add_u32 s50, s50, s63
    buffer_load_dwordx4 v204, s[12:15], s50 offen  lds
    buffer_load_dword v252, v243, s[16:19], s10 offen sc1
    s_waitcnt vmcnt(9)
    ds_read_b32 v240, v12 offset:57344
    ds_read_b32 v241, v12 offset:61440
    ds_read_b64_tr_b16 v[40:41], v205 offset:16384
    ds_read_b64_tr_b16 v[42:43], v205 offset:16896
    ds_read_b64_tr_b16 v[44:45], v205 offset:20480
    ds_read_b64_tr_b16 v[46:47], v205 offset:20992
L83_hc:
    s_waitcnt lgkmcnt(0)
    v_max_u32 v240, v240, v241
    v_cmp_eq_u32 vcc, -1, v240
    s_nop 1
    s_cbranch_vccnz L83_hcr
L84_hok:
    s_barrier
    s_mul_i32 s50, s96, 14
    s_add_u32 m0, s39, 118784
    s_add_u32 s50, s50, s61
    buffer_load_dwordx4 v204, s[12:15], s50 offen  lds
    s_mul_i32 s50, s96, 14
    s_add_u32 m0, s39, 122880
    s_add_u32 s50, s50, s62
    buffer_load_dwordx4 v204, s[12:15], s50 offen  lds
    s_mul_i32 s50, s96, 14
    s_add_u32 m0, s39, 126976
    s_add_u32 s50, s50, s63
    buffer_load_dwordx4 v204, s[12:15], s50 offen  lds
    s_waitcnt vmcnt(8)
    ds_read_b32 v240, v15 offset:0
    ds_read_b32 v241, v15 offset:4096
    ds_read_b64_tr_b16 v[52:53], v205 offset:24576
    ds_read_b64_tr_b16 v[54:55], v205 offset:25088
    ds_read_b64_tr_b16 v[56:57], v205 offset:28672
    ds_read_b64_tr_b16 v[58:59], v205 offset:29184
L85_hc:
    s_waitcnt lgkmcnt(0)
    v_max_u32 v240, v240, v241
    v_cmp_eq_u32 vcc, -1, v240
    s_nop 1
    s_cbranch_vccnz L85_hcr
L86_hok:
    s_barrier
    s_mul_i32 s50, s97, 14
    s_add_u32 m0, s39, 131072
    s_add_u32 s50, s50, s61
    buffer_load_dwordx4 v204, s[12:15], s50 offen  lds
    s_mul_i32 s50, s97, 14
    s_add_u32 m0, s39, 135168
    s_add_u32 s50, s50, s62
    buffer_load_dwordx4 v204, s[12:15], s50 offen  lds
    s_mul_i32 s50, s97, 14
    s_add_u32 m0, s39, 139264
    s_add_u32 s50, s50, s63
    buffer_load_dwordx4 v204, s[12:15], s50 offen  lds
    buffer_load_dword v244, v243, s[16:19], s11 offen sc1
    s_waitcnt vmcnt(8)
    s_cmp_eq_u32 s30, 4
    s_cbranch_scc1 k_f2b
k_f2r:
    ds_read_b32 v240, v15 offset:8192
    ds_read_b32 v241, v15 offset:12288
    ds_read_b64_tr_b16 v[60:61], v205 offset:32768
    ds_read_b64_tr_b16 v[62:63], v205 offset:33280
    ds_read_b64_tr_b16 v[68:69], v205 offset:36864
    ds_read_b64_tr_b16 v[70:71], v205 offset:37376
L87_hc:
    s_waitcnt lgkmcnt(0)
    v_max_u32 v240, v240, v241
    v_cmp_eq_u32 vcc, -1, v240
    s_nop 1
    s_cbranch_vccnz L87_hcr
L88_hok:
    s_barrier
    s_mul_i32 s50, s98, 14
    s_add_u32 m0, s39, 143360
    s_add_u32 s50, s50, s61
    buffer_load_dwordx4 v204, s[12:15], s50 offen  lds
    s_mul_i32 s50, s98, 14
    s_add_u32 m0, s39, 147456
    s_add_u32 s50, s50, s62
    buffer_load_dwordx4 v204, s[12:15], s50 offen  lds
    s_mul_i32 s50, s98, 14
    s_add_u32 m0, s39, 151552
    s_add_u32 s50, s50, s63
    buffer_load_dwordx4 v204, s[12:15], s50 offen  lds
    s_waitcnt vmcnt(7)
    ds_read_b32 v240, v15 offset:16384
    ds_read_b32 v241, v15 offset:20480
    ds_read_b64_tr_b16 v[72:73], v205 offset:40960
    ds_read_b64_tr_b16 v[74:75], v205 offset:41472
    ds_read_b64_tr_b16 v[76:77], v205 offset:0
    ds_read_b64_tr_b16 v[78:79], v205 offset:512
L91_gc:
    v_cmp_eq_u32 vcc, -1, v252
    s_nop 1
    s_cbranch_vccnz L91_gcr
L91_gck:
    s_mov_b32 vcc_lo, 0
    s_mov_b32 vcc_hi, -1
    v_sub_f32 v252, 0, v252
    v_cvt_pk_bf16_f32 v253, v252, 0
    v_lshlrev_b32 v254, 16, v253
    v_sub_f32 v254, v252, v254
    v_cvt_pk_bf16_f32 v254, v254, 0
    v_cndmask_b32 v226, v253, v254, vcc
    v_cndmask_b32 v231, v253, v254, vcc
L89_hc:
    s_waitcnt lgkmcnt(0)
    v_max_u32 v240, v240, v241
    v_cmp_eq_u32 vcc, -1, v240
    s_nop 1
    s_cbranch_vccnz L89_hcr
L90_hok:
    s_barrier
    s_waitcnt vmcnt(4)
    ds_read_b32 v240, v15 offset:24576
    ds_read_b32 v241, v15 offset:28672
    ds_read_b64_tr_b16 v[84:85], v205 offset:4096
    ds_read_b64_tr_b16 v[86:87], v205 offset:4608
    ds_read_b64_tr_b16 v[88:89], v205 offset:8192
    ds_read_b64_tr_b16 v[90:91], v205 offset:8704
    ds_read_b64_tr_b16 v[92:93], v205 offset:12288
    ds_read_b64_tr_b16 v[94:95], v205 offset:12800
L92_hc:
    s_waitcnt lgkmcnt(0)
    v_max_u32 v240, v240, v241
    v_cmp_eq_u32 vcc, -1, v240
    s_nop 1
    s_cbranch_vccnz L92_hcr
L93_hok:
    s_barrier
    s_waitcnt vmcnt(0)
    ds_read_b32 v240, v15 offset:32768
    ds_read_b32 v241, v15 offset:36864
    ds_read_b64_tr_b16 v[100:101], v205 offset:16384
    ds_read_b64_tr_b16 v[102:103], v205 offset:16896
    ds_read_b64_tr_b16 v[104:105], v205 offset:20480
    ds_read_b64_tr_b16 v[106:107], v205 offset:20992
    ds_read_b64_tr_b16 v[108:109], v205 offset:24576
    ds_read_b64_tr_b16 v[110:111], v205 offset:25088
    v_cmp_eq_u32 vcc, -1, v244
    s_nop 1
    s_cbranch_vccnz L96_gzr
L96_gz:
L94_hc:
    s_waitcnt lgkmcnt(0)
    v_max_u32 v240, v240, v241
    v_cmp_eq_u32 vcc, -1, v240
    s_nop 1
    s_cbranch_vccnz L94_hcr
L95_hok:
    s_barrier
    ds_read_b32 v240, v15 offset:40960
    ds_read_b32 v241, v15 offset:45056
    ds_read_b64_tr_b16 v[116:117], v205 offset:28672
    ds_read_b64_tr_b16 v[118:119], v205 offset:29184
    ds_read_b64_tr_b16 v[120:121], v205 offset:32768
    ds_read_b64_tr_b16 v[122:123], v205 offset:33280
    ds_read_b64_tr_b16 v[124:125], v205 offset:36864
    ds_read_b64_tr_b16 v[126:127], v205 offset:37376
L97_hc:
    s_waitcnt lgkmcnt(0)
    v_max_u32 v240, v240, v241
    v_cmp_eq_u32 vcc, -1, v240
    s_nop 1
    s_cbranch_vccnz L97_hcr
L98_hok:
    s_barrier
    s_waitcnt vmcnt(0)
L99_gc:
    v_cmp_eq_u32 vcc, -1, v244
    s_nop 1
    s_cbranch_vccnz L99_gcr
L99_gck:
    ds_write_b32 v245, v244
    s_setprio 0
    s_lshl_b32 s44, s39, 3
    s_add_u32 s44, s44, 114688
    v_add_u32 v12, s44, v2
    ds_read_b64_tr_b16 v[192:193], v4 offset:0
    ds_read_b64_tr_b16 v[194:195], v4 offset:1024
    ds_read_b64_tr_b16 v[196:197], v5 offset:0
    ds_read_b64_tr_b16 v[198:199], v5 offset:1024
    ds_read_b64_tr_b16 v[200:201], v4 offset:4096
    ds_read_b64_tr_b16 v[202:203], v4 offset:5120
    ds_read_b64_tr_b16 v[204:205], v5 offset:4096
    ds_read_b64_tr_b16 v[206:207], v5 offset:5120
    s_waitcnt lgkmcnt(6)
    v_mfma_f32_32x32x16_bf16 v[128:143], v[16:19], v[192:195], 0
    ds_read_b64_tr_b16 v[208:209], v4 offset:8192
    ds_read_b64_tr_b16 v[210:211], v4 offset:9216
    s_waitcnt lgkmcnt(6)
    v_mfma_f32_32x32x16_bf16 v[144:159], v[16:19], v[196:199], 0
    ds_read_b64_tr_b16 v[212:213], v5 offset:8192
    ds_read_b64_tr_b16 v[214:215], v5 offset:9216
    s_waitcnt lgkmcnt(6)
    v_mfma_f32_32x32x16_bf16 v[128:143], v[20:23], v[200:203], v[128:143]
    ds_read_b64_tr_b16 v[216:217], v4 offset:12288
    ds_read_b64_tr_b16 v[218:219], v4 offset:13312
    s_waitcnt lgkmcnt(6)
    v_mfma_f32_32x32x16_bf16 v[144:159], v[20:23], v[204:207], v[144:159]
    ds_read_b64_tr_b16 v[220:221], v5 offset:12288
    ds_read_b64_tr_b16 v[222:223], v5 offset:13312
    s_waitcnt lgkmcnt(6)
    v_mfma_f32_32x32x16_bf16 v[128:143], v[24:27], v[208:211], v[128:143]
    ds_read_b64_tr_b16 v[192:193], v4 offset:16384
    ds_read_b64_tr_b16 v[194:195], v4 offset:17408
    s_waitcnt lgkmcnt(6)
    v_mfma_f32_32x32x16_bf16 v[144:159], v[24:27], v[212:215], v[144:159]
    ds_read_b64_tr_b16 v[196:197], v5 offset:16384
    ds_read_b64_tr_b16 v[198:199], v5 offset:17408
    s_waitcnt lgkmcnt(6)
    v_mfma_f32_32x32x16_bf16 v[128:143], v[28:31], v[216:219], v[128:143]
    ds_read_b64_tr_b16 v[200:201], v4 offset:20480
    ds_read_b64_tr_b16 v[202:203], v4 offset:21504
    s_waitcnt lgkmcnt(6)
    v_mfma_f32_32x32x16_bf16 v[144:159], v[28:31], v[220:223], v[144:159]
    ds_read_b64_tr_b16 v[204:205], v5 offset:20480
    ds_read_b64_tr_b16 v[206:207], v5 offset:21504
    s_waitcnt lgkmcnt(6)
    v_mfma_f32_32x32x16_bf16 v[128:143], v[32:35], v[192:195], v[128:143]
    ds_read_b64_tr_b16 v[208:209], v4 offset:24576
    ds_read_b64_tr_b16 v[210:211], v4 offset:25600
    s_waitcnt lgkmcnt(6)
    v_mfma_f32_32x32x16_bf16 v[144:159], v[32:35], v[196:199], v[144:159]
    ds_read_b64_tr_b16 v[212:213], v5 offset:24576
    ds_read_b64_tr_b16 v[214:215], v5 offset:25600
    s_waitcnt lgkmcnt(6)
    v_mfma_f32_32x32x16_bf16 v[128:143], v[36:39], v[200:203], v[128:143]
    ds_read_b64_tr_b16 v[216:217], v4 offset:28672
    ds_read_b64_tr_b16 v[218:219], v4 offset:29696
    s_waitcnt lgkmcnt(6)
    v_mfma_f32_32x32x16_bf16 v[144:159], v[36:39], v[204:207], v[144:159]
    ds_read_b64_tr_b16 v[220:221], v5 offset:28672
    ds_read_b64_tr_b16 v[222:223], v5 offset:29696
    s_waitcnt lgkmcnt(6)
    v_mfma_f32_32x32x16_bf16 v[128:143], v[40:43], v[208:211], v[128:143]
    ds_read_b64_tr_b16 v[192:193], v4 offset:32768
    ds_read_b64_tr_b16 v[194:195], v4 offset:33792
    s_waitcnt lgkmcnt(6)
    v_mfma_f32_32x32x16_bf16 v[144:159], v[40:43], v[212:215], v[144:159]
    ds_read_b64_tr_b16 v[196:197], v5 offset:32768
    ds_read_b64_tr_b16 v[198:199], v5 offset:33792
    s_waitcnt lgkmcnt(6)
    v_mfma_f32_32x32x16_bf16 v[128:143], v[44:47], v[216:219], v[128:143]
    ds_read_b64_tr_b16 v[200:201], v4 offset:36864
    ds_read_b64_tr_b16 v[202:203], v4 offset:37888
    s_waitcnt lgkmcnt(6)
    v_mfma_f32_32x32x16_bf16 v[144:159], v[44:47], v[220:223], v[144:159]
    ds_read_b64_tr_b16 v[204:205], v5 offset:36864
    ds_read_b64_tr_b16 v[206:207], v5 offset:37888
    s_waitcnt lgkmcnt(6)
    v_mfma_f32_32x32x16_bf16 v[128:143], v[48:51], v[192:195], v[128:143]
    ds_read_b64_tr_b16 v[208:209], v4 offset:40960
    ds_read_b64_tr_b16 v[210:211], v4 offset:41984
    s_waitcnt lgkmcnt(6)
    v_mfma_f32_32x32x16_bf16 v[144:159], v[48:51], v[196:199], v[144:159]
    ds_read_b64_tr_b16 v[212:213], v5 offset:40960
    ds_read_b64_tr_b16 v[214:215], v5 offset:41984
    s_waitcnt lgkmcnt(6)
    v_mfma_f32_32x32x16_bf16 v[128:143], v[52:55], v[200:203], v[128:143]
    ds_read_b64_tr_b16 v[216:217], v4 offset:45056
    ds_read_b64_tr_b16 v[218:219], v4 offset:46080
    s_waitcnt lgkmcnt(6)
    v_mfma_f32_32x32x16_bf16 v[144:159], v[52:55], v[204:207], v[144:159]
    ds_read_b64_tr_b16 v[220:221], v5 offset:45056
    ds_read_b64_tr_b16 v[222:223], v5 offset:46080
    s_waitcnt lgkmcnt(6)
    v_mfma_f32_32x32x16_bf16 v[128:143], v[56:59], v[208:211], v[128:143]
    ds_read_b64_tr_b16 v[192:193], v4 offset:49152
    ds_read_b64_tr_b16 v[194:195], v4 offset:50176
    s_waitcnt lgkmcnt(6)
    v_mfma_f32_32x32x16_bf16 v[144:159], v[56:59], v[212:215], v[144:159]
    ds_read_b64_tr_b16 v[196:197], v5 offset:49152
    ds_read_b64_tr_b16 v[198:199], v5 offset:50176
    s_waitcnt lgkmcnt(6)
    v_mfma_f32_32x32x16_bf16 v[128:143], v[60:63], v[216:219], v[128:143]
    ds_read_b64_tr_b16 v[200:201], v4 offset:53248
    ds_read_b64_tr_b16 v[202:203], v4 offset:54272
    s_waitcnt lgkmcnt(6)
    v_mfma_f32_32x32x16_bf16 v[144:159], v[60:63], v[220:223], v[144:159]
    ds_read_b64_tr_b16 v[204:205], v5 offset:53248
    ds_read_b64_tr_b16 v[206:207], v5 offset:54272
    s_waitcnt lgkmcnt(6)
    v_mfma_f32_32x32x16_bf16 v[128:143], v[64:67], v[192:195], v[128:143]
    ds_read_b64_tr_b16 v[208:209], v4 offset:57344
    ds_read_b64_tr_b16 v[210:211], v4 offset:58368
    s_waitcnt lgkmcnt(6)
    v_mfma_f32_32x32x16_bf16 v[144:159], v[64:67], v[196:199], v[144:159]
    ds_read_b64_tr_b16 v[212:213], v5 offset:57344
    ds_read_b64_tr_b16 v[214:215], v5 offset:58368
    s_waitcnt lgkmcnt(6)
    v_mfma_f32_32x32x16_bf16 v[128:143], v[68:71], v[200:203], v[128:143]
    ds_read_b64_tr_b16 v[216:217], v4 offset:61440
    ds_read_b64_tr_b16 v[218:219], v4 offset:62464
    s_waitcnt lgkmcnt(6)
    v_mfma_f32_32x32x16_bf16 v[144:159], v[68:71], v[204:207], v[144:159]
    ds_read_b64_tr_b16 v[220:221], v5 offset:61440
    ds_read_b64_tr_b16 v[222:223], v5 offset:62464
    s_waitcnt lgkmcnt(6)
    v_mfma_f32_32x32x16_bf16 v[128:143], v[72:75], v[208:211], v[128:143]
    ds_read_b64_tr_b16 v[192:193], v8 offset:0
    ds_read_b64_tr_b16 v[194:195], v8 offset:1024
    s_waitcnt lgkmcnt(6)
    v_mfma_f32_32x32x16_bf16 v[144:159], v[72:75], v[212:215], v[144:159]
    ds_read_b64_tr_b16 v[196:197], v9 offset:0
    ds_read_b64_tr_b16 v[198:199], v9 offset:1024
    s_waitcnt lgkmcnt(6)
    v_mfma_f32_32x32x16_bf16 v[128:143], v[76:79], v[216:219], v[128:143]
    ds_read_b64_tr_b16 v[200:201], v8 offset:4096
    ds_read_b64_tr_b16 v[202:203], v8 offset:5120
    s_waitcnt lgkmcnt(6)
    v_mfma_f32_32x32x16_bf16 v[144:159], v[76:79], v[220:223], v[144:159]
    ds_read_b64_tr_b16 v[204:205], v9 offset:4096
    ds_read_b64_tr_b16 v[206:207], v9 offset:5120
    s_waitcnt lgkmcnt(6)
    v_mfma_f32_32x32x16_bf16 v[128:143], v[80:83], v[192:195], v[128:143]
    ds_read_b64_tr_b16 v[208:209], v8 offset:8192
    ds_read_b64_tr_b16 v[210:211], v8 offset:9216
    s_waitcnt lgkmcnt(6)
    v_mfma_f32_32x32x16_bf16 v[144:159], v[80:83], v[196:199], v[144:159]
    ds_read_b64_tr_b16 v[212:213], v9 offset:8192
    ds_read_b64_tr_b16 v[214:215], v9 offset:9216
    s_waitcnt lgkmcnt(6)
    v_mfma_f32_32x32x16_bf16 v[128:143], v[84:87], v[200:203], v[128:143]
    ds_read_b64_tr_b16 v[216:217], v8 offset:12288
    ds_read_b64_tr_b16 v[218:219], v8 offset:13312
    s_waitcnt lgkmcnt(6)
    v_mfma_f32_32x32x16_bf16 v[144:159], v[84:87], v[204:207], v[144:159]
    ds_read_b64_tr_b16 v[220:221], v9 offset:12288
    ds_read_b64_tr_b16 v[222:223], v9 offset:13312
    s_waitcnt lgkmcnt(6)
    v_mfma_f32_32x32x16_bf16 v[128:143], v[88:91], v[208:211], v[128:143]
    ds_read_b64_tr_b16 v[192:193], v8 offset:16384
    ds_read_b64_tr_b16 v[194:195], v8 offset:17408
    ds_read_b128 v[248:251], v13
    s_waitcnt lgkmcnt(7)
    v_mfma_f32_32x32x16_bf16 v[144:159], v[88:91], v[212:215], v[144:159]
    ds_read_b64_tr_b16 v[196:197], v9 offset:16384
    ds_read_b64_tr_b16 v[198:199], v9 offset:17408
    s_waitcnt lgkmcnt(7)
    v_mfma_f32_32x32x16_bf16 v[128:143], v[92:95], v[216:219], v[128:143]
    ds_read_b64_tr_b16 v[200:201], v8 offset:20480
    ds_read_b64_tr_b16 v[202:203], v8 offset:21504
    s_waitcnt lgkmcnt(7)
    v_mfma_f32_32x32x16_bf16 v[144:159], v[92:95], v[220:223], v[144:159]
    ds_read_b64_tr_b16 v[204:205], v9 offset:20480
    ds_read_b64_tr_b16 v[206:207], v9 offset:21504
    s_waitcnt lgkmcnt(7)
    v_mfma_f32_32x32x16_bf16 v[128:143], v[96:99], v[192:195], v[128:143]
    ds_read_b64_tr_b16 v[208:209], v8 offset:24576
    ds_read_b64_tr_b16 v[210:211], v8 offset:25600
    s_waitcnt lgkmcnt(6)
    v_mfma_f32_32x32x16_bf16 v[144:159], v[96:99], v[196:199], v[144:159]
    ds_read_b64_tr_b16 v[212:213], v9 offset:24576
    ds_read_b64_tr_b16 v[214:215], v9 offset:25600
    s_waitcnt lgkmcnt(6)
    v_mfma_f32_32x32x16_bf16 v[128:143], v[100:103], v[200:203], v[128:143]
    ds_read_b64_tr_b16 v[216:217], v8 offset:28672
    ds_read_b64_tr_b16 v[218:219], v8 offset:29696
    s_waitcnt lgkmcnt(6)
    v_mfma_f32_32x32x16_bf16 v[144:159], v[100:103], v[204:207], v[144:159]
    ds_read_b64_tr_b16 v[220:221], v9 offset:28672
    ds_read_b64_tr_b16 v[222:223], v9 offset:29696
    s_waitcnt lgkmcnt(6)
    v_mfma_f32_32x32x16_bf16 v[128:143], v[104:107], v[208:211], v[128:143]
    ds_read_b64_tr_b16 v[192:193], v8 offset:32768
    ds_read_b64_tr_b16 v[194:195], v8 offset:33792
    s_waitcnt lgkmcnt(6)
    v_mfma_f32_32x32x16_bf16 v[144:159], v[104:107], v[212:215], v[144:159]
    ds_read_b64_tr_b16 v[196:197], v9 offset:32768
    ds_read_b64_tr_b16 v[198:199], v9 offset:33792
    s_waitcnt lgkmcnt(6)
    v_mfma_f32_32x32x16_bf16 v[128:143], v[108:111], v[216:219], v[128:143]
    ds_read_b64_tr_b16 v[200:201], v8 offset:36864
    ds_read_b64_tr_b16 v[202:203], v8 offset:37888
    s_waitcnt lgkmcnt(6)
    v_mfma_f32_32x32x16_bf16 v[144:159], v[108:111], v[220:223], v[144:159]
    ds_read_b64_tr_b16 v[204:205], v9 offset:36864
    ds_read_b64_tr_b16 v[206:207], v9 offset:37888
    s_waitcnt lgkmcnt(6)
    v_mfma_f32_32x32x16_bf16 v[128:143], v[112:115], v[192:195], v[128:143]
    ds_read_b64_tr_b16 v[208:209], v8 offset:40960
    ds_read_b64_tr_b16 v[210:211], v8 offset:41984
    s_waitcnt lgkmcnt(6)
    v_mfma_f32_32x32x16_bf16 v[144:159], v[112:115], v[196:199], v[144:159]
    ds_read_b64_tr_b16 v[212:213], v9 offset:40960
    ds_read_b64_tr_b16 v[214:215], v9 offset:41984
    s_waitcnt lgkmcnt(6)
    v_mfma_f32_32x32x16_bf16 v[128:143], v[116:119], v[200:203], v[128:143]
    ds_read_b64_tr_b16 v[216:217], v8 offset:45056
    ds_read_b64_tr_b16 v[218:219], v8 offset:46080
    s_waitcnt lgkmcnt(6)
    v_mfma_f32_32x32x16_bf16 v[144:159], v[116:119], v[204:207], v[144:159]
    ds_read_b64_tr_b16 v[220:221], v9 offset:45056
    ds_read_b64_tr_b16 v[222:223], v9 offset:46080
    s_waitcnt lgkmcnt(6)
    v_mfma_f32_32x32x16_bf16 v[128:143], v[120:123], v[208:211], v[128:143]
    ds_read_b64_tr_b16 v[192:193], v6 offset:0
    ds_read_b64_tr_b16 v[194:195], v6 offset:1024
    s_waitcnt lgkmcnt(6)
    v_mfma_f32_32x32x16_bf16 v[144:159], v[120:123], v[212:215], v[144:159]
    ds_read_b64_tr_b16 v[196:197], v7 offset:0
    ds_read_b64_tr_b16 v[198:199], v7 offset:1024
L100_st:
    v_min_u32 v14, v248, v249
    v_min3_u32 v14, v14, v250, v251
    v_cmp_eq_u32 vcc, 0, v14
    s_nop 1
    s_cbranch_vccnz L100_str
L101_stok:
    v_mfma_f32_32x32x16_bf16 v[160:175], v[224:227], v[248:251], 0
    v_mfma_f32_32x32x16_bf16 v[176:191], v[228:231], v[248:251], 0
    v_mfma_f32_32x32x16_bf16 v[128:143], v[226:229], v[248:251], v[128:143]
    v_mfma_f32_32x32x16_bf16 v[144:159], v[230:233], v[248:251], v[144:159]
    s_waitcnt lgkmcnt(6)
    v_mfma_f32_32x32x16_bf16 v[128:143], v[124:127], v[216:219], v[128:143]
    ds_read_b64_tr_b16 v[200:201], v6 offset:4096
    ds_read_b64_tr_b16 v[202:203], v6 offset:5120
    s_waitcnt lgkmcnt(6)
    v_mfma_f32_32x32x16_bf16 v[144:159], v[124:127], v[220:223], v[144:159]
    ds_read_b64_tr_b16 v[204:205], v7 offset:4096
    ds_read_b64_tr_b16 v[206:207], v7 offset:5120
    s_waitcnt lgkmcnt(6)
    v_mfma_f32_32x32x16_bf16 v[160:175], v[16:19], v[192:195], v[160:175]
    ds_read_b64_tr_b16 v[208:209], v6 offset:8192
    ds_read_b64_tr_b16 v[210:211], v6 offset:9216
    s_waitcnt lgkmcnt(6)
    v_mfma_f32_32x32x16_bf16 v[176:191], v[16:19], v[196:199], v[176:191]
    ds_read_b64_tr_b16 v[212:213], v7 offset:8192
    ds_read_b64_tr_b16 v[214:215], v7 offset:9216
    ds_write_b128 v12, v[128:131] offset:0
    buffer_load_dwordx4 v[16:19], v2, s[16:19], s42 offen offset:0 sc1
    s_waitcnt lgkmcnt(7)
    v_mfma_f32_32x32x16_bf16 v[160:175], v[20:23], v[200:203], v[160:175]
    ds_read_b64_tr_b16 v[216:217], v6 offset:12288
    ds_read_b64_tr_b16 v[218:219], v6 offset:13312
    ds_write_b128 v12, v[132:135] offset:1024
    s_waitcnt lgkmcnt(8)
    v_mfma_f32_32x32x16_bf16 v[176:191], v[20:23], v[204:207], v[176:191]
    ds_read_b64_tr_b16 v[220:221], v7 offset:12288
    ds_read_b64_tr_b16 v[222:223], v7 offset:13312
    ds_write_b128 v12, v[136:139] offset:2048
    buffer_load_dwordx4 v[20:23], v2, s[16:19], s42 offen offset:1024 sc1
    s_add_u32 s42, s42, 2048
    s_cmp_eq_u32 s42, s5
    s_cselect_b32 s42, s4, s42
    s_waitcnt lgkmcnt(9)
    v_mfma_f32_32x32x16_bf16 v[160:175], v[24:27], v[208:211], v[160:175]
    ds_read_b64_tr_b16 v[192:193], v6 offset:16384
    ds_read_b64_tr_b16 v[194:195], v6 offset:17408
    ds_write_b128 v12, v[140:143] offset:3072
    s_waitcnt lgkmcnt(10)
    v_mfma_f32_32x32x16_bf16 v[176:191], v[24:27], v[212:215], v[176:191]
    ds_read_b64_tr_b16 v[196:197], v7 offset:16384
    ds_read_b64_tr_b16 v[198:199], v7 offset:17408
    ds_write_b128 v12, v[144:147] offset:4096
    buffer_load_dwordx4 v[24:27], v2, s[16:19], s42 offen offset:0 sc1
    s_waitcnt lgkmcnt(10)
    v_mfma_f32_32x32x16_bf16 v[160:175], v[28:31], v[216:219], v[160:175]
    ds_read_b64_tr_b16 v[200:201], v6 offset:20480
    ds_read_b64_tr_b16 v[202:203], v6 offset:21504
    ds_write_b128 v12, v[148:151] offset:5120
    s_waitcnt lgkmcnt(10)
    v_mfma_f32_32x32x16_bf16 v[176:191], v[28:31], v[220:223], v[176:191]
    ds_read_b64_tr_b16 v[204:205], v7 offset:20480
    ds_read_b64_tr_b16 v[206:207], v7 offset:21504
    ds_write_b128 v12, v[152:155] offset:6144
    buffer_load_dwordx4 v[28:31], v2, s[16:19], s42 offen offset:1024 sc1
    s_add_u32 s42, s42, 2048
    s_cmp_eq_u32 s42, s5
    s_cselect_b32 s42, s4, s42
    s_waitcnt lgkmcnt(10)
    v_mfma_f32_32x32x16_bf16 v[160:175], v[32:35], v[192:195], v[160:175]
    ds_read_b64_tr_b16 v[208:209], v6 offset:24576
    ds_read_b64_tr_b16 v[210:211], v6 offset:25600
    ds_write_b128 v12, v[156:159] offset:7168
    s_lshr_b32 s44, s39, 8
    s_add_u32 s44, s44, 160768
    v_mov_b32 v14, s44
    v_mov_b32 v15, 1
    s_mov_b64 exec, 1
    ds_add_u32 v14, v15 offset:80
    s_mov_b64 exec, -1
    s_waitcnt lgkmcnt(11)
    v_mfma_f32_32x32x16_bf16 v[176:191], v[32:35], v[196:199], v[176:191]
    ds_read_b64_tr_b16 v[212:213], v7 offset:24576
    ds_read_b64_tr_b16 v[214:215], v7 offset:25600
    buffer_load_dwordx4 v[32:35], v2, s[16:19], s42 offen offset:0 sc1
    s_waitcnt lgkmcnt(10)
    v_mfma_f32_32x32x16_bf16 v[160:175], v[36:39], v[200:203], v[160:175]
    ds_read_b64_tr_b16 v[216:217], v6 offset:28672
    ds_read_b64_tr_b16 v[218:219], v6 offset:29696
    s_waitcnt lgkmcnt(9)
    v_mfma_f32_32x32x16_bf16 v[176:191], v[36:39], v[204:207], v[176:191]
    ds_read_b64_tr_b16 v[220:221], v7 offset:28672
    ds_read_b64_tr_b16 v[222:223], v7 offset:29696
    buffer_load_dwordx4 v[36:39], v2, s[16:19], s42 offen offset:1024 sc1
    s_add_u32 s42, s42, 2048
    s_cmp_eq_u32 s42, s5
    s_cselect_b32 s42, s4, s42
    s_waitcnt lgkmcnt(8)
    v_mfma_f32_32x32x16_bf16 v[160:175], v[40:43], v[208:211], v[160:175]
    ds_read_b64_tr_b16 v[192:193], v6 offset:32768
    ds_read_b64_tr_b16 v[194:195], v6 offset:33792
    s_waitcnt lgkmcnt(6)
    v_mfma_f32_32x32x16_bf16 v[176:191], v[40:43], v[212:215], v[176:191]
    ds_read_b64_tr_b16 v[196:197], v7 offset:32768
    ds_read_b64_tr_b16 v[198:199], v7 offset:33792
    buffer_load_dwordx4 v[40:43], v2, s[16:19], s42 offen offset:0 sc1
    s_waitcnt lgkmcnt(6)
    v_mfma_f32_32x32x16_bf16 v[160:175], v[44:47], v[216:219], v[160:175]
    ds_read_b64_tr_b16 v[200:201], v6 offset:36864
    ds_read_b64_tr_b16 v[202:203], v6 offset:37888
    s_waitcnt lgkmcnt(6)
    v_mfma_f32_32x32x16_bf16 v[176:191], v[44:47], v[220:223], v[176:191]
    ds_read_b64_tr_b16 v[204:205], v7 offset:36864
    ds_read_b64_tr_b16 v[206:207], v7 offset:37888
    buffer_load_dwordx4 v[44:47], v2, s[16:19], s42 offen offset:1024 sc1
    s_add_u32 s42, s42, 2048
    s_cmp_eq_u32 s42, s5
    s_cselect_b32 s42, s4, s42
    s_waitcnt lgkmcnt(6)
    v_mfma_f32_32x32x16_bf16 v[160:175], v[48:51], v[192:195], v[160:175]
    ds_read_b64_tr_b16 v[208:209], v6 offset:40960
    ds_read_b64_tr_b16 v[210:211], v6 offset:41984
    s_waitcnt lgkmcnt(6)
    v_mfma_f32_32x32x16_bf16 v[176:191], v[48:51], v[196:199], v[176:191]
    ds_read_b64_tr_b16 v[212:213], v7 offset:40960
    ds_read_b64_tr_b16 v[214:215], v7 offset:41984
    buffer_load_dwordx4 v[48:51], v2, s[16:19], s42 offen offset:0 sc1
    s_waitcnt lgkmcnt(6)
    v_mfma_f32_32x32x16_bf16 v[160:175], v[52:55], v[200:203], v[160:175]
    ds_read_b64_tr_b16 v[216:217], v6 offset:45056
    ds_read_b64_tr_b16 v[218:219], v6 offset:46080
    s_waitcnt lgkmcnt(6)
    v_mfma_f32_32x32x16_bf16 v[176:191], v[52:55], v[204:207], v[176:191]
    ds_read_b64_tr_b16 v[220:221], v7 offset:45056
    ds_read_b64_tr_b16 v[222:223], v7 offset:46080
    buffer_load_dwordx4 v[52:55], v2, s[16:19], s42 offen offset:1024 sc1
    s_add_u32 s42, s42, 2048
    s_cmp_eq_u32 s42, s5
    s_cselect_b32 s42, s4, s42
    s_waitcnt lgkmcnt(6)
    v_mfma_f32_32x32x16_bf16 v[160:175], v[56:59], v[208:211], v[160:175]
    ds_read_b64_tr_b16 v[192:193], v6 offset:49152
    ds_read_b64_tr_b16 v[194:195], v6 offset:50176
    s_waitcnt lgkmcnt(6)
    v_mfma_f32_32x32x16_bf16 v[176:191], v[56:59], v[212:215], v[176:191]
    ds_read_b64_tr_b16 v[196:197], v7 offset:49152
    ds_read_b64_tr_b16 v[198:199], v7 offset:50176
    buffer_load_dwordx4 v[56:59], v2, s[16:19], s42 offen offset:0 sc1
    s_waitcnt lgkmcnt(6)
    v_mfma_f32_32x32x16_bf16 v[160:175], v[60:63], v[216:219], v[160:175]
    ds_read_b64_tr_b16 v[200:201], v6 offset:53248
    ds_read_b64_tr_b16 v[202:203], v6 offset:54272
    s_waitcnt lgkmcnt(6)
    v_mfma_f32_32x32x16_bf16 v[176:191], v[60:63], v[220:223], v[176:191]
    ds_read_b64_tr_b16 v[204:205], v7 offset:53248
    ds_read_b64_tr_b16 v[206:207], v7 offset:54272
    buffer_load_dwordx4 v[60:63], v2, s[16:19], s42 offen offset:1024 sc1
    s_add_u32 s42, s42, 2048
    s_cmp_eq_u32 s42, s5
    s_cselect_b32 s42, s4, s42
    s_waitcnt lgkmcnt(6)
    v_mfma_f32_32x32x16_bf16 v[160:175], v[64:67], v[192:195], v[160:175]
    ds_read_b64_tr_b16 v[208:209], v6 offset:57344
    ds_read_b64_tr_b16 v[210:211], v6 offset:58368
    s_waitcnt lgkmcnt(6)
    v_mfma_f32_32x32x16_bf16 v[176:191], v[64:67], v[196:199], v[176:191]
    ds_read_b64_tr_b16 v[212:213], v7 offset:57344
    ds_read_b64_tr_b16 v[214:215], v7 offset:58368
    buffer_load_dwordx4 v[64:67], v2, s[16:19], s42 offen offset:0 sc1
    s_waitcnt lgkmcnt(6)
    v_mfma_f32_32x32x16_bf16 v[160:175], v[68:71], v[200:203], v[160:175]
    ds_read_b64_tr_b16 v[216:217], v6 offset:61440
    ds_read_b64_tr_b16 v[218:219], v6 offset:62464
    s_waitcnt lgkmcnt(6)
    v_mfma_f32_32x32x16_bf16 v[176:191], v[68:71], v[204:207], v[176:191]
    ds_read_b64_tr_b16 v[220:221], v7 offset:61440
    ds_read_b64_tr_b16 v[222:223], v7 offset:62464
    buffer_load_dwordx4 v[68:71], v2, s[16:19], s42 offen offset:1024 sc1
    s_add_u32 s42, s42, 2048
    s_cmp_eq_u32 s42, s5
    s_cselect_b32 s42, s4, s42
    s_waitcnt lgkmcnt(6)
    v_mfma_f32_32x32x16_bf16 v[160:175], v[72:75], v[208:211], v[160:175]
    ds_read_b64_tr_b16 v[192:193], v10 offset:0
    ds_read_b64_tr_b16 v[194:195], v10 offset:1024
    s_waitcnt lgkmcnt(6)
    v_mfma_f32_32x32x16_bf16 v[176:191], v[72:75], v[212:215], v[176:191]
    ds_read_b64_tr_b16 v[196:197], v11 offset:0
    ds_read_b64_tr_b16 v[198:199], v11 offset:1024
    buffer_load_dwordx4 v[72:75], v2, s[16:19], s42 offen offset:0 sc1
    s_waitcnt lgkmcnt(6)
    v_mfma_f32_32x32x16_bf16 v[160:175], v[76:79], v[216:219], v[160:175]
    ds_read_b64_tr_b16 v[200:201], v10 offset:4096
    ds_read_b64_tr_b16 v[202:203], v10 offset:5120
    s_waitcnt lgkmcnt(6)
    v_mfma_f32_32x32x16_bf16 v[176:191], v[76:79], v[220:223], v[176:191]
    ds_read_b64_tr_b16 v[204:205], v11 offset:4096
    ds_read_b64_tr_b16 v[206:207], v11 offset:5120
    buffer_load_dwordx4 v[76:79], v2, s[16:19], s42 offen offset:1024 sc1
    s_add_u32 s42, s42, 2048
    s_cmp_eq_u32 s42, s5
    s_cselect_b32 s42, s4, s42
    s_waitcnt lgkmcnt(6)
    v_mfma_f32_32x32x16_bf16 v[160:175], v[80:83], v[192:195], v[160:175]
    ds_read_b64_tr_b16 v[208:209], v10 offset:8192
    ds_read_b64_tr_b16 v[210:211], v10 offset:9216
    s_waitcnt lgkmcnt(6)
    v_mfma_f32_32x32x16_bf16 v[176:191], v[80:83], v[196:199], v[176:191]
    ds_read_b64_tr_b16 v[212:213], v11 offset:8192
    ds_read_b64_tr_b16 v[214:215], v11 offset:9216
    buffer_load_dwordx4 v[80:83], v2, s[16:19], s42 offen offset:0 sc1
    s_waitcnt lgkmcnt(6)
    v_mfma_f32_32x32x16_bf16 v[160:175], v[84:87], v[200:203], v[160:175]
    ds_read_b64_tr_b16 v[216:217], v10 offset:12288
    ds_read_b64_tr_b16 v[218:219], v10 offset:13312
    s_waitcnt lgkmcnt(6)
    v_mfma_f32_32x32x16_bf16 v[176:191], v[84:87], v[204:207], v[176:191]
    ds_read_b64_tr_b16 v[220:221], v11 offset:12288
    ds_read_b64_tr_b16 v[222:223], v11 offset:13312
    buffer_load_dwordx4 v[84:87], v2, s[16:19], s42 offen offset:1024 sc1
    s_add_u32 s42, s42, 2048
    s_cmp_eq_u32 s42, s5
    s_cselect_b32 s42, s4, s42
    s_waitcnt lgkmcnt(6)
    v_mfma_f32_32x32x16_bf16 v[160:175], v[88:91], v[208:211], v[160:175]
    ds_read_b64_tr_b16 v[192:193], v10 offset:16384
    ds_read_b64_tr_b16 v[194:195], v10 offset:17408
    s_waitcnt lgkmcnt(6)
    v_mfma_f32_32x32x16_bf16 v[176:191], v[88:91], v[212:215], v[176:191]
    ds_read_b64_tr_b16 v[196:197], v11 offset:16384
    ds_read_b64_tr_b16 v[198:199], v11 offset:17408
    buffer_load_dwordx4 v[88:91], v2, s[16:19], s42 offen offset:0 sc1
    s_waitcnt lgkmcnt(6)
    v_mfma_f32_32x32x16_bf16 v[160:175], v[92:95], v[216:219], v[160:175]
    ds_read_b64_tr_b16 v[200:201], v10 offset:20480
    ds_read_b64_tr_b16 v[202:203], v10 offset:21504
    s_waitcnt lgkmcnt(6)
    v_mfma_f32_32x32x16_bf16 v[176:191], v[92:95], v[220:223], v[176:191]
    ds_read_b64_tr_b16 v[204:205], v11 offset:20480
    ds_read_b64_tr_b16 v[206:207], v11 offset:21504
    buffer_load_dwordx4 v[92:95], v2, s[16:19], s42 offen offset:1024 sc1
    v_mov_b32 v14, 160768
    v_mov_b32 v15, 1
    s_mov_b64 exec, 1
    ds_add_u32 v14, v15 offset:28
    s_mov_b64 exec, -1
    s_add_u32 s42, s42, 2048
    s_cmp_eq_u32 s42, s5
    s_cselect_b32 s42, s4, s42
    s_waitcnt lgkmcnt(7)
    v_mfma_f32_32x32x16_bf16 v[160:175], v[96:99], v[192:195], v[160:175]
    ds_read_b64_tr_b16 v[208:209], v10 offset:24576
    ds_read_b64_tr_b16 v[210:211], v10 offset:25600
    s_waitcnt lgkmcnt(7)
    v_mfma_f32_32x32x16_bf16 v[176:191], v[96:99], v[196:199], v[176:191]
    ds_read_b64_tr_b16 v[212:213], v11 offset:24576
    ds_read_b64_tr_b16 v[214:215], v11 offset:25600
    buffer_load_dwordx4 v[96:99], v2, s[16:19], s42 offen offset:0 sc1
    s_waitcnt lgkmcnt(7)
    v_mfma_f32_32x32x16_bf16 v[160:175], v[100:103], v[200:203], v[160:175]
    ds_read_b64_tr_b16 v[216:217], v10 offset:28672
    ds_read_b64_tr_b16 v[218:219], v10 offset:29696
    s_waitcnt lgkmcnt(7)
    v_mfma_f32_32x32x16_bf16 v[176:191], v[100:103], v[204:207], v[176:191]
    ds_read_b64_tr_b16 v[220:221], v11 offset:28672
    ds_read_b64_tr_b16 v[222:223], v11 offset:29696
    buffer_load_dwordx4 v[100:103], v2, s[16:19], s42 offen offset:1024 sc1
    s_add_u32 s42, s42, 2048
    s_cmp_eq_u32 s42, s5
    s_cselect_b32 s42, s4, s42
    s_waitcnt lgkmcnt(6)
    v_mfma_f32_32x32x16_bf16 v[160:175], v[104:107], v[208:211], v[160:175]
    ds_read_b64_tr_b16 v[192:193], v10 offset:32768
    ds_read_b64_tr_b16 v[194:195], v10 offset:33792
    s_waitcnt lgkmcnt(6)
    v_mfma_f32_32x32x16_bf16 v[176:191], v[104:107], v[212:215], v[176:191]
    ds_read_b64_tr_b16 v[196:197], v11 offset:32768
    ds_read_b64_tr_b16 v[198:199], v11 offset:33792
    buffer_load_dwordx4 v[104:107], v2, s[16:19], s42 offen offset:0 sc1
    s_waitcnt lgkmcnt(6)
    v_mfma_f32_32x32x16_bf16 v[160:175], v[108:111], v[216:219], v[160:175]
    ds_read_b64_tr_b16 v[200:201], v10 offset:36864
    ds_read_b64_tr_b16 v[202:203], v10 offset:37888
    s_waitcnt lgkmcnt(6)
    v_mfma_f32_32x32x16_bf16 v[176:191], v[108:111], v[220:223], v[176:191]
    ds_read_b64_tr_b16 v[204:205], v11 offset:36864
    ds_read_b64_tr_b16 v[206:207], v11 offset:37888
    buffer_load_dwordx4 v[108:111], v2, s[16:19], s42 offen offset:1024 sc1
    s_add_u32 s42, s42, 2048
    s_cmp_eq_u32 s42, s5
    s_cselect_b32 s42, s4, s42
    s_waitcnt lgkmcnt(6)
    v_mfma_f32_32x32x16_bf16 v[160:175], v[112:115], v[192:195], v[160:175]
    ds_read_b64_tr_b16 v[208:209], v10 offset:40960
    ds_read_b64_tr_b16 v[210:211], v10 offset:41984
    s_waitcnt lgkmcnt(6)
    v_mfma_f32_32x32x16_bf16 v[176:191], v[112:115], v[196:199], v[176:191]
    ds_read_b64_tr_b16 v[212:213], v11 offset:40960
    ds_read_b64_tr_b16 v[214:215], v11 offset:41984
    buffer_load_dwordx4 v[112:115], v2, s[16:19], s42 offen offset:0 sc1
    s_waitcnt lgkmcnt(6)
    v_mfma_f32_32x32x16_bf16 v[160:175], v[116:119], v[200:203], v[160:175]
    ds_read_b64_tr_b16 v[216:217], v10 offset:45056
    ds_read_b64_tr_b16 v[218:219], v10 offset:46080
    s_waitcnt lgkmcnt(6)
    v_mfma_f32_32x32x16_bf16 v[176:191], v[116:119], v[204:207], v[176:191]
    ds_read_b64_tr_b16 v[220:221], v11 offset:45056
    ds_read_b64_tr_b16 v[222:223], v11 offset:46080
    buffer_load_dwordx4 v[116:119], v2, s[16:19], s42 offen offset:1024 sc1
    s_add_u32 s42, s42, 2048
    s_cmp_eq_u32 s42, s5
    s_cselect_b32 s42, s4, s42
    s_waitcnt lgkmcnt(6)
    v_mfma_f32_32x32x16_bf16 v[160:175], v[120:123], v[208:211], v[160:175]
    s_waitcnt lgkmcnt(4)
    v_mfma_f32_32x32x16_bf16 v[176:191], v[120:123], v[212:215], v[176:191]
    buffer_load_dwordx4 v[120:123], v2, s[16:19], s42 offen offset:0 sc1
    s_waitcnt lgkmcnt(2)
    v_mfma_f32_32x32x16_bf16 v[160:175], v[124:127], v[216:219], v[160:175]
    s_waitcnt lgkmcnt(0)
    v_mfma_f32_32x32x16_bf16 v[176:191], v[124:127], v[220:223], v[176:191]
    buffer_load_dwordx4 v[124:127], v2, s[16:19], s42 offen offset:1024 sc1
    v_mov_b32 v14, 160768
    v_mov_b32 v15, 1
    s_mov_b64 exec, 1
    ds_add_u32 v14, v15 offset:28
    s_mov_b64 exec, -1
    v_and_b32 v254, 0xffff0000, v250
    v_rcp_f32 v253, v254
    v_mul_f32 v254, v254, v254
    v_mul_f32 v253, 0xbfb8aa3b, v253
    v_mul_f32 v240, v160, v253
    v_mul_f32 v241, v161, v253
    v_mul_f32 v242, v162, v253
    v_mul_f32 v243, v163, v253
    v_mul_f32 v244, v164, v253
    v_mul_f32 v245, v165, v253
    v_mul_f32 v246, v166, v253
    v_mul_f32 v247, v167, v253
    v_exp_f32 v240, v240
    v_mul_f32 v160, v160, v168
    v_exp_f32 v241, v241
    v_mul_f32 v161, v161, v169
    v_exp_f32 v242, v242
    v_mul_f32 v162, v162, v170
    v_exp_f32 v243, v243
    v_mul_f32 v163, v163, v171
    v_exp_f32 v244, v244
    v_mul_f32 v164, v164, v172
    v_exp_f32 v245, v245
    v_mul_f32 v165, v165, v173
    v_exp_f32 v246, v246
    v_mul_f32 v166, v166, v174
    v_exp_f32 v247, v247
    v_mul_f32 v167, v167, v175
    v_fma_f32 v240, v240, v254, v254
    v_fma_f32 v241, v241, v254, v254
    v_fma_f32 v242, v242, v254, v254
    v_fma_f32 v243, v243, v254, v254
    v_fma_f32 v244, v244, v254, v254
    v_fma_f32 v245, v245, v254, v254
    v_fma_f32 v246, v246, v254, v254
    v_fma_f32 v247, v247, v254, v254
    v_rcp_f32 v240, v240
    v_rcp_f32 v241, v241
    v_rcp_f32 v242, v242
    v_rcp_f32 v243, v243
    v_rcp_f32 v244, v244
    v_rcp_f32 v245, v245
    v_rcp_f32 v246, v246
    v_rcp_f32 v247, v247
    v_mul_f32 v160, v160, v240
    v_mul_f32 v161, v161, v241
    v_mul_f32 v162, v162, v242
    v_mul_f32 v163, v163, v243
    v_mul_f32 v164, v164, v244
    v_mul_f32 v165, v165, v245
    v_mul_f32 v166, v166, v246
    v_mul_f32 v167, v167, v247
    v_cvt_pk_bf16_f32 v168, v160, v161
    v_cvt_pk_bf16_f32 v169, v162, v163
    v_cvt_pk_bf16_f32 v170, v164, v165
    v_cvt_pk_bf16_f32 v171, v166, v167
    s_add_u32 s44, s40, 229376
    buffer_store_dwordx4 v[168:171], v2, s[16:19], s44 offen sc1
    v_and_b32 v254, 0xffff0000, v251
    v_rcp_f32 v253, v254
    v_mul_f32 v254, v254, v254
    v_mul_f32 v253, 0xbfb8aa3b, v253
    v_mul_f32 v240, v176, v253
    v_mul_f32 v241, v177, v253
    v_mul_f32 v242, v178, v253
    v_mul_f32 v243, v179, v253
    v_mul_f32 v244, v180, v253
    v_mul_f32 v245, v181, v253
    v_mul_f32 v246, v182, v253
    v_mul_f32 v247, v183, v253
    v_exp_f32 v240, v240
    v_mul_f32 v176, v176, v184
    v_exp_f32 v241, v241
    v_mul_f32 v177, v177, v185
    v_exp_f32 v242, v242
    v_mul_f32 v178, v178, v186
    v_exp_f32 v243, v243
    v_mul_f32 v179, v179, v187
    v_exp_f32 v244, v244
    v_mul_f32 v180, v180, v188
    v_exp_f32 v245, v245
    v_mul_f32 v181, v181, v189
    v_exp_f32 v246, v246
    v_mul_f32 v182, v182, v190
    v_exp_f32 v247, v247
    v_mul_f32 v183, v183, v191
    v_fma_f32 v240, v240, v254, v254
    v_fma_f32 v241, v241, v254, v254
    v_fma_f32 v242, v242, v254, v254
    v_fma_f32 v243, v243, v254, v254
    v_fma_f32 v244, v244, v254, v254
    v_fma_f32 v245, v245, v254, v254
    v_fma_f32 v246, v246, v254, v254
    v_fma_f32 v247, v247, v254, v254
    v_rcp_f32 v240, v240
    v_rcp_f32 v241, v241
    v_rcp_f32 v242, v242
    v_rcp_f32 v243, v243
    v_rcp_f32 v244, v244
    v_rcp_f32 v245, v245
    v_rcp_f32 v246, v246
    v_rcp_f32 v247, v247
    v_mul_f32 v176, v176, v240
    v_mul_f32 v177, v177, v241
    v_mul_f32 v178, v178, v242
    v_mul_f32 v179, v179, v243
    v_mul_f32 v180, v180, v244
    v_mul_f32 v181, v181, v245
    v_mul_f32 v182, v182, v246
    v_mul_f32 v183, v183, v247
    v_cvt_pk_bf16_f32 v184, v176, v177
    v_cvt_pk_bf16_f32 v185, v178, v179
    v_cvt_pk_bf16_f32 v186, v180, v181
    v_cvt_pk_bf16_f32 v187, v182, v183
    s_add_u32 s44, s40, 344064
    buffer_store_dwordx4 v[184:187], v2, s[16:19], s44 offen sc1
    s_waitcnt vmcnt(0)
    s_mov_b64 exec, 1
    v_mov_b32 v14, 1
    buffer_atomic_add v14, off, s[16:19], s41 sc1
    s_mov_b64 exec, -1
    v_mov_b32 v12, 160768
    s_mov_b32 s47, 0x8000
L102_sp:
    ds_read_b32 v14, v12 offset:44
    s_waitcnt lgkmcnt(0)
    v_readfirstlane_b32 s48, v14
    s_nop 0
    s_cmp_ge_u32 s48, 4
    s_cbranch_scc1 L103_ok
    s_sleep 2
    s_sub_u32 s47, s47, 1
    s_cbranch_scc0 L102_sp
L103_ok:
    s_buffer_load_dword s58, s[16:19], s41 glc
    s_waitcnt lgkmcnt(0)
    s_cmp_lt_u32 s58, 3584
    s_cbranch_scc1 L104_poll
L105_pok:
    v_and_b32 v12, 31, v1
    v_lshrrev_b32 v13, 5, v1
    v_lshlrev_b32 v12, 4, v12
    v_lshl_add_u32 v12, v13, 9, v12
    s_lshl_b32 s44, s39, 4
    v_add_u32 v12, s44, v12
    v_add_u32 v15, 229376, v2
    buffer_load_dwordx4 v[192:195], v2, s[16:19], s43 offen sc1
    s_add_u32 s43, s43, 8192
    s_cmp_eq_u32 s43, s7
    s_cselect_b32 s43, s6, s43
    buffer_load_dwordx4 v[196:199], v2, s[16:19], s43 offen sc1
    s_add_u32 s43, s43, 8192
    s_cmp_eq_u32 s43, s7
    s_cselect_b32 s43, s6, s43
    s_waitcnt vmcnt(1)
    buffer_load_dwordx4 v[200:203], v2, s[16:19], s43 offen sc1
    s_add_u32 s43, s43, 8192
    s_cmp_eq_u32 s43, s7
    s_cselect_b32 s43, s6, s43
    s_buffer_load_dword s58, s[16:19], s41 glc
    buffer_load_dwordx4 v[204:207], v2, s[16:19], s43 offen sc1
    s_add_u32 s43, s43, 8192
    s_cmp_eq_u32 s43, s7
    s_cselect_b32 s43, s6, s43
    buffer_load_dwordx4 v[208:211], v2, s[16:19], s43 offen sc1
    s_add_u32 s43, s43, 8192
    s_cmp_eq_u32 s43, s7
    s_cselect_b32 s43, s6, s43
    buffer_load_dwordx4 v[212:215], v2, s[16:19], s43 offen sc1
    s_add_u32 s43, s43, 8192
    s_cmp_eq_u32 s43, s7
    s_cselect_b32 s43, s6, s43
    buffer_load_dwordx4 v[216:219], v2, s[16:19], s43 offen sc1
    s_add_u32 s43, s43, 8192
    s_cmp_eq_u32 s43, s7
    s_cselect_b32 s43, s6, s43
    buffer_load_dwordx4 v[220:223], v2, s[16:19], s43 offen sc1
    s_add_u32 s43, s43, 8192
    s_cmp_eq_u32 s43, s7
    s_cselect_b32 s43, s6, s43
    buffer_load_dwordx4 v[224:227], v2, s[16:19], s43 offen sc1
    s_add_u32 s43, s43, 8192
    s_cmp_eq_u32 s43, s7
    s_cselect_b32 s43, s6, s43
    buffer_load_dwordx4 v[228:231], v2, s[16:19], s43 offen sc1
    s_add_u32 s43, s43, 8192
    s_cmp_eq_u32 s43, s7
    s_cselect_b32 s43, s6, s43
    s_waitcnt lgkmcnt(0)
    s_cmp_lt_u32 s58, 3598
    s_cbranch_scc1 L106_poll
L107_pok:
    buffer_load_dwordx4 v[232:235], v15, s[16:19], s8 offen sc1
    s_add_u32 s8, s8, 8192
    s_cmp_eq_u32 s8, s7
    s_cselect_b32 s8, s6, s8
    buffer_load_dwordx4 v[236:239], v15, s[16:19], s8 offen sc1
    s_add_u32 s8, s8, 8192
    s_cmp_eq_u32 s8, s7
    s_cselect_b32 s8, s6, s8
    v_mfma_f32_32x32x16_bf16 v[128:143], v[16:19], v[192:195], 0
    v_mfma_f32_32x32x16_bf16 v[144:159], v[20:23], v[192:195], 0
    buffer_load_dwordx4 v[192:195], v2, s[16:19], s43 offen sc1
    s_add_u32 s43, s43, 8192
    s_cmp_eq_u32 s43, s7
    s_cselect_b32 s43, s6, s43
    s_waitcnt vmcnt(11)
    v_mfma_f32_32x32x16_bf16 v[128:143], v[24:27], v[196:199], v[128:143]
    v_mfma_f32_32x32x16_bf16 v[144:159], v[28:31], v[196:199], v[144:159]
    buffer_load_dwordx4 v[196:199], v2, s[16:19], s43 offen sc1
    s_add_u32 s43, s43, 8192
    s_cmp_eq_u32 s43, s7
    s_cselect_b32 s43, s6, s43
    s_waitcnt vmcnt(11)
    v_mfma_f32_32x32x16_bf16 v[128:143], v[32:35], v[200:203], v[128:143]
    v_mfma_f32_32x32x16_bf16 v[144:159], v[36:39], v[200:203], v[144:159]
    buffer_load_dwordx4 v[200:203], v2, s[16:19], s43 offen sc1
    s_add_u32 s43, s43, 8192
    s_cmp_eq_u32 s43, s7
    s_cselect_b32 s43, s6, s43
    s_waitcnt vmcnt(11)
    v_mfma_f32_32x32x16_bf16 v[128:143], v[40:43], v[204:207], v[128:143]
    v_mfma_f32_32x32x16_bf16 v[144:159], v[44:47], v[204:207], v[144:159]
    buffer_load_dwordx4 v[204:207], v2, s[16:19], s43 offen sc1
    s_waitcnt vmcnt(11)
    v_mfma_f32_32x32x16_bf16 v[128:143], v[48:51], v[208:211], v[128:143]
    v_mfma_f32_32x32x16_bf16 v[144:159], v[52:55], v[208:211], v[144:159]
    buffer_load_dwordx4 v[208:211], v15, s[16:19], s8 offen sc1
    s_add_u32 s8, s8, 8192
    s_cmp_eq_u32 s8, s7
    s_cselect_b32 s8, s6, s8
    s_waitcnt vmcnt(11)
    v_mfma_f32_32x32x16_bf16 v[128:143], v[56:59], v[212:215], v[128:143]
    v_mfma_f32_32x32x16_bf16 v[144:159], v[60:63], v[212:215], v[144:159]
    buffer_load_dwordx4 v[212:215], v15, s[16:19], s8 offen sc1
    s_add_u32 s8, s8, 8192
    s_cmp_eq_u32 s8, s7
    s_cselect_b32 s8, s6, s8
    s_waitcnt vmcnt(11)
    v_mfma_f32_32x32x16_bf16 v[128:143], v[64:67], v[216:219], v[128:143]
    v_mfma_f32_32x32x16_bf16 v[144:159], v[68:71], v[216:219], v[144:159]
    buffer_load_dwordx4 v[216:219], v15, s[16:19], s8 offen sc1
    s_add_u32 s8, s8, 8192
    s_cmp_eq_u32 s8, s7
    s_cselect_b32 s8, s6, s8
    s_waitcnt vmcnt(11)
    v_mfma_f32_32x32x16_bf16 v[128:143], v[72:75], v[220:223], v[128:143]
    v_mfma_f32_32x32x16_bf16 v[144:159], v[76:79], v[220:223], v[144:159]
    buffer_load_dwordx4 v[220:223], v15, s[16:19], s8 offen sc1
    s_add_u32 s8, s8, 8192
    s_cmp_eq_u32 s8, s7
    s_cselect_b32 s8, s6, s8
    s_waitcnt vmcnt(11)
    v_mfma_f32_32x32x16_bf16 v[128:143], v[80:83], v[224:227], v[128:143]
    v_mfma_f32_32x32x16_bf16 v[144:159], v[84:87], v[224:227], v[144:159]
    buffer_load_dwordx4 v[224:227], v15, s[16:19], s8 offen sc1
    s_add_u32 s8, s8, 8192
    s_cmp_eq_u32 s8, s7
    s_cselect_b32 s8, s6, s8
    s_waitcnt vmcnt(11)
    v_mfma_f32_32x32x16_bf16 v[128:143], v[88:91], v[228:231], v[128:143]
    v_mfma_f32_32x32x16_bf16 v[144:159], v[92:95], v[228:231], v[144:159]
    buffer_load_dwordx4 v[228:231], v15, s[16:19], s8 offen sc1
    s_add_u32 s8, s8, 8192
    s_cmp_eq_u32 s8, s7
    s_cselect_b32 s8, s6, s8
    s_waitcnt vmcnt(11)
    v_mfma_f32_32x32x16_bf16 v[160:175], v[16:19], v[232:235], 0
    v_mfma_f32_32x32x16_bf16 v[176:191], v[20:23], v[232:235], 0
    buffer_load_dwordx4 v[232:235], v15, s[16:19], s8 offen sc1
    s_add_u32 s8, s8, 8192
    s_cmp_eq_u32 s8, s7
    s_cselect_b32 s8, s6, s8
    s_waitcnt vmcnt(11)
    v_mfma_f32_32x32x16_bf16 v[160:175], v[24:27], v[236:239], v[160:175]
    v_mfma_f32_32x32x16_bf16 v[176:191], v[28:31], v[236:239], v[176:191]
    buffer_load_dwordx4 v[236:239], v15, s[16:19], s8 offen sc1
    s_add_u32 s8, s8, 8192
    s_cmp_eq_u32 s8, s7
    s_cselect_b32 s8, s6, s8
    s_waitcnt vmcnt(11)
    v_mfma_f32_32x32x16_bf16 v[128:143], v[96:99], v[192:195], v[128:143]
    v_mfma_f32_32x32x16_bf16 v[144:159], v[100:103], v[192:195], v[144:159]
    buffer_load_dwordx4 v[192:195], v15, s[16:19], s8 offen sc1
    s_add_u32 s8, s8, 8192
    s_cmp_eq_u32 s8, s7
    s_cselect_b32 s8, s6, s8
    s_waitcnt vmcnt(11)
    v_mfma_f32_32x32x16_bf16 v[128:143], v[104:107], v[196:199], v[128:143]
    v_mfma_f32_32x32x16_bf16 v[144:159], v[108:111], v[196:199], v[144:159]
    buffer_load_dwordx4 v[196:199], v15, s[16:19], s8 offen sc1
    s_add_u32 s8, s8, 8192
    s_cmp_eq_u32 s8, s7
    s_cselect_b32 s8, s6, s8
    s_waitcnt vmcnt(11)
    v_mfma_f32_32x32x16_bf16 v[128:143], v[112:115], v[200:203], v[128:143]
    v_mfma_f32_32x32x16_bf16 v[144:159], v[116:119], v[200:203], v[144:159]
    buffer_load_dwordx4 v[200:203], v15, s[16:19], s8 offen sc1
    s_add_u32 s8, s8, 8192
    s_cmp_eq_u32 s8, s7
    s_cselect_b32 s8, s6, s8
    s_waitcnt vmcnt(11)
    v_mfma_f32_32x32x16_bf16 v[128:143], v[120:123], v[204:207], v[128:143]
    v_mfma_f32_32x32x16_bf16 v[144:159], v[124:127], v[204:207], v[144:159]
    buffer_load_dwordx4 v[204:207], v15, s[16:19], s8 offen sc1
    v_mov_b32 v242, 160768
    s_mov_b32 s47, 0x8000
L108_sp:
    ds_read_b32 v243, v242 offset:28
    s_waitcnt lgkmcnt(0)
    v_readfirstlane_b32 s48, v243
    s_nop 0
    s_cmp_ge_u32 s48, 8
    s_cbranch_scc1 L109_ok
    s_sleep 1
    s_sub_u32 s47, s47, 1
    s_cbranch_scc0 L108_sp
L109_ok:
    s_waitcnt vmcnt(11)
    v_mfma_f32_32x32x16_bf16 v[160:175], v[32:35], v[208:211], v[160:175]
    v_mfma_f32_32x32x16_bf16 v[176:191], v[36:39], v[208:211], v[176:191]
    s_waitcnt vmcnt(10)
    v_mfma_f32_32x32x16_bf16 v[160:175], v[40:43], v[212:215], v[160:175]
    v_xor_b32 v13, 0, v12
    ds_write_b128 v13, v[128:131] offset:0
    v_mfma_f32_32x32x16_bf16 v[176:191], v[44:47], v[212:215], v[176:191]
    v_xor_b32 v14, 32, v12
    ds_write_b128 v14, v[132:135] offset:1024
    s_waitcnt vmcnt(9)
    v_mfma_f32_32x32x16_bf16 v[160:175], v[48:51], v[216:219], v[160:175]
    v_xor_b32 v13, 64, v12
    ds_write_b128 v13, v[136:139] offset:2048
    v_mfma_f32_32x32x16_bf16 v[176:191], v[52:55], v[216:219], v[176:191]
    v_xor_b32 v14, 96, v12
    ds_write_b128 v14, v[140:143] offset:3072
    s_waitcnt vmcnt(8)
    v_mfma_f32_32x32x16_bf16 v[160:175], v[56:59], v[220:223], v[160:175]
    v_xor_b32 v13, 128, v12
    ds_write_b128 v13, v[144:147] offset:4096
    v_mfma_f32_32x32x16_bf16 v[176:191], v[60:63], v[220:223], v[176:191]
    v_xor_b32 v14, 160, v12
    ds_write_b128 v14, v[148:151] offset:5120
    s_waitcnt vmcnt(7)
    v_mfma_f32_32x32x16_bf16 v[160:175], v[64:67], v[224:227], v[160:175]
    v_xor_b32 v13, 192, v12
    ds_write_b128 v13, v[152:155] offset:6144
    v_mfma_f32_32x32x16_bf16 v[176:191], v[68:71], v[224:227], v[176:191]
    v_xor_b32 v14, 224, v12
    ds_write_b128 v14, v[156:159] offset:7168
    s_waitcnt vmcnt(6)
    v_mfma_f32_32x32x16_bf16 v[160:175], v[72:75], v[228:231], v[160:175]
    v_mfma_f32_32x32x16_bf16 v[176:191], v[76:79], v[228:231], v[176:191]
    s_waitcnt vmcnt(5)
    v_mfma_f32_32x32x16_bf16 v[160:175], v[80:83], v[232:235], v[160:175]
    v_mfma_f32_32x32x16_bf16 v[176:191], v[84:87], v[232:235], v[176:191]
    s_waitcnt vmcnt(4)
    v_mfma_f32_32x32x16_bf16 v[160:175], v[88:91], v[236:239], v[160:175]
    v_mfma_f32_32x32x16_bf16 v[176:191], v[92:95], v[236:239], v[176:191]
    s_waitcnt vmcnt(3)
    v_mfma_f32_32x32x16_bf16 v[160:175], v[96:99], v[192:195], v[160:175]
    v_mfma_f32_32x32x16_bf16 v[176:191], v[100:103], v[192:195], v[176:191]
    s_waitcnt lgkmcnt(0)
    s_barrier
    s_waitcnt vmcnt(2)
    v_mfma_f32_32x32x16_bf16 v[160:175], v[104:107], v[196:199], v[160:175]
    v_mfma_f32_32x32x16_bf16 v[176:191], v[108:111], v[196:199], v[176:191]
    s_waitcnt vmcnt(1)
    v_mfma_f32_32x32x16_bf16 v[160:175], v[112:115], v[200:203], v[160:175]
    v_mfma_f32_32x32x16_bf16 v[176:191], v[116:119], v[200:203], v[176:191]
    s_waitcnt vmcnt(0)
    v_mfma_f32_32x32x16_bf16 v[160:175], v[120:123], v[204:207], v[160:175]
    v_mfma_f32_32x32x16_bf16 v[176:191], v[124:127], v[204:207], v[176:191]
    v_xor_b32 v13, 0, v12
    s_nop 9
    ds_write_b128 v13, v[160:163] offset:8192
    v_xor_b32 v14, 32, v12
    ds_write_b128 v14, v[164:167] offset:9216
    v_xor_b32 v13, 64, v12
    ds_write_b128 v13, v[168:171] offset:10240
    v_xor_b32 v14, 96, v12
    ds_write_b128 v14, v[172:175] offset:11264
    v_xor_b32 v13, 128, v12
    ds_write_b128 v13, v[176:179] offset:12288
    v_xor_b32 v14, 160, v12
    ds_write_b128 v14, v[180:183] offset:13312
    v_xor_b32 v13, 192, v12
    ds_write_b128 v13, v[184:187] offset:14336
    v_xor_b32 v14, 224, v12
    ds_write_b128 v14, v[188:191] offset:15360
    s_waitcnt lgkmcnt(0)
    s_barrier
    s_endpgm
k_statY:
    v_lshrrev_b32 v3, 3, v1
    v_mul_u32_u24 v3, 896, v3
    v_and_b32 v6, 7, v1
    v_lshl_add_u32 v3, v6, 4, v3
    v_mov_b32 v167, 1
    s_lshr_b32 s44, s31, 3
    s_and_b32 s45, s31, 1
    s_lshl_b32 s45, s45, 3
    s_bfe_u32 s48, s31, 0x10001
    s_bfe_u32 s49, s31, 0x10002
    s_lshl_b32 s50, s48, 1
    s_add_u32 s50, s50, s49
    s_lshl_b32 s46, s44, 4
    s_add_u32 s46, s46, s45
    s_add_u32 s46, s46, s30
    s_lshl_b32 s46, s46, 2
    s_add_u32 s46, s46, s50
    s_mul_i32 s46, s46, 7168
    s_waitcnt lgkmcnt(0)
    buffer_load_dwordx4 v[128:131], v3, s[20:23], s46 offen offset:0 nt
    buffer_load_dwordx4 v[132:135], v3, s[20:23], s46 offen offset:128 nt
    buffer_load_dwordx4 v[136:139], v3, s[20:23], s46 offen offset:256 nt
    buffer_load_dwordx4 v[140:143], v3, s[20:23], s46 offen offset:384 nt
    buffer_load_dwordx4 v[144:147], v3, s[20:23], s46 offen offset:512 nt
    buffer_load_dwordx4 v[148:151], v3, s[20:23], s46 offen offset:640 nt
    buffer_load_dwordx4 v[152:155], v3, s[20:23], s46 offen offset:768 nt
    s_barrier
    s_bfe_u32 s48, s31, 0x20001
    s_lshl_b32 s48, s48, 4
    s_add_u32 s45, s45, s48
    s_lshl_b32 s45, s45, 4
    s_lshl_b32 s44, s44, 11
    s_add_u32 s45, s45, s44
    s_add_u32 s45, s45, 20971520
    s_lshl_b32 s48, s30, 4
    s_add_u32 s48, s48, 29504
    v_lshrrev_b32 v164, 5, v1
    v_lshl_add_u32 v164, v164, 7, s48
    v_bfe_u32 v165, v1, 3, 2
    v_lshl_add_u32 v164, v165, 2, v164
    s_mov_b32 s49, 0x3f803f80
    v_mov_b32 v160, 0
    v_mov_b32 v161, 0
    v_mov_b32 v162, 0
    v_mov_b32 v163, 0
    s_waitcnt vmcnt(6)
    v_dot2c_f32_bf16 v160, s49, v128
    v_dot2c_f32_bf16 v162, v128, v128
    v_dot2c_f32_bf16 v161, s49, v129
    v_dot2c_f32_bf16 v163, v129, v129
    v_dot2c_f32_bf16 v160, s49, v130
    v_dot2c_f32_bf16 v162, v130, v130
    v_dot2c_f32_bf16 v161, s49, v131
    v_dot2c_f32_bf16 v163, v131, v131
    s_waitcnt vmcnt(5)
    v_dot2c_f32_bf16 v160, s49, v132
    v_dot2c_f32_bf16 v162, v132, v132
    v_dot2c_f32_bf16 v161, s49, v133
    v_dot2c_f32_bf16 v163, v133, v133
    v_dot2c_f32_bf16 v160, s49, v134
    v_dot2c_f32_bf16 v162, v134, v134
    v_dot2c_f32_bf16 v161, s49, v135
    v_dot2c_f32_bf16 v163, v135, v135
    s_waitcnt vmcnt(4)
    v_dot2c_f32_bf16 v160, s49, v136
    v_dot2c_f32_bf16 v162, v136, v136
    v_dot2c_f32_bf16 v161, s49, v137
    v_dot2c_f32_bf16 v163, v137, v137
    v_dot2c_f32_bf16 v160, s49, v138
    v_dot2c_f32_bf16 v162, v138, v138
    v_dot2c_f32_bf16 v161, s49, v139
    v_dot2c_f32_bf16 v163, v139, v139
    s_waitcnt vmcnt(3)
    v_dot2c_f32_bf16 v160, s49, v140
    v_dot2c_f32_bf16 v162, v140, v140
    v_dot2c_f32_bf16 v161, s49, v141
    v_dot2c_f32_bf16 v163, v141, v141
    v_dot2c_f32_bf16 v160, s49, v142
    v_dot2c_f32_bf16 v162, v142, v142
    v_dot2c_f32_bf16 v161, s49, v143
    v_dot2c_f32_bf16 v163, v143, v143
    s_waitcnt vmcnt(2)
    v_dot2c_f32_bf16 v160, s49, v144
    v_dot2c_f32_bf16 v162, v144, v144
    v_dot2c_f32_bf16 v161, s49, v145
    v_dot2c_f32_bf16 v163, v145, v145
    v_dot2c_f32_bf16 v160, s49, v146
    v_dot2c_f32_bf16 v162, v146, v146
    v_dot2c_f32_bf16 v161, s49, v147
    v_dot2c_f32_bf16 v163, v147, v147
    s_waitcnt vmcnt(1)
    v_dot2c_f32_bf16 v160, s49, v148
    v_dot2c_f32_bf16 v162, v148, v148
    v_dot2c_f32_bf16 v161, s49, v149
    v_dot2c_f32_bf16 v163, v149, v149
    v_dot2c_f32_bf16 v160, s49, v150
    v_dot2c_f32_bf16 v162, v150, v150
    v_dot2c_f32_bf16 v161, s49, v151
    v_dot2c_f32_bf16 v163, v151, v151
    s_waitcnt vmcnt(0)
    v_dot2c_f32_bf16 v160, s49, v152
    v_dot2c_f32_bf16 v162, v152, v152
    v_dot2c_f32_bf16 v161, s49, v153
    v_dot2c_f32_bf16 v163, v153, v153
    v_dot2c_f32_bf16 v160, s49, v154
    v_dot2c_f32_bf16 v162, v154, v154
    v_dot2c_f32_bf16 v161, s49, v155
    v_dot2c_f32_bf16 v163, v155, v155
    s_nop 1
    v_add_f32 v160, v160, v161
    v_add_f32 v162, v162, v163
    s_nop 0
    v_add_f32_dpp v160, v160, v160 quad_perm:[1,0,3,2] row_mask:0xf bank_mask:0xf
    v_add_f32_dpp v162, v162, v162 quad_perm:[1,0,3,2] row_mask:0xf bank_mask:0xf
    s_nop 0
    v_add_f32_dpp v160, v160, v160 quad_perm:[2,3,0,1] row_mask:0xf bank_mask:0xf
    v_add_f32_dpp v162, v162, v162 quad_perm:[2,3,0,1] row_mask:0xf bank_mask:0xf
    s_nop 0
    v_add_f32_dpp v160, v160, v160 row_half_mirror row_mask:0xf bank_mask:0xf
    v_add_f32_dpp v162, v162, v162 row_half_mirror row_mask:0xf bank_mask:0xf
    v_mul_f32 v163, 0x3b124925, v160
    v_mul_f32 v160, 0x3b124925, v162
    v_fma_f32 v160, -v163, v163, v160
    v_max_f32 v160, 0, v160
    v_cvt_pk_bf16_f32 v160, v160, v160
    v_lshlrev_b32 v160, 16, v160
    v_add_f32 v160, 0x3727c5ac, v160
    v_cvt_pk_bf16_f32 v160, v160, v160
    v_lshlrev_b32 v160, 16, v160
    v_sqrt_f32 v160, v160
    s_mov_b32 exec_lo, 0x01010101
    s_mov_b32 exec_hi, 0x01010101
    v_cvt_pk_bf16_f32 v160, v163, v160
    ds_write_b32 v164, v160
    s_mov_b64 exec, 1
    ds_add_u32 v13, v167 offset:48
    s_mov_b64 exec, -1
    s_branch k_yj
k_lp:
    v_mov_b32 v224, -1
    v_mov_b32 v225, -1
    v_mov_b32 v226, -1
    v_mov_b32 v227, -1
    buffer_store_dwordx4 v[224:227], v2, s[16:19], s39 offen sc1
    buffer_store_dwordx4 v[224:227], v2, s[16:19], s39 offen offset:1024 sc1
    s_branch k_lpr
k_le:
    v_mov_b32 v15, 1
    s_waitcnt vmcnt(4)
    s_mov_b64 exec, 1
    ds_add_rtn_u32 v14, v13, v15 offset:0
    s_waitcnt lgkmcnt(0)
    v_readfirstlane_b32 s48, v14
    s_nop 0
    s_cmp_lg_u32 s48, 3
    s_cbranch_scc1 L110_la
    buffer_store_byte v15, v246, s[24:27], s29 offen offset:200 sc1
L110_la:
    s_mov_b64 exec, -1
    s_sub_u32 s48, s39, 20971520
    s_lshr_b32 s48, s48, 1
    s_add_u32 s49, s48, 21037056
    buffer_store_dwordx4 v[224:227], v2, s[16:19], s49 offen sc1
    s_add_u32 s49, s48, 21069824
    buffer_store_dwordx4 v[224:227], v2, s[16:19], s49 offen sc1
    s_branch k_ler
L62_flg:
    s_sleep 16
    s_mov_b64 exec, 1
    buffer_load_dwordx2 v[236:237], v246, s[24:27], 0 offen offset:160 sc1
    s_waitcnt vmcnt(0)
    v_and_b32 v236, v236, v237
    v_cmp_eq_u32 vcc, 0x01010101, v236
    s_nop 1
    v_cndmask_b32 v236, 0, v236, vcc
    s_mov_b64 exec, -1
    s_branch L63_flr
L67_hcr:
    s_cmp_eq_u32 s47, 0
    s_cbranch_scc1 L68_hok
    s_sub_u32 s47, s47, 1
    s_sleep 2
    s_add_u32 m0, s39, 0
    s_add_u32 s38, s52, s92
    buffer_load_dwordx4 v3, s[16:19], s38 offen sc1 lds
    s_add_u32 m0, s39, 4096
    s_add_u32 s38, s53, s92
    buffer_load_dwordx4 v3, s[16:19], s38 offen sc1 lds
    s_add_u32 m0, s39, 8192
    s_add_u32 s38, s54, s92
    buffer_load_dwordx4 v3, s[16:19], s38 offen sc1 lds
    s_add_u32 m0, s39, 12288
    s_add_u32 s38, s55, s92
    buffer_load_dwordx4 v3, s[16:19], s38 offen sc1 lds
    s_add_u32 m0, s39, 16384
    s_add_u32 s38, s52, s93
    buffer_load_dwordx4 v3, s[16:19], s38 offen sc1 lds
    s_add_u32 m0, s39, 20480
    s_add_u32 s38, s53, s93
    buffer_load_dwordx4 v3, s[16:19], s38 offen sc1 lds
    s_add_u32 m0, s39, 24576
    s_add_u32 s38, s54, s93
    buffer_load_dwordx4 v3, s[16:19], s38 offen sc1 lds
    s_add_u32 m0, s39, 28672
    s_add_u32 s38, s55, s93
    buffer_load_dwordx4 v3, s[16:19], s38 offen sc1 lds
    s_add_u32 m0, s39, 32768
    s_add_u32 s38, s52, s94
    buffer_load_dwordx4 v3, s[16:19], s38 offen sc1 lds
    s_add_u32 m0, s39, 36864
    s_add_u32 s38, s53, s94
    buffer_load_dwordx4 v3, s[16:19], s38 offen sc1 lds
    s_waitcnt vmcnt(9)
    ds_read_b32 v240, v12 offset:0
    s_branch L67_hc
L69_hcr:
    s_cmp_eq_u32 s47, 0
    s_cbranch_scc1 L70_hok
    s_sub_u32 s47, s47, 1
    s_sleep 2
    s_add_u32 m0, s39, 4096
    s_add_u32 s38, s53, s92
    buffer_load_dwordx4 v3, s[16:19], s38 offen sc1 lds
    s_add_u32 m0, s39, 8192
    s_add_u32 s38, s54, s92
    buffer_load_dwordx4 v3, s[16:19], s38 offen sc1 lds
    s_add_u32 m0, s39, 12288
    s_add_u32 s38, s55, s92
    buffer_load_dwordx4 v3, s[16:19], s38 offen sc1 lds
    s_add_u32 m0, s39, 16384
    s_add_u32 s38, s52, s93
    buffer_load_dwordx4 v3, s[16:19], s38 offen sc1 lds
    s_add_u32 m0, s39, 20480
    s_add_u32 s38, s53, s93
    buffer_load_dwordx4 v3, s[16:19], s38 offen sc1 lds
    s_add_u32 m0, s39, 24576
    s_add_u32 s38, s54, s93
    buffer_load_dwordx4 v3, s[16:19], s38 offen sc1 lds
    s_add_u32 m0, s39, 28672
    s_add_u32 s38, s55, s93
    buffer_load_dwordx4 v3, s[16:19], s38 offen sc1 lds
    s_add_u32 m0, s39, 32768
    s_add_u32 s38, s52, s94
    buffer_load_dwordx4 v3, s[16:19], s38 offen sc1 lds
    s_add_u32 m0, s39, 36864
    s_add_u32 s38, s53, s94
    buffer_load_dwordx4 v3, s[16:19], s38 offen sc1 lds
    s_add_u32 m0, s39, 40960
    s_add_u32 s38, s54, s94
    buffer_load_dwordx4 v3, s[16:19], s38 offen sc1 lds
    s_add_u32 m0, s39, 45056
    s_add_u32 s38, s55, s94
    buffer_load_dwordx4 v3, s[16:19], s38 offen sc1 lds
    s_add_u32 m0, s39, 49152
    s_add_u32 s38, s52, s95
    buffer_load_dwordx4 v3, s[16:19], s38 offen sc1 lds
    s_add_u32 m0, s39, 53248
    s_add_u32 s38, s53, s95
    buffer_load_dwordx4 v3, s[16:19], s38 offen sc1 lds
    s_waitcnt vmcnt(12)
    ds_read_b32 v240, v12 offset:4096
    s_branch L69_hc
L71_hcr:
    s_cmp_eq_u32 s47, 0
    s_cbranch_scc1 L72_hok
    s_sub_u32 s47, s47, 1
    s_sleep 2
    s_add_u32 m0, s39, 8192
    s_add_u32 s38, s54, s92
    buffer_load_dwordx4 v3, s[16:19], s38 offen sc1 lds
    s_add_u32 m0, s39, 12288
    s_add_u32 s38, s55, s92
    buffer_load_dwordx4 v3, s[16:19], s38 offen sc1 lds
    s_add_u32 m0, s39, 16384
    s_add_u32 s38, s52, s93
    buffer_load_dwordx4 v3, s[16:19], s38 offen sc1 lds
    s_add_u32 m0, s39, 20480
    s_add_u32 s38, s53, s93
    buffer_load_dwordx4 v3, s[16:19], s38 offen sc1 lds
    s_add_u32 m0, s39, 24576
    s_add_u32 s38, s54, s93
    buffer_load_dwordx4 v3, s[16:19], s38 offen sc1 lds
    s_add_u32 m0, s39, 28672
    s_add_u32 s38, s55, s93
    buffer_load_dwordx4 v3, s[16:19], s38 offen sc1 lds
    s_add_u32 m0, s39, 32768
    s_add_u32 s38, s52, s94
    buffer_load_dwordx4 v3, s[16:19], s38 offen sc1 lds
    s_add_u32 m0, s39, 36864
    s_add_u32 s38, s53, s94
    buffer_load_dwordx4 v3, s[16:19], s38 offen sc1 lds
    s_add_u32 m0, s39, 40960
    s_add_u32 s38, s54, s94
    buffer_load_dwordx4 v3, s[16:19], s38 offen sc1 lds
    s_add_u32 m0, s39, 45056
    s_add_u32 s38, s55, s94
    buffer_load_dwordx4 v3, s[16:19], s38 offen sc1 lds
    s_add_u32 m0, s39, 49152
    s_add_u32 s38, s52, s95
    buffer_load_dwordx4 v3, s[16:19], s38 offen sc1 lds
    s_add_u32 m0, s39, 53248
    s_add_u32 s38, s53, s95
    buffer_load_dwordx4 v3, s[16:19], s38 offen sc1 lds
    s_add_u32 m0, s39, 57344
    s_add_u32 s38, s54, s95
    buffer_load_dwordx4 v3, s[16:19], s38 offen sc1 lds
    s_add_u32 m0, s39, 61440
    s_add_u32 s38, s55, s95
    buffer_load_dwordx4 v3, s[16:19], s38 offen sc1 lds
    s_waitcnt vmcnt(12)
    ds_read_b32 v240, v12 offset:8192
    ds_read_b32 v241, v12 offset:12288
    s_branch L71_hc
L73_hcr:
    s_cmp_eq_u32 s47, 0
    s_cbranch_scc1 L74_hok
    s_sub_u32 s47, s47, 1
    s_sleep 2
    s_add_u32 m0, s39, 16384
    s_add_u32 s38, s52, s93
    buffer_load_dwordx4 v3, s[16:19], s38 offen sc1 lds
    s_add_u32 m0, s39, 20480
    s_add_u32 s38, s53, s93
    buffer_load_dwordx4 v3, s[16:19], s38 offen sc1 lds
    s_add_u32 m0, s39, 24576
    s_add_u32 s38, s54, s93
    buffer_load_dwordx4 v3, s[16:19], s38 offen sc1 lds
    s_add_u32 m0, s39, 28672
    s_add_u32 s38, s55, s93
    buffer_load_dwordx4 v3, s[16:19], s38 offen sc1 lds
    s_add_u32 m0, s39, 32768
    s_add_u32 s38, s52, s94
    buffer_load_dwordx4 v3, s[16:19], s38 offen sc1 lds
    s_add_u32 m0, s39, 36864
    s_add_u32 s38, s53, s94
    buffer_load_dwordx4 v3, s[16:19], s38 offen sc1 lds
    s_add_u32 m0, s39, 40960
    s_add_u32 s38, s54, s94
    buffer_load_dwordx4 v3, s[16:19], s38 offen sc1 lds
    s_add_u32 m0, s39, 45056
    s_add_u32 s38, s55, s94
    buffer_load_dwordx4 v3, s[16:19], s38 offen sc1 lds
    s_add_u32 m0, s39, 49152
    s_add_u32 s38, s52, s95
    buffer_load_dwordx4 v3, s[16:19], s38 offen sc1 lds
    s_add_u32 m0, s39, 53248
    s_add_u32 s38, s53, s95
    buffer_load_dwordx4 v3, s[16:19], s38 offen sc1 lds
    s_add_u32 m0, s39, 57344
    s_add_u32 s38, s54, s95
    buffer_load_dwordx4 v3, s[16:19], s38 offen sc1 lds
    s_add_u32 m0, s39, 61440
    s_add_u32 s38, s55, s95
    buffer_load_dwordx4 v3, s[16:19], s38 offen sc1 lds
    s_add_u32 m0, s39, 65536
    s_add_u32 s38, s52, s96
    buffer_load_dwordx4 v3, s[16:19], s38 offen sc1 lds
    s_add_u32 m0, s39, 69632
    s_add_u32 s38, s53, s96
    buffer_load_dwordx4 v3, s[16:19], s38 offen sc1 lds
    s_waitcnt vmcnt(12)
    ds_read_b32 v240, v12 offset:16384
    ds_read_b32 v241, v12 offset:20480
    s_branch L73_hc
L75_hcr:
    s_cmp_eq_u32 s47, 0
    s_cbranch_scc1 L76_hok
    s_sub_u32 s47, s47, 1
    s_sleep 2
    s_add_u32 m0, s39, 24576
    s_add_u32 s38, s54, s93
    buffer_load_dwordx4 v3, s[16:19], s38 offen sc1 lds
    s_add_u32 m0, s39, 28672
    s_add_u32 s38, s55, s93
    buffer_load_dwordx4 v3, s[16:19], s38 offen sc1 lds
    s_add_u32 m0, s39, 32768
    s_add_u32 s38, s52, s94
    buffer_load_dwordx4 v3, s[16:19], s38 offen sc1 lds
    s_add_u32 m0, s39, 36864
    s_add_u32 s38, s53, s94
    buffer_load_dwordx4 v3, s[16:19], s38 offen sc1 lds
    s_add_u32 m0, s39, 40960
    s_add_u32 s38, s54, s94
    buffer_load_dwordx4 v3, s[16:19], s38 offen sc1 lds
    s_add_u32 m0, s39, 45056
    s_add_u32 s38, s55, s94
    buffer_load_dwordx4 v3, s[16:19], s38 offen sc1 lds
    s_add_u32 m0, s39, 49152
    s_add_u32 s38, s52, s95
    buffer_load_dwordx4 v3, s[16:19], s38 offen sc1 lds
    s_add_u32 m0, s39, 53248
    s_add_u32 s38, s53, s95
    buffer_load_dwordx4 v3, s[16:19], s38 offen sc1 lds
    s_add_u32 m0, s39, 57344
    s_add_u32 s38, s54, s95
    buffer_load_dwordx4 v3, s[16:19], s38 offen sc1 lds
    s_add_u32 m0, s39, 61440
    s_add_u32 s38, s55, s95
    buffer_load_dwordx4 v3, s[16:19], s38 offen sc1 lds
    s_add_u32 m0, s39, 65536
    s_add_u32 s38, s52, s96
    buffer_load_dwordx4 v3, s[16:19], s38 offen sc1 lds
    s_add_u32 m0, s39, 69632
    s_add_u32 s38, s53, s96
    buffer_load_dwordx4 v3, s[16:19], s38 offen sc1 lds
    s_add_u32 m0, s39, 73728
    s_add_u32 s38, s54, s96
    buffer_load_dwordx4 v3, s[16:19], s38 offen sc1 lds
    s_add_u32 m0, s39, 77824
    s_add_u32 s38, s55, s96
    buffer_load_dwordx4 v3, s[16:19], s38 offen sc1 lds
    s_waitcnt vmcnt(12)
    ds_read_b32 v240, v12 offset:24576
    ds_read_b32 v241, v12 offset:28672
    s_branch L75_hc
L77_hcr:
    s_cmp_eq_u32 s47, 0
    s_cbranch_scc1 L78_hok
    s_sub_u32 s47, s47, 1
    s_sleep 2
    s_add_u32 m0, s39, 32768
    s_add_u32 s38, s52, s94
    buffer_load_dwordx4 v3, s[16:19], s38 offen sc1 lds
    s_add_u32 m0, s39, 36864
    s_add_u32 s38, s53, s94
    buffer_load_dwordx4 v3, s[16:19], s38 offen sc1 lds
    s_add_u32 m0, s39, 40960
    s_add_u32 s38, s54, s94
    buffer_load_dwordx4 v3, s[16:19], s38 offen sc1 lds
    s_add_u32 m0, s39, 45056
    s_add_u32 s38, s55, s94
    buffer_load_dwordx4 v3, s[16:19], s38 offen sc1 lds
    s_add_u32 m0, s39, 49152
    s_add_u32 s38, s52, s95
    buffer_load_dwordx4 v3, s[16:19], s38 offen sc1 lds
    s_add_u32 m0, s39, 53248
    s_add_u32 s38, s53, s95
    buffer_load_dwordx4 v3, s[16:19], s38 offen sc1 lds
    s_add_u32 m0, s39, 57344
    s_add_u32 s38, s54, s95
    buffer_load_dwordx4 v3, s[16:19], s38 offen sc1 lds
    s_add_u32 m0, s39, 61440
    s_add_u32 s38, s55, s95
    buffer_load_dwordx4 v3, s[16:19], s38 offen sc1 lds
    s_add_u32 m0, s39, 65536
    s_add_u32 s38, s52, s96
    buffer_load_dwordx4 v3, s[16:19], s38 offen sc1 lds
    s_add_u32 m0, s39, 69632
    s_add_u32 s38, s53, s96
    buffer_load_dwordx4 v3, s[16:19], s38 offen sc1 lds
    s_add_u32 m0, s39, 73728
    s_add_u32 s38, s54, s96
    buffer_load_dwordx4 v3, s[16:19], s38 offen sc1 lds
    s_add_u32 m0, s39, 77824
    s_add_u32 s38, s55, s96
    buffer_load_dwordx4 v3, s[16:19], s38 offen sc1 lds
    s_add_u32 m0, s39, 81920
    s_add_u32 s38, s52, s97
    buffer_load_dwordx4 v3, s[16:19], s38 offen sc1 lds
    s_add_u32 m0, s39, 86016
    s_add_u32 s38, s53, s97
    buffer_load_dwordx4 v3, s[16:19], s38 offen sc1 lds
    s_waitcnt vmcnt(12)
    ds_read_b32 v240, v12 offset:32768
    ds_read_b32 v241, v12 offset:36864
    s_branch L77_hc
L79_hcr:
    s_cmp_eq_u32 s47, 0
    s_cbranch_scc1 L80_hok
    s_sub_u32 s47, s47, 1
    s_sleep 2
    s_add_u32 m0, s39, 40960
    s_add_u32 s38, s54, s94
    buffer_load_dwordx4 v3, s[16:19], s38 offen sc1 lds
    s_add_u32 m0, s39, 45056
    s_add_u32 s38, s55, s94
    buffer_load_dwordx4 v3, s[16:19], s38 offen sc1 lds
    s_add_u32 m0, s39, 49152
    s_add_u32 s38, s52, s95
    buffer_load_dwordx4 v3, s[16:19], s38 offen sc1 lds
    s_add_u32 m0, s39, 53248
    s_add_u32 s38, s53, s95
    buffer_load_dwordx4 v3, s[16:19], s38 offen sc1 lds
    s_add_u32 m0, s39, 57344
    s_add_u32 s38, s54, s95
    buffer_load_dwordx4 v3, s[16:19], s38 offen sc1 lds
    s_add_u32 m0, s39, 61440
    s_add_u32 s38, s55, s95
    buffer_load_dwordx4 v3, s[16:19], s38 offen sc1 lds
    s_add_u32 m0, s39, 65536
    s_add_u32 s38, s52, s96
    buffer_load_dwordx4 v3, s[16:19], s38 offen sc1 lds
    s_add_u32 m0, s39, 69632
    s_add_u32 s38, s53, s96
    buffer_load_dwordx4 v3, s[16:19], s38 offen sc1 lds
    s_add_u32 m0, s39, 73728
    s_add_u32 s38, s54, s96
    buffer_load_dwordx4 v3, s[16:19], s38 offen sc1 lds
    s_add_u32 m0, s39, 77824
    s_add_u32 s38, s55, s96
    buffer_load_dwordx4 v3, s[16:19], s38 offen sc1 lds
    s_add_u32 m0, s39, 81920
    s_add_u32 s38, s52, s97
    buffer_load_dwordx4 v3, s[16:19], s38 offen sc1 lds
    s_add_u32 m0, s39, 86016
    s_add_u32 s38, s53, s97
    buffer_load_dwordx4 v3, s[16:19], s38 offen sc1 lds
    s_add_u32 m0, s39, 90112
    s_add_u32 s38, s54, s97
    buffer_load_dwordx4 v3, s[16:19], s38 offen sc1 lds
    s_add_u32 m0, s39, 94208
    s_add_u32 s38, s55, s97
    buffer_load_dwordx4 v3, s[16:19], s38 offen sc1 lds
    s_waitcnt vmcnt(12)
    ds_read_b32 v240, v12 offset:40960
    ds_read_b32 v241, v12 offset:45056
    s_branch L79_hc
L81_hcr:
    s_cmp_eq_u32 s47, 0
    s_cbranch_scc1 L82_hok
    s_sub_u32 s47, s47, 1
    s_sleep 2
    s_add_u32 m0, s39, 49152
    s_add_u32 s38, s52, s95
    buffer_load_dwordx4 v3, s[16:19], s38 offen sc1 lds
    s_add_u32 m0, s39, 53248
    s_add_u32 s38, s53, s95
    buffer_load_dwordx4 v3, s[16:19], s38 offen sc1 lds
    s_add_u32 m0, s39, 57344
    s_add_u32 s38, s54, s95
    buffer_load_dwordx4 v3, s[16:19], s38 offen sc1 lds
    s_add_u32 m0, s39, 61440
    s_add_u32 s38, s55, s95
    buffer_load_dwordx4 v3, s[16:19], s38 offen sc1 lds
    s_add_u32 m0, s39, 65536
    s_add_u32 s38, s52, s96
    buffer_load_dwordx4 v3, s[16:19], s38 offen sc1 lds
    s_add_u32 m0, s39, 69632
    s_add_u32 s38, s53, s96
    buffer_load_dwordx4 v3, s[16:19], s38 offen sc1 lds
    s_add_u32 m0, s39, 73728
    s_add_u32 s38, s54, s96
    buffer_load_dwordx4 v3, s[16:19], s38 offen sc1 lds
    s_add_u32 m0, s39, 77824
    s_add_u32 s38, s55, s96
    buffer_load_dwordx4 v3, s[16:19], s38 offen sc1 lds
    s_add_u32 m0, s39, 81920
    s_add_u32 s38, s52, s97
    buffer_load_dwordx4 v3, s[16:19], s38 offen sc1 lds
    s_add_u32 m0, s39, 86016
    s_add_u32 s38, s53, s97
    buffer_load_dwordx4 v3, s[16:19], s38 offen sc1 lds
    s_add_u32 m0, s39, 90112
    s_add_u32 s38, s54, s97
    buffer_load_dwordx4 v3, s[16:19], s38 offen sc1 lds
    s_add_u32 m0, s39, 94208
    s_add_u32 s38, s55, s97
    buffer_load_dwordx4 v3, s[16:19], s38 offen sc1 lds
    s_add_u32 m0, s39, 98304
    s_add_u32 s38, s52, s98
    buffer_load_dwordx4 v3, s[16:19], s38 offen sc1 lds
    s_add_u32 m0, s39, 102400
    s_add_u32 s38, s53, s98
    buffer_load_dwordx4 v3, s[16:19], s38 offen sc1 lds
    s_waitcnt vmcnt(12)
    ds_read_b32 v240, v12 offset:49152
    ds_read_b32 v241, v12 offset:53248
    s_branch L81_hc
L83_hcr:
    s_cmp_eq_u32 s47, 0
    s_cbranch_scc1 L84_hok
    s_sub_u32 s47, s47, 1
    s_sleep 2
    s_add_u32 m0, s39, 57344
    s_add_u32 s38, s54, s95
    buffer_load_dwordx4 v3, s[16:19], s38 offen sc1 lds
    s_add_u32 m0, s39, 61440
    s_add_u32 s38, s55, s95
    buffer_load_dwordx4 v3, s[16:19], s38 offen sc1 lds
    s_add_u32 m0, s39, 65536
    s_add_u32 s38, s52, s96
    buffer_load_dwordx4 v3, s[16:19], s38 offen sc1 lds
    s_add_u32 m0, s39, 69632
    s_add_u32 s38, s53, s96
    buffer_load_dwordx4 v3, s[16:19], s38 offen sc1 lds
    s_add_u32 m0, s39, 73728
    s_add_u32 s38, s54, s96
    buffer_load_dwordx4 v3, s[16:19], s38 offen sc1 lds
    s_add_u32 m0, s39, 77824
    s_add_u32 s38, s55, s96
    buffer_load_dwordx4 v3, s[16:19], s38 offen sc1 lds
    s_add_u32 m0, s39, 81920
    s_add_u32 s38, s52, s97
    buffer_load_dwordx4 v3, s[16:19], s38 offen sc1 lds
    s_add_u32 m0, s39, 86016
    s_add_u32 s38, s53, s97
    buffer_load_dwordx4 v3, s[16:19], s38 offen sc1 lds
    s_add_u32 m0, s39, 90112
    s_add_u32 s38, s54, s97
    buffer_load_dwordx4 v3, s[16:19], s38 offen sc1 lds
    s_add_u32 m0, s39, 94208
    s_add_u32 s38, s55, s97
    buffer_load_dwordx4 v3, s[16:19], s38 offen sc1 lds
    s_add_u32 m0, s39, 98304
    s_add_u32 s38, s52, s98
    buffer_load_dwordx4 v3, s[16:19], s38 offen sc1 lds
    s_add_u32 m0, s39, 102400
    s_add_u32 s38, s53, s98
    buffer_load_dwordx4 v3, s[16:19], s38 offen sc1 lds
    s_add_u32 m0, s39, 106496
    s_add_u32 s38, s54, s98
    buffer_load_dwordx4 v3, s[16:19], s38 offen sc1 lds
    s_add_u32 m0, s39, 110592
    s_add_u32 s38, s55, s98
    buffer_load_dwordx4 v3, s[16:19], s38 offen sc1 lds
    s_waitcnt vmcnt(12)
    ds_read_b32 v240, v12 offset:57344
    ds_read_b32 v241, v12 offset:61440
    s_branch L83_hc
L85_hcr:
    s_cmp_eq_u32 s47, 0
    s_cbranch_scc1 L86_hok
    s_sub_u32 s47, s47, 1
    s_sleep 2
    s_add_u32 m0, s39, 65536
    s_add_u32 s38, s52, s96
    buffer_load_dwordx4 v3, s[16:19], s38 offen sc1 lds
    s_add_u32 m0, s39, 69632
    s_add_u32 s38, s53, s96
    buffer_load_dwordx4 v3, s[16:19], s38 offen sc1 lds
    s_add_u32 m0, s39, 73728
    s_add_u32 s38, s54, s96
    buffer_load_dwordx4 v3, s[16:19], s38 offen sc1 lds
    s_add_u32 m0, s39, 77824
    s_add_u32 s38, s55, s96
    buffer_load_dwordx4 v3, s[16:19], s38 offen sc1 lds
    s_add_u32 m0, s39, 81920
    s_add_u32 s38, s52, s97
    buffer_load_dwordx4 v3, s[16:19], s38 offen sc1 lds
    s_add_u32 m0, s39, 86016
    s_add_u32 s38, s53, s97
    buffer_load_dwordx4 v3, s[16:19], s38 offen sc1 lds
    s_add_u32 m0, s39, 90112
    s_add_u32 s38, s54, s97
    buffer_load_dwordx4 v3, s[16:19], s38 offen sc1 lds
    s_add_u32 m0, s39, 94208
    s_add_u32 s38, s55, s97
    buffer_load_dwordx4 v3, s[16:19], s38 offen sc1 lds
    s_add_u32 m0, s39, 98304
    s_add_u32 s38, s52, s98
    buffer_load_dwordx4 v3, s[16:19], s38 offen sc1 lds
    s_add_u32 m0, s39, 102400
    s_add_u32 s38, s53, s98
    buffer_load_dwordx4 v3, s[16:19], s38 offen sc1 lds
    s_add_u32 m0, s39, 106496
    s_add_u32 s38, s54, s98
    buffer_load_dwordx4 v3, s[16:19], s38 offen sc1 lds
    s_add_u32 m0, s39, 110592
    s_add_u32 s38, s55, s98
    buffer_load_dwordx4 v3, s[16:19], s38 offen sc1 lds
    s_waitcnt vmcnt(10)
    ds_read_b32 v240, v15 offset:0
    ds_read_b32 v241, v15 offset:4096
    s_branch L85_hc
k_f2b:
    s_waitcnt vmcnt(12)
    s_mov_b32 s59, 4096
k_f2c:
    v_readfirstlane_b32 s48, v236
    s_nop 0
    s_bitcmp1_b32 s48, 24
    s_cbranch_scc1 k_f2r
    s_sub_u32 s59, s59, 1
    s_cbranch_scc1 k_f2r
    s_cmp_lt_u32 s59, 4072
    s_cbranch_scc1 k_f2g
    s_sleep 4
    s_mov_b64 exec, 1
    buffer_load_dword v236, v247, s[24:27], 0 offen offset:124 sc1
    s_mov_b64 exec, -1
    s_waitcnt vmcnt(0)
    s_branch k_f2c
k_f2g:
    s_sleep 16
    s_mov_b64 exec, 0xff
    buffer_load_dword v236, v247, s[24:27], 0 offen offset:168 sc1
    s_waitcnt vmcnt(0)
    v_cmp_ne_u32 vcc, 0x01010101, v236
    s_mov_b64 exec, -1
    v_mov_b32 v236, 0
    s_and_b32 s48, vcc_lo, 0xff
    s_cbranch_scc0 k_f2r
    s_branch k_f2c
L87_hcr:
    s_cmp_eq_u32 s47, 0
    s_cbranch_scc1 L88_hok
    s_sub_u32 s47, s47, 1
    s_sleep 2
    s_add_u32 m0, s39, 73728
    s_add_u32 s38, s54, s96
    buffer_load_dwordx4 v3, s[16:19], s38 offen sc1 lds
    s_add_u32 m0, s39, 77824
    s_add_u32 s38, s55, s96
    buffer_load_dwordx4 v3, s[16:19], s38 offen sc1 lds
    s_add_u32 m0, s39, 81920
    s_add_u32 s38, s52, s97
    buffer_load_dwordx4 v3, s[16:19], s38 offen sc1 lds
    s_add_u32 m0, s39, 86016
    s_add_u32 s38, s53, s97
    buffer_load_dwordx4 v3, s[16:19], s38 offen sc1 lds
    s_add_u32 m0, s39, 90112
    s_add_u32 s38, s54, s97
    buffer_load_dwordx4 v3, s[16:19], s38 offen sc1 lds
    s_add_u32 m0, s39, 94208
    s_add_u32 s38, s55, s97
    buffer_load_dwordx4 v3, s[16:19], s38 offen sc1 lds
    s_add_u32 m0, s39, 98304
    s_add_u32 s38, s52, s98
    buffer_load_dwordx4 v3, s[16:19], s38 offen sc1 lds
    s_add_u32 m0, s39, 102400
    s_add_u32 s38, s53, s98
    buffer_load_dwordx4 v3, s[16:19], s38 offen sc1 lds
    s_add_u32 m0, s39, 106496
    s_add_u32 s38, s54, s98
    buffer_load_dwordx4 v3, s[16:19], s38 offen sc1 lds
    s_add_u32 m0, s39, 110592
    s_add_u32 s38, s55, s98
    buffer_load_dwordx4 v3, s[16:19], s38 offen sc1 lds
    s_waitcnt vmcnt(8)
    ds_read_b32 v240, v15 offset:8192
    ds_read_b32 v241, v15 offset:12288
    s_branch L87_hc
L91_gcr:
    s_cmp_eq_u32 s47, 0
    s_cbranch_scc1 L91_gck
    s_sub_u32 s47, s47, 1
    s_sleep 2
    buffer_load_dword v252, v243, s[16:19], s10 offen sc1
    s_waitcnt vmcnt(0)
    s_branch L91_gc
L89_hcr:
    s_cmp_eq_u32 s47, 0
    s_cbranch_scc1 L90_hok
    s_sub_u32 s47, s47, 1
    s_sleep 2
    s_add_u32 m0, s39, 81920
    s_add_u32 s38, s52, s97
    buffer_load_dwordx4 v3, s[16:19], s38 offen sc1 lds
    s_add_u32 m0, s39, 86016
    s_add_u32 s38, s53, s97
    buffer_load_dwordx4 v3, s[16:19], s38 offen sc1 lds
    s_add_u32 m0, s39, 90112
    s_add_u32 s38, s54, s97
    buffer_load_dwordx4 v3, s[16:19], s38 offen sc1 lds
    s_add_u32 m0, s39, 94208
    s_add_u32 s38, s55, s97
    buffer_load_dwordx4 v3, s[16:19], s38 offen sc1 lds
    s_add_u32 m0, s39, 98304
    s_add_u32 s38, s52, s98
    buffer_load_dwordx4 v3, s[16:19], s38 offen sc1 lds
    s_add_u32 m0, s39, 102400
    s_add_u32 s38, s53, s98
    buffer_load_dwordx4 v3, s[16:19], s38 offen sc1 lds
    s_add_u32 m0, s39, 106496
    s_add_u32 s38, s54, s98
    buffer_load_dwordx4 v3, s[16:19], s38 offen sc1 lds
    s_add_u32 m0, s39, 110592
    s_add_u32 s38, s55, s98
    buffer_load_dwordx4 v3, s[16:19], s38 offen sc1 lds
    s_waitcnt vmcnt(6)
    ds_read_b32 v240, v15 offset:16384
    ds_read_b32 v241, v15 offset:20480
    s_branch L89_hc
L92_hcr:
    s_cmp_eq_u32 s47, 0
    s_cbranch_scc1 L93_hok
    s_sub_u32 s47, s47, 1
    s_sleep 2
    s_add_u32 m0, s39, 90112
    s_add_u32 s38, s54, s97
    buffer_load_dwordx4 v3, s[16:19], s38 offen sc1 lds
    s_add_u32 m0, s39, 94208
    s_add_u32 s38, s55, s97
    buffer_load_dwordx4 v3, s[16:19], s38 offen sc1 lds
    s_add_u32 m0, s39, 98304
    s_add_u32 s38, s52, s98
    buffer_load_dwordx4 v3, s[16:19], s38 offen sc1 lds
    s_add_u32 m0, s39, 102400
    s_add_u32 s38, s53, s98
    buffer_load_dwordx4 v3, s[16:19], s38 offen sc1 lds
    s_add_u32 m0, s39, 106496
    s_add_u32 s38, s54, s98
    buffer_load_dwordx4 v3, s[16:19], s38 offen sc1 lds
    s_add_u32 m0, s39, 110592
    s_add_u32 s38, s55, s98
    buffer_load_dwordx4 v3, s[16:19], s38 offen sc1 lds
    s_waitcnt vmcnt(4)
    ds_read_b32 v240, v15 offset:24576
    ds_read_b32 v241, v15 offset:28672
    s_branch L92_hc
L96_gzr:
    buffer_load_dword v244, v243, s[16:19], s11 offen sc1
    s_branch L96_gz
L94_hcr:
    s_cmp_eq_u32 s47, 0
    s_cbranch_scc1 L95_hok
    s_sub_u32 s47, s47, 1
    s_sleep 2
    s_add_u32 m0, s39, 98304
    s_add_u32 s38, s52, s98
    buffer_load_dwordx4 v3, s[16:19], s38 offen sc1 lds
    s_add_u32 m0, s39, 102400
    s_add_u32 s38, s53, s98
    buffer_load_dwordx4 v3, s[16:19], s38 offen sc1 lds
    s_add_u32 m0, s39, 106496
    s_add_u32 s38, s54, s98
    buffer_load_dwordx4 v3, s[16:19], s38 offen sc1 lds
    s_add_u32 m0, s39, 110592
    s_add_u32 s38, s55, s98
    buffer_load_dwordx4 v3, s[16:19], s38 offen sc1 lds
    s_waitcnt vmcnt(2)
    ds_read_b32 v240, v15 offset:32768
    ds_read_b32 v241, v15 offset:36864
    s_branch L94_hc
L97_hcr:
    s_cmp_eq_u32 s47, 0
    s_cbranch_scc1 L98_hok
    s_sub_u32 s47, s47, 1
    s_sleep 2
    s_add_u32 m0, s39, 106496
    s_add_u32 s38, s54, s98
    buffer_load_dwordx4 v3, s[16:19], s38 offen sc1 lds
    s_add_u32 m0, s39, 110592
    s_add_u32 s38, s55, s98
    buffer_load_dwordx4 v3, s[16:19], s38 offen sc1 lds
    s_waitcnt vmcnt(0)
    ds_read_b32 v240, v15 offset:40960
    ds_read_b32 v241, v15 offset:45056
    s_branch L97_hc
L99_gcr:
    s_cmp_eq_u32 s47, 0
    s_cbranch_scc1 L99_gck
    s_sub_u32 s47, s47, 1
    s_sleep 2
    buffer_load_dword v244, v243, s[16:19], s11 offen sc1
    s_waitcnt vmcnt(0)
    s_branch L99_gc
L100_str:
    s_cmp_eq_u32 s47, 0
    s_cbranch_scc1 L101_stok
    s_sub_u32 s47, s47, 1
    ds_read_b128 v[248:251], v13
    s_waitcnt lgkmcnt(0)
    s_branch L100_st
L104_poll:
    s_mov_b32 s47, 40
L111_rt:
    s_sleep 2
    s_buffer_load_dword s58, s[16:19], s41 glc
    s_waitcnt lgkmcnt(0)
    s_cmp_ge_u32 s58, 3584
    s_cbranch_scc1 L105_pok
    s_sub_u32 s47, s47, 1
    s_cbranch_scc0 L111_rt
    s_mov_b32 s47, 0x4000
L111_rtv:
    buffer_load_dword v14, off, s[16:19], s41 sc1
    s_waitcnt vmcnt(0)
    v_readfirstlane_b32 s58, v14
    s_nop 0
    s_cmp_ge_u32 s58, 3584
    s_cbranch_scc1 L105_pok
    s_sleep 8
    s_sub_u32 s47, s47, 1
    s_cbranch_scc0 L111_rtv
    s_branch L105_pok
L106_poll:
    s_mov_b32 s47, 40
L112_rt:
    s_sleep 2
    s_buffer_load_dword s58, s[16:19], s41 glc
    s_waitcnt lgkmcnt(0)
    s_cmp_ge_u32 s58, 3598
    s_cbranch_scc1 L107_pok
    s_sub_u32 s47, s47, 1
    s_cbranch_scc0 L112_rt
    s_mov_b32 s47, 0x4000
L112_rtv:
    buffer_load_dword v240, off, s[16:19], s41 sc1
    s_waitcnt vmcnt(0)
    v_readfirstlane_b32 s58, v240
    s_nop 0
    s_cmp_ge_u32 s58, 3598
    s_cbranch_scc1 L107_pok
    s_sleep 8
    s_sub_u32 s47, s47, 1
    s_cbranch_scc0 L112_rtv
    s_branch L107_pok
k_ys2:
    s_sub_u32 s44, s2, 224
    s_lshl_b32 s57, s44, 10
    s_add_u32 s57, s57, 27262976
    s_mul_i32 s51, s37, 14336
    s_add_u32 s51, s51, 46080
    s_mul_i32 s44, s44, 7
    s_add_u32 s42, s44, s37
    s_add_u32 s43, s42, 3
    v_bfe_u32 v6, v1, 2, 2
    v_mul_u32_u24 v8, 896, v6
    v_lshrrev_b32 v6, 4, v1
    v_lshl_add_u32 v8, v6, 5, v8
    v_and_b32 v6, 3, v1
    v_lshl_add_u32 v8, v6, 3, v8
    v_add_u32 v8, s51, v8
    v_lshrrev_b32 v6, 5, v1
    v_lshl_add_u32 v11, v6, 9, v2
    v_mov_b32 v210, v13
    v_mov_b32 v211, 1
    s_mul_i32 s53, s42, 7168
    s_bfe_u32 s48, s42, 0x30001
    s_mul_i32 s48, s48, 14
    s_lshr_b32 s49, s42, 4
    s_add_u32 s48, s48, s49
    s_lshl_b32 s48, s48, 2
    s_and_b32 s49, s42, 1
    s_add_u32 s48, s48, s49
    s_lshl_b32 s48, s48, 9
    s_add_u32 s58, s48, 25165824
    s_mul_i32 s54, s43, 7168
    s_bfe_u32 s48, s43, 0x30001
    s_mul_i32 s48, s48, 14
    s_lshr_b32 s49, s43, 4
    s_add_u32 s48, s48, s49
    s_lshl_b32 s48, s48, 2
    s_and_b32 s49, s43, 1
    s_add_u32 s48, s48, s49
    s_lshl_b32 s48, s48, 9
    s_add_u32 s59, s48, 25165824
    v_mov_b32 v224, 0
    v_mov_b32 v225, 0
    v_mov_b32 v226, 0
    v_mov_b32 v227, 0
    s_waitcnt vmcnt(0)
    s_cmp_eq_u32 s29, 7
    s_cbranch_scc1 L113_ed
    ds_write_b128 v235, v[16:19] offset:4160
    ds_write_b128 v235, v[20:23] offset:5184
    v_readlane_b32 s48, v19, 63
    v_mov_b32_dpp v24, v19 wave_shr:1 row_mask:0xf bank_mask:0xf
    s_nop 0
    v_mov_b32 v25, s48
    v_alignbit_b32 v28, v16, v24, 16
    s_nop 0
    v_mov_b32_dpp v25, v23 wave_shr:1 row_mask:0xf bank_mask:0xf
    v_alignbit_b32 v29, v17, v16, 16
    v_alignbit_b32 v30, v18, v17, 16
    v_alignbit_b32 v31, v19, v18, 16
    ds_write_b128 v235, v[28:31]
    v_alignbit_b32 v32, v20, v25, 16
    v_alignbit_b32 v33, v21, v20, 16
    v_alignbit_b32 v34, v22, v21, 16
    v_alignbit_b32 v35, v23, v22, 16
    ds_write_b128 v235, v[32:35] offset:1024
    s_mov_b64 exec, 1
    ds_add_u32 v13, v15 offset:12
    s_mov_b64 exec, -1
L113_ed:
    buffer_store_dwordx4 v[224:227], v2, s[16:19], s57 offen sc1
    s_cmp_ge_i32 s62, 248
    s_cbranch_scc1 k_ld
    s_mov_b32 s47, 0x8000
L114_sp:
    ds_read_b32 v14, v13 offset:24
    s_waitcnt lgkmcnt(0)
    v_readfirstlane_b32 s48, v14
    s_nop 0
    s_cmp_ge_u32 s48, 4
    s_cbranch_scc1 L115_ok
    s_sleep 1
    s_sub_u32 s47, s47, 1
    s_cbranch_scc0 L114_sp
L115_ok:
    s_cmp_lg_u32 s28, 0
    s_cbranch_scc1 L116_sd
    s_mov_b32 m0, s38
    s_nop 0
    buffer_load_dwordx4 v2, s[16:19], s39 offen sc1 lds
    s_add_u32 m0, s38, 3072
    s_nop 0
    buffer_load_dwordx4 v2, s[16:19], s39 offen offset:1024 sc1 lds
L116_sd:
k_sp0a:
    s_add_u32 m0, s51, 0
    s_add_u32 s48, s53, 0
    buffer_load_dwordx4 v2, s[12:15], s48 offen offset:0 nt lds
    buffer_load_dwordx4 v2, s[12:15], s48 offen offset:1024 nt lds
    buffer_load_dwordx4 v2, s[12:15], s48 offen offset:2048 nt lds
    buffer_load_dwordx4 v2, s[12:15], s48 offen offset:3072 nt lds
    s_add_u32 m0, s51, 4096
    s_add_u32 s48, s53, 4096
    buffer_load_dwordx4 v2, s[12:15], s48 offen offset:0 nt lds
    buffer_load_dwordx4 v2, s[12:15], s48 offen offset:1024 nt lds
    buffer_load_dwordx4 v2, s[12:15], s48 offen offset:2048 nt lds
    s_waitcnt vmcnt(7)
    s_cmp_lg_u32 s28, 0
    s_cbranch_scc1 L117_sd
    ds_read_b128 v[128:131], v233
    ds_read_b128 v[132:135], v233 offset:4096
    s_waitcnt lgkmcnt(0)
    v_max3_u32 v128, v128, v129, v130
    v_max3_u32 v131, v131, v132, v133
    v_max3_u32 v128, v128, v134, v135
    v_max_u32 v128, v128, v131
    v_cmp_eq_u32 vcc, -1, v128
    s_mov_b32 s28, 1
    s_nop 0
    s_cbranch_vccz L117_sd
    s_mov_b32 s28, 0
    s_mov_b32 m0, s38
    s_nop 0
    buffer_load_dwordx4 v2, s[16:19], s39 offen sc1 lds
    s_add_u32 m0, s38, 3072
    s_nop 0
    buffer_load_dwordx4 v2, s[16:19], s39 offen offset:1024 sc1 lds
L117_sd:
    s_cmp_eq_u32 s37, 0
    s_cbranch_scc1 k_sp0
    s_add_u32 m0, s51, 7168
    s_add_u32 s48, s54, 0
    buffer_load_dwordx4 v2, s[12:15], s48 offen offset:0 nt lds
    buffer_load_dwordx4 v2, s[12:15], s48 offen offset:1024 nt lds
    buffer_load_dwordx4 v2, s[12:15], s48 offen offset:2048 nt lds
    buffer_load_dwordx4 v2, s[12:15], s48 offen offset:3072 nt lds
    s_add_u32 m0, s51, 11264
    s_add_u32 s48, s54, 4096
    buffer_load_dwordx4 v2, s[12:15], s48 offen offset:0 nt lds
    buffer_load_dwordx4 v2, s[12:15], s48 offen offset:1024 nt lds
    buffer_load_dwordx4 v2, s[12:15], s48 offen offset:2048 nt lds
    s_waitcnt vmcnt(7)
    s_cmp_lg_u32 s28, 0
    s_cbranch_scc1 L118_sd
    ds_read_b128 v[128:131], v233
    ds_read_b128 v[132:135], v233 offset:4096
    s_waitcnt lgkmcnt(0)
    v_max3_u32 v128, v128, v129, v130
    v_max3_u32 v131, v131, v132, v133
    v_max3_u32 v128, v128, v134, v135
    v_max_u32 v128, v128, v131
    v_cmp_eq_u32 vcc, -1, v128
    s_mov_b32 s28, 1
    s_nop 0
    s_cbranch_vccz L118_sd
    s_mov_b32 s28, 0
    s_mov_b32 m0, s38
    s_nop 0
    buffer_load_dwordx4 v2, s[16:19], s39 offen sc1 lds
    s_add_u32 m0, s38, 3072
    s_nop 0
    buffer_load_dwordx4 v2, s[16:19], s39 offen offset:1024 sc1 lds
L118_sd:
    ds_read_b64_tr_b16 v[16:17], v8 offset:0
    ds_read_b64_tr_b16 v[18:19], v8 offset:3584
    ds_read_b64_tr_b16 v[20:21], v8 offset:128
    ds_read_b64_tr_b16 v[22:23], v8 offset:3712
    ds_read_b64_tr_b16 v[24:25], v8 offset:256
    ds_read_b64_tr_b16 v[26:27], v8 offset:3840
    ds_read_b64_tr_b16 v[28:29], v8 offset:384
    ds_read_b64_tr_b16 v[30:31], v8 offset:3968
    ds_read_b64_tr_b16 v[32:33], v8 offset:512
    ds_read_b64_tr_b16 v[34:35], v8 offset:4096
    ds_read_b64_tr_b16 v[36:37], v8 offset:640
    ds_read_b64_tr_b16 v[38:39], v8 offset:4224
    ds_read_b64_tr_b16 v[40:41], v8 offset:768
    ds_read_b64_tr_b16 v[42:43], v8 offset:4352
    s_waitcnt lgkmcnt(12)
    buffer_store_dwordx4 v[16:19], v11, s[16:19], s58 offen sc1
    s_add_u32 s58, s58, 229376
    s_waitcnt lgkmcnt(10)
    buffer_store_dwordx4 v[20:23], v11, s[16:19], s58 offen sc1
    s_add_u32 s58, s58, 229376
    s_waitcnt lgkmcnt(8)
    buffer_store_dwordx4 v[24:27], v11, s[16:19], s58 offen sc1
    s_add_u32 s58, s58, 229376
    s_waitcnt lgkmcnt(6)
    buffer_store_dwordx4 v[28:31], v11, s[16:19], s58 offen sc1
    s_add_u32 s58, s58, 229376
    s_waitcnt lgkmcnt(4)
    buffer_store_dwordx4 v[32:35], v11, s[16:19], s58 offen sc1
    s_add_u32 s58, s58, 229376
    s_waitcnt lgkmcnt(2)
    buffer_store_dwordx4 v[36:39], v11, s[16:19], s58 offen sc1
    s_add_u32 s58, s58, 229376
    s_waitcnt lgkmcnt(0)
    buffer_store_dwordx4 v[40:43], v11, s[16:19], s58 offen sc1
    s_add_u32 s58, s58, 229376
    s_waitcnt vmcnt(7)
    ds_read_b64_tr_b16 v[44:45], v8 offset:7168
    ds_read_b64_tr_b16 v[46:47], v8 offset:10752
    ds_read_b64_tr_b16 v[48:49], v8 offset:7296
    ds_read_b64_tr_b16 v[50:51], v8 offset:10880
    ds_read_b64_tr_b16 v[52:53], v8 offset:7424
    ds_read_b64_tr_b16 v[54:55], v8 offset:11008
    ds_read_b64_tr_b16 v[56:57], v8 offset:7552
    ds_read_b64_tr_b16 v[58:59], v8 offset:11136
    ds_read_b64_tr_b16 v[60:61], v8 offset:7680
    ds_read_b64_tr_b16 v[62:63], v8 offset:11264
    ds_read_b64_tr_b16 v[64:65], v8 offset:7808
    ds_read_b64_tr_b16 v[66:67], v8 offset:11392
    ds_read_b64_tr_b16 v[68:69], v8 offset:7936
    ds_read_b64_tr_b16 v[70:71], v8 offset:11520
    s_waitcnt lgkmcnt(12)
    buffer_store_dwordx4 v[44:47], v11, s[16:19], s59 offen sc1
    s_add_u32 s59, s59, 229376
    s_waitcnt lgkmcnt(10)
    buffer_store_dwordx4 v[48:51], v11, s[16:19], s59 offen sc1
    s_add_u32 s59, s59, 229376
    s_waitcnt lgkmcnt(8)
    buffer_store_dwordx4 v[52:55], v11, s[16:19], s59 offen sc1
    s_add_u32 s59, s59, 229376
    s_waitcnt lgkmcnt(6)
    buffer_store_dwordx4 v[56:59], v11, s[16:19], s59 offen sc1
    s_add_u32 s59, s59, 229376
    s_waitcnt lgkmcnt(4)
    buffer_store_dwordx4 v[60:63], v11, s[16:19], s59 offen sc1
    s_add_u32 s59, s59, 229376
    s_waitcnt lgkmcnt(2)
    buffer_store_dwordx4 v[64:67], v11, s[16:19], s59 offen sc1
    s_add_u32 s59, s59, 229376
    s_waitcnt lgkmcnt(0)
    buffer_store_dwordx4 v[68:71], v11, s[16:19], s59 offen sc1
    s_add_u32 s59, s59, 229376
    s_branch k_sp1
k_sp0:
    s_waitcnt vmcnt(0)
    s_cmp_lg_u32 s28, 0
    s_cbranch_scc1 L119_sd
    ds_read_b128 v[128:131], v233
    ds_read_b128 v[132:135], v233 offset:4096
    s_waitcnt lgkmcnt(0)
    v_max3_u32 v128, v128, v129, v130
    v_max3_u32 v131, v131, v132, v133
    v_max3_u32 v128, v128, v134, v135
    v_max_u32 v128, v128, v131
    v_cmp_eq_u32 vcc, -1, v128
    s_mov_b32 s28, 1
    s_nop 0
    s_cbranch_vccz L119_sd
    s_mov_b32 s28, 0
    s_mov_b32 m0, s38
    s_nop 0
    buffer_load_dwordx4 v2, s[16:19], s39 offen sc1 lds
    s_add_u32 m0, s38, 3072
    s_nop 0
    buffer_load_dwordx4 v2, s[16:19], s39 offen offset:1024 sc1 lds
L119_sd:
    ds_read_b64_tr_b16 v[16:17], v8 offset:0
    ds_read_b64_tr_b16 v[18:19], v8 offset:3584
    ds_read_b64_tr_b16 v[20:21], v8 offset:128
    ds_read_b64_tr_b16 v[22:23], v8 offset:3712
    ds_read_b64_tr_b16 v[24:25], v8 offset:256
    ds_read_b64_tr_b16 v[26:27], v8 offset:3840
    ds_read_b64_tr_b16 v[28:29], v8 offset:384
    ds_read_b64_tr_b16 v[30:31], v8 offset:3968
    ds_read_b64_tr_b16 v[32:33], v8 offset:512
    ds_read_b64_tr_b16 v[34:35], v8 offset:4096
    ds_read_b64_tr_b16 v[36:37], v8 offset:640
    ds_read_b64_tr_b16 v[38:39], v8 offset:4224
    ds_read_b64_tr_b16 v[40:41], v8 offset:768
    ds_read_b64_tr_b16 v[42:43], v8 offset:4352
    s_waitcnt lgkmcnt(12)
    buffer_store_dwordx4 v[16:19], v11, s[16:19], s58 offen sc1
    s_add_u32 s58, s58, 229376
    s_waitcnt lgkmcnt(10)
    buffer_store_dwordx4 v[20:23], v11, s[16:19], s58 offen sc1
    s_add_u32 s58, s58, 229376
    s_waitcnt lgkmcnt(8)
    buffer_store_dwordx4 v[24:27], v11, s[16:19], s58 offen sc1
    s_add_u32 s58, s58, 229376
    s_waitcnt lgkmcnt(6)
    buffer_store_dwordx4 v[28:31], v11, s[16:19], s58 offen sc1
    s_add_u32 s58, s58, 229376
    s_waitcnt lgkmcnt(4)
    buffer_store_dwordx4 v[32:35], v11, s[16:19], s58 offen sc1
    s_add_u32 s58, s58, 229376
    s_waitcnt lgkmcnt(2)
    buffer_store_dwordx4 v[36:39], v11, s[16:19], s58 offen sc1
    s_add_u32 s58, s58, 229376
    s_waitcnt lgkmcnt(0)
    buffer_store_dwordx4 v[40:43], v11, s[16:19], s58 offen sc1
    s_add_u32 s58, s58, 229376
k_sp1:
    s_sub_u32 s44, s2, 224
    s_waitcnt vmcnt(0)
    s_mov_b64 exec, 1
    ds_add_rtn_u32 v14, v13, v15 offset:44
    s_waitcnt lgkmcnt(0)
    v_readfirstlane_b32 s48, v14
    s_nop 0
    s_cmp_lg_u32 s48, 3
    s_cbranch_scc1 L120_la
    buffer_store_byte v15, v246, s[24:27], s44 offen offset:168 sc1
L120_la:
    s_mov_b64 exec, -1
    s_cmp_lt_i32 s62, 248
    s_cbranch_scc1 k_spare_end
k_sp2:
    s_mov_b32 s47, 4096
k_lf:
    s_buffer_load_dwordx8 s[52:59], s[24:27], 168 glc
    s_waitcnt lgkmcnt(0)
    s_and_b64 s[52:53], s[52:53], s[54:55]
    s_and_b64 s[56:57], s[56:57], s[58:59]
    s_and_b64 s[52:53], s[52:53], s[56:57]
    s_and_b32 s52, s52, s53
    s_cmp_eq_u32 s52, 0x01010101
    s_cbranch_scc1 k_lf1
    s_sleep 2
    s_sub_u32 s47, s47, 1
    s_cbranch_scc0 k_lf
    s_branch k_spare_end
k_lf1:
    s_mov_b64 exec, 1
    s_and_b32 s48, s24, 127
    s_cbranch_scc1 L121_pub
    buffer_store_byte v15, v246, s[24:27], 0 offen offset:127
L121_pub:
    s_mov_b64 exec, -1
    s_waitcnt vmcnt(0)
k_spare_end:
k_end:
    s_endpgm
k_ld:
    s_mov_b64 exec, 1
    buffer_load_dword v237, v246, s[24:27], 0 offen offset:124 sc1
    s_mov_b64 exec, -1
    s_cmp_eq_u32 s29, 7
    s_cbranch_scc1 k_ldp
    s_mov_b32 s47, 0x8000
L122_sp:
    ds_read_b32 v14, v13 offset:12
    s_waitcnt lgkmcnt(0)
    v_readfirstlane_b32 s48, v14
    s_nop 0
    s_cmp_ge_u32 s48, 8
    s_cbranch_scc1 L123_ok
    s_sleep 1
    s_sub_u32 s47, s47, 1
    s_cbranch_scc0 L122_sp
L123_ok:
k_ldp:
    s_mov_b32 s47, 0x8000
L124_sp:
    ds_read_b32 v14, v13 offset:24
    s_waitcnt lgkmcnt(0)
    v_readfirstlane_b32 s48, v14
    s_nop 0
    s_cmp_ge_u32 s48, 4
    s_cbranch_scc1 L125_ok
    s_sleep 1
    s_sub_u32 s47, s47, 1
    s_cbranch_scc0 L124_sp
L125_ok:
k_ldq:
    s_mov_b64 exec, 1
    buffer_store_byte v15, v246, s[24:27], s29 offen offset:160 sc1
    s_mov_b64 exec, -1
    s_mov_b32 s47, 4096
    s_mov_b32 s61, 1
    s_cmp_lg_u32 s28, 0
    s_cbranch_scc1 L126_sd
    ds_read_b128 v[128:131], v233
    ds_read_b128 v[132:135], v233 offset:4096
    s_waitcnt lgkmcnt(0)
    v_max3_u32 v128, v128, v129, v130
    v_max3_u32 v131, v131, v132, v133
    v_max3_u32 v128, v128, v134, v135
    v_max_u32 v128, v128, v131
    v_cmp_eq_u32 vcc, -1, v128
    s_mov_b32 s28, 1
    s_nop 0
    s_cbranch_vccz L126_sd
    s_mov_b32 s28, 0
    s_mov_b32 m0, s38
    s_nop 0
    buffer_load_dwordx4 v2, s[16:19], s39 offen sc1 lds
    s_add_u32 m0, s38, 3072
    s_nop 0
    buffer_load_dwordx4 v2, s[16:19], s39 offen offset:1024 sc1 lds
L126_sd:
    s_mov_b32 s61, 0
    s_add_u32 m0, s51, 0
    s_add_u32 s48, s53, 0
    buffer_load_dwordx4 v2, s[12:15], s48 offen offset:0 nt lds
    buffer_load_dwordx4 v2, s[12:15], s48 offen offset:1024 nt lds
    buffer_load_dwordx4 v2, s[12:15], s48 offen offset:2048 nt lds
    buffer_load_dwordx4 v2, s[12:15], s48 offen offset:3072 nt lds
    s_add_u32 m0, s51, 4096
    s_add_u32 s48, s53, 4096
    buffer_load_dwordx4 v2, s[12:15], s48 offen offset:0 nt lds
    buffer_load_dwordx4 v2, s[12:15], s48 offen offset:1024 nt lds
    buffer_load_dwordx4 v2, s[12:15], s48 offen offset:2048 nt lds
    s_buffer_load_dwordx2 s[48:49], s[24:27], 160 glc
    s_waitcnt lgkmcnt(0)
    s_and_b32 s48, s48, s49
    s_cmp_eq_u32 s48, 0x01010101
    s_cbranch_scc1 k_ld4
    s_sleep 1
    s_buffer_load_dwordx2 s[48:49], s[24:27], 160 glc
    s_waitcnt lgkmcnt(0)
    s_and_b32 s48, s48, s49
    s_cmp_eq_u32 s48, 0x01010101
    s_cbranch_scc1 k_ld4
    s_sleep 1
    s_waitcnt vmcnt(7)
k_ld0:
    s_cmp_lg_u32 s28, 0
    s_cbranch_scc1 L127_sd
    ds_read_b128 v[128:131], v233
    ds_read_b128 v[132:135], v233 offset:4096
    s_waitcnt lgkmcnt(0)
    v_max3_u32 v128, v128, v129, v130
    v_max3_u32 v131, v131, v132, v133
    v_max3_u32 v128, v128, v134, v135
    v_max_u32 v128, v128, v131
    v_cmp_eq_u32 vcc, -1, v128
    s_mov_b32 s28, 1
    s_nop 0
    s_cbranch_vccz L127_sd
    s_mov_b32 s28, 0
    s_mov_b32 m0, s38
    s_nop 0
    buffer_load_dwordx4 v2, s[16:19], s39 offen sc1 lds
    s_add_u32 m0, s38, 3072
    s_nop 0
    buffer_load_dwordx4 v2, s[16:19], s39 offen offset:1024 sc1 lds
L127_sd:
    s_buffer_load_dwordx2 s[48:49], s[24:27], 160 glc
    s_waitcnt lgkmcnt(0)
    s_and_b32 s48, s48, s49
    s_cmp_eq_u32 s48, 0x01010101
    s_cbranch_scc1 k_ld4
    s_sleep 1
    s_buffer_load_dwordx2 s[48:49], s[24:27], 160 glc
    s_waitcnt lgkmcnt(0)
    s_and_b32 s48, s48, s49
    s_cmp_eq_u32 s48, 0x01010101
    s_cbranch_scc1 k_ld4
    s_sleep 1
    s_buffer_load_dwordx2 s[48:49], s[24:27], 160 glc
    s_waitcnt lgkmcnt(0)
    s_and_b32 s48, s48, s49
    s_cmp_eq_u32 s48, 0x01010101
    s_cbranch_scc1 k_ld4
    s_sleep 1
    s_buffer_load_dwordx2 s[48:49], s[24:27], 160 glc
    s_waitcnt lgkmcnt(0)
    s_and_b32 s48, s48, s49
    s_cmp_eq_u32 s48, 0x01010101
    s_cbranch_scc1 k_ld4
    s_sleep 1
    s_waitcnt vmcnt(0)
    s_sub_u32 s47, s47, 1
    s_cbranch_scc0 k_ld0
    s_branch k_ld5
k_ld4:
    s_mov_b64 exec, 1
    s_and_b32 s48, s24, 127
    s_cbranch_scc1 L128_pub
    buffer_store_byte v15, v246, s[24:27], 0 offen offset:126
L128_pub:
    s_mov_b64 exec, -1
k_ld5:
    ds_write_b32 v13, v15 offset:52
    s_branch k_sp0
k_s2:
    s_setprio 3
    s_bfe_u32 s44, s2, 0x20001
    s_lshl_b32 s44, s44, 2
    s_bfe_u32 s45, s2, 0x20003
    s_add_u32 s44, s44, s45
    s_mul_i32 s45, s44, 114688
    s_and_b32 s46, s2, 1
    s_lshl_b32 s44, s44, 1
    s_add_u32 s44, s44, s46
    s_lshl_b32 s46, s46, 7
    s_add_u32 s45, s45, s46
    s_mul_i32 s46, s30, 28672
    s_add_u32 s45, s45, s46
    s_add_u32 s52, s45, 5242880
    v_lshrrev_b32 v3, 3, v1
    v_lshlrev_b32 v3, 8, v3
    v_and_b32 v4, 7, v1
    v_lshl_add_u32 v3, v4, 4, v3
    s_mov_b32 s47, 4096
    s_waitcnt vmcnt(2)
    v_readfirstlane_b32 s48, v251
    s_nop 0
    s_bitcmp0_b32 s48, 16
    s_cbranch_scc1 k_s2a
    s_sleep 6
k_s2b:
    s_mov_b32 s47, 0x8000
L129_sp:
    ds_read_b32 v14, v31 offset:44
    s_waitcnt lgkmcnt(0)
    v_readfirstlane_b32 s48, v14
    s_nop 0
    s_cmp_ge_u32 s48, 4
    s_cbranch_scc1 L130_ok
    s_sleep 2
    s_sub_u32 s47, s47, 1
    s_cbranch_scc0 L129_sp
L130_ok:
    s_mov_b32 s47, 4096
    buffer_load_dwordx4 v[32:35], v3, s[16:19], s52 offen offset:0 sc1
    buffer_load_dwordx4 v[36:39], v3, s[16:19], s52 offen offset:2048 sc1
    s_add_u32 s53, s52, 4096
    buffer_load_dwordx4 v[40:43], v3, s[16:19], s53 offen offset:0 sc1
    buffer_load_dwordx4 v[44:47], v3, s[16:19], s53 offen offset:2048 sc1
    s_add_u32 s54, s52, 8192
    buffer_load_dwordx4 v[48:51], v3, s[16:19], s54 offen offset:0 sc1
    buffer_load_dwordx4 v[52:55], v3, s[16:19], s54 offen offset:2048 sc1
    s_add_u32 s55, s52, 12288
    buffer_load_dwordx4 v[56:59], v3, s[16:19], s55 offen offset:0 sc1
    buffer_load_dwordx4 v[60:63], v3, s[16:19], s55 offen offset:2048 sc1
    s_add_u32 s56, s52, 16384
    buffer_load_dwordx4 v[64:67], v3, s[16:19], s56 offen offset:0 sc1
    buffer_load_dwordx4 v[68:71], v3, s[16:19], s56 offen offset:2048 sc1
    s_add_u32 s57, s52, 20480
    buffer_load_dwordx4 v[72:75], v3, s[16:19], s57 offen offset:0 sc1
    buffer_load_dwordx4 v[76:79], v3, s[16:19], s57 offen offset:2048 sc1
    s_add_u32 s58, s52, 24576
    buffer_load_dwordx4 v[80:83], v3, s[16:19], s58 offen offset:0 sc1
    buffer_load_dwordx4 v[84:87], v3, s[16:19], s58 offen offset:2048 sc1
    s_lshl_b32 s44, s44, 8
    s_add_u32 s44, s44, 21069824
    v_lshrrev_b32 v5, 5, v1
    v_lshlrev_b32 v5, 8, v5
    v_lshl_add_u32 v5, v4, 5, v5
    v_and_b32 v4, 16, v1
    v_add_u32 v5, v4, v5
    s_lshl_b32 s46, s30, 9
    s_add_u32 s46, s46, 161792
    v_add_u32 v5, s46, v5
    v_lshlrev_b32 v6, 2, v1
    v_add_u32 v7, 161792, v6
    s_mov_b32 s50, 0
    s_mov_b32 s45, 0x05040100
    s_mov_b32 s46, 0x07060302
    s_mov_b32 s49, 0x3f803f80
    v_mov_b32 v96, 0
    v_mov_b32 v97, 0
    v_mov_b32 v98, 0
    v_mov_b32 v99, 0
    v_mov_b32 v100, 0
    v_mov_b32 v101, 0
    v_mov_b32 v102, 0
    v_mov_b32 v103, 0
    v_mov_b32 v104, 0
    v_mov_b32 v105, 0
    v_mov_b32 v106, 0
    v_mov_b32 v107, 0
    v_mov_b32 v108, 0
    v_mov_b32 v109, 0
    v_mov_b32 v110, 0
    v_mov_b32 v111, 0
    s_mov_b32 s47, 0x1000
    s_mov_b32 s51, 0
    s_cmp_lg_u32 s51, 0
    s_waitcnt vmcnt(12)
k_s2c0:
    v_max_u32 v112, v32, v36
    v_cmp_eq_u32 vcc, -1, v112
    s_bitset0_b32 s50, 0
    s_nop 0
    s_cbranch_vccnz k_s2v0
    v_perm_b32 v112, v36, v32, s45
    v_perm_b32 v113, v36, v32, s46
    v_perm_b32 v114, v37, v33, s45
    v_perm_b32 v115, v37, v33, s46
    v_perm_b32 v116, v38, v34, s45
    v_perm_b32 v117, v38, v34, s46
    v_perm_b32 v118, v39, v35, s45
    v_perm_b32 v119, v39, v35, s46
    v_dot2c_f32_bf16 v96, s49, v112
    v_dot2c_f32_bf16 v104, v112, v112
    v_dot2c_f32_bf16 v97, s49, v113
    v_dot2c_f32_bf16 v105, v113, v113
    v_dot2c_f32_bf16 v98, s49, v114
    v_dot2c_f32_bf16 v106, v114, v114
    v_dot2c_f32_bf16 v99, s49, v115
    v_dot2c_f32_bf16 v107, v115, v115
    v_dot2c_f32_bf16 v100, s49, v116
    v_dot2c_f32_bf16 v108, v116, v116
    v_dot2c_f32_bf16 v101, s49, v117
    v_dot2c_f32_bf16 v109, v117, v117
    v_dot2c_f32_bf16 v102, s49, v118
    v_dot2c_f32_bf16 v110, v118, v118
    v_dot2c_f32_bf16 v103, s49, v119
    v_dot2c_f32_bf16 v111, v119, v119
k_s2n0:
    s_cbranch_scc1 k_s2q
    s_waitcnt vmcnt(10)
k_s2c1:
    v_max_u32 v112, v40, v44
    v_cmp_eq_u32 vcc, -1, v112
    s_bitset0_b32 s50, 1
    s_nop 0
    s_cbranch_vccnz k_s2v1
    v_perm_b32 v112, v44, v40, s45
    v_perm_b32 v113, v44, v40, s46
    v_perm_b32 v114, v45, v41, s45
    v_perm_b32 v115, v45, v41, s46
    v_perm_b32 v116, v46, v42, s45
    v_perm_b32 v117, v46, v42, s46
    v_perm_b32 v118, v47, v43, s45
    v_perm_b32 v119, v47, v43, s46
    v_dot2c_f32_bf16 v96, s49, v112
    v_dot2c_f32_bf16 v104, v112, v112
    v_dot2c_f32_bf16 v97, s49, v113
    v_dot2c_f32_bf16 v105, v113, v113
    v_dot2c_f32_bf16 v98, s49, v114
    v_dot2c_f32_bf16 v106, v114, v114
    v_dot2c_f32_bf16 v99, s49, v115
    v_dot2c_f32_bf16 v107, v115, v115
    v_dot2c_f32_bf16 v100, s49, v116
    v_dot2c_f32_bf16 v108, v116, v116
    v_dot2c_f32_bf16 v101, s49, v117
    v_dot2c_f32_bf16 v109, v117, v117
    v_dot2c_f32_bf16 v102, s49, v118
    v_dot2c_f32_bf16 v110, v118, v118
    v_dot2c_f32_bf16 v103, s49, v119
    v_dot2c_f32_bf16 v111, v119, v119
k_s2n1:
    s_cbranch_scc1 k_s2q
    s_waitcnt vmcnt(8)
k_s2c2:
    v_max_u32 v112, v48, v52
    v_cmp_eq_u32 vcc, -1, v112
    s_bitset0_b32 s50, 2
    s_nop 0
    s_cbranch_vccnz k_s2v2
    v_perm_b32 v112, v52, v48, s45
    v_perm_b32 v113, v52, v48, s46
    v_perm_b32 v114, v53, v49, s45
    v_perm_b32 v115, v53, v49, s46
    v_perm_b32 v116, v54, v50, s45
    v_perm_b32 v117, v54, v50, s46
    v_perm_b32 v118, v55, v51, s45
    v_perm_b32 v119, v55, v51, s46
    v_dot2c_f32_bf16 v96, s49, v112
    v_dot2c_f32_bf16 v104, v112, v112
    v_dot2c_f32_bf16 v97, s49, v113
    v_dot2c_f32_bf16 v105, v113, v113
    v_dot2c_f32_bf16 v98, s49, v114
    v_dot2c_f32_bf16 v106, v114, v114
    v_dot2c_f32_bf16 v99, s49, v115
    v_dot2c_f32_bf16 v107, v115, v115
    v_dot2c_f32_bf16 v100, s49, v116
    v_dot2c_f32_bf16 v108, v116, v116
    v_dot2c_f32_bf16 v101, s49, v117
    v_dot2c_f32_bf16 v109, v117, v117
    v_dot2c_f32_bf16 v102, s49, v118
    v_dot2c_f32_bf16 v110, v118, v118
    v_dot2c_f32_bf16 v103, s49, v119
    v_dot2c_f32_bf16 v111, v119, v119
k_s2n2:
    s_cbranch_scc1 k_s2q
    s_waitcnt vmcnt(6)
k_s2c3:
    v_max_u32 v112, v56, v60
    v_cmp_eq_u32 vcc, -1, v112
    s_bitset0_b32 s50, 3
    s_nop 0
    s_cbranch_vccnz k_s2v3
    v_perm_b32 v112, v60, v56, s45
    v_perm_b32 v113, v60, v56, s46
    v_perm_b32 v114, v61, v57, s45
    v_perm_b32 v115, v61, v57, s46
    v_perm_b32 v116, v62, v58, s45
    v_perm_b32 v117, v62, v58, s46
    v_perm_b32 v118, v63, v59, s45
    v_perm_b32 v119, v63, v59, s46
    v_dot2c_f32_bf16 v96, s49, v112
    v_dot2c_f32_bf16 v104, v112, v112
    v_dot2c_f32_bf16 v97, s49, v113
    v_dot2c_f32_bf16 v105, v113, v113
    v_dot2c_f32_bf16 v98, s49, v114
    v_dot2c_f32_bf16 v106, v114, v114
    v_dot2c_f32_bf16 v99, s49, v115
    v_dot2c_f32_bf16 v107, v115, v115
    v_dot2c_f32_bf16 v100, s49, v116
    v_dot2c_f32_bf16 v108, v116, v116
    v_dot2c_f32_bf16 v101, s49, v117
    v_dot2c_f32_bf16 v109, v117, v117
    v_dot2c_f32_bf16 v102, s49, v118
    v_dot2c_f32_bf16 v110, v118, v118
    v_dot2c_f32_bf16 v103, s49, v119
    v_dot2c_f32_bf16 v111, v119, v119
k_s2n3:
    s_cbranch_scc1 k_s2q
    s_waitcnt vmcnt(4)
k_s2c4:
    v_max_u32 v112, v64, v68
    v_cmp_eq_u32 vcc, -1, v112
    s_bitset0_b32 s50, 4
    s_nop 0
    s_cbranch_vccnz k_s2v4
    v_perm_b32 v112, v68, v64, s45
    v_perm_b32 v113, v68, v64, s46
    v_perm_b32 v114, v69, v65, s45
    v_perm_b32 v115, v69, v65, s46
    v_perm_b32 v116, v70, v66, s45
    v_perm_b32 v117, v70, v66, s46
    v_perm_b32 v118, v71, v67, s45
    v_perm_b32 v119, v71, v67, s46
    v_dot2c_f32_bf16 v96, s49, v112
    v_dot2c_f32_bf16 v104, v112, v112
    v_dot2c_f32_bf16 v97, s49, v113
    v_dot2c_f32_bf16 v105, v113, v113
    v_dot2c_f32_bf16 v98, s49, v114
    v_dot2c_f32_bf16 v106, v114, v114
    v_dot2c_f32_bf16 v99, s49, v115
    v_dot2c_f32_bf16 v107, v115, v115
    v_dot2c_f32_bf16 v100, s49, v116
    v_dot2c_f32_bf16 v108, v116, v116
    v_dot2c_f32_bf16 v101, s49, v117
    v_dot2c_f32_bf16 v109, v117, v117
    v_dot2c_f32_bf16 v102, s49, v118
    v_dot2c_f32_bf16 v110, v118, v118
    v_dot2c_f32_bf16 v103, s49, v119
    v_dot2c_f32_bf16 v111, v119, v119
k_s2n4:
    s_cbranch_scc1 k_s2q
    s_waitcnt vmcnt(2)
k_s2c5:
    v_max_u32 v112, v72, v76
    v_cmp_eq_u32 vcc, -1, v112
    s_bitset0_b32 s50, 5
    s_nop 0
    s_cbranch_vccnz k_s2v5
    v_perm_b32 v112, v76, v72, s45
    v_perm_b32 v113, v76, v72, s46
    v_perm_b32 v114, v77, v73, s45
    v_perm_b32 v115, v77, v73, s46
    v_perm_b32 v116, v78, v74, s45
    v_perm_b32 v117, v78, v74, s46
    v_perm_b32 v118, v79, v75, s45
    v_perm_b32 v119, v79, v75, s46
    v_dot2c_f32_bf16 v96, s49, v112
    v_dot2c_f32_bf16 v104, v112, v112
    v_dot2c_f32_bf16 v97, s49, v113
    v_dot2c_f32_bf16 v105, v113, v113
    v_dot2c_f32_bf16 v98, s49, v114
    v_dot2c_f32_bf16 v106, v114, v114
    v_dot2c_f32_bf16 v99, s49, v115
    v_dot2c_f32_bf16 v107, v115, v115
    v_dot2c_f32_bf16 v100, s49, v116
    v_dot2c_f32_bf16 v108, v116, v116
    v_dot2c_f32_bf16 v101, s49, v117
    v_dot2c_f32_bf16 v109, v117, v117
    v_dot2c_f32_bf16 v102, s49, v118
    v_dot2c_f32_bf16 v110, v118, v118
    v_dot2c_f32_bf16 v103, s49, v119
    v_dot2c_f32_bf16 v111, v119, v119
k_s2n5:
    s_cbranch_scc1 k_s2q
    s_waitcnt vmcnt(0)
k_s2c6:
    v_max_u32 v112, v80, v84
    v_cmp_eq_u32 vcc, -1, v112
    s_bitset0_b32 s50, 6
    s_nop 0
    s_cbranch_vccnz k_s2v6
    v_perm_b32 v112, v84, v80, s45
    v_perm_b32 v113, v84, v80, s46
    v_perm_b32 v114, v85, v81, s45
    v_perm_b32 v115, v85, v81, s46
    v_perm_b32 v116, v86, v82, s45
    v_perm_b32 v117, v86, v82, s46
    v_perm_b32 v118, v87, v83, s45
    v_perm_b32 v119, v87, v83, s46
    v_dot2c_f32_bf16 v96, s49, v112
    v_dot2c_f32_bf16 v104, v112, v112
    v_dot2c_f32_bf16 v97, s49, v113
    v_dot2c_f32_bf16 v105, v113, v113
    v_dot2c_f32_bf16 v98, s49, v114
    v_dot2c_f32_bf16 v106, v114, v114
    v_dot2c_f32_bf16 v99, s49, v115
    v_dot2c_f32_bf16 v107, v115, v115
    v_dot2c_f32_bf16 v100, s49, v116
    v_dot2c_f32_bf16 v108, v116, v116
    v_dot2c_f32_bf16 v101, s49, v117
    v_dot2c_f32_bf16 v109, v117, v117
    v_dot2c_f32_bf16 v102, s49, v118
    v_dot2c_f32_bf16 v110, v118, v118
    v_dot2c_f32_bf16 v103, s49, v119
    v_dot2c_f32_bf16 v111, v119, v119
k_s2n6:
    s_cbranch_scc1 k_s2q
k_s2t:
    s_cmp_lg_u32 s51, 0
    s_cbranch_scc1 k_s2p
k_s2d:
    s_nop 1
    v_permlane32_swap_b32 v96, v104
    v_permlane32_swap_b32 v97, v105
    v_permlane32_swap_b32 v98, v106
    v_permlane32_swap_b32 v99, v107
    v_permlane32_swap_b32 v100, v108
    v_permlane32_swap_b32 v101, v109
    v_permlane32_swap_b32 v102, v110
    v_permlane32_swap_b32 v103, v111
    v_add_f32 v96, v96, v104
    v_add_f32 v97, v97, v105
    v_add_f32 v98, v98, v106
    v_add_f32 v99, v99, v107
    v_add_f32 v100, v100, v108
    v_add_f32 v101, v101, v109
    v_add_f32 v102, v102, v110
    v_add_f32 v103, v103, v111
    v_permlane16_swap_b32 v96, v100
    v_permlane16_swap_b32 v97, v101
    v_permlane16_swap_b32 v98, v102
    v_permlane16_swap_b32 v99, v103
    v_add_f32 v96, v96, v100
    v_add_f32 v97, v97, v101
    v_add_f32 v98, v98, v102
    v_add_f32 v99, v99, v103
    v_add_f32_dpp v96, v96, v96 row_ror:8 row_mask:0xf bank_mask:0xf
    v_add_f32_dpp v97, v97, v97 row_ror:8 row_mask:0xf bank_mask:0xf
    v_add_f32_dpp v98, v98, v98 row_ror:8 row_mask:0xf bank_mask:0xf
    v_add_f32_dpp v99, v99, v99 row_ror:8 row_mask:0xf bank_mask:0xf
    ds_write_b128 v5, v[96:99]
    s_mov_b64 exec, 1
    ds_add_rtn_u32 v14, v31, v15 offset:40
    s_waitcnt lgkmcnt(0)
    v_readfirstlane_b32 s48, v14
    s_mov_b64 exec, -1
    s_cmp_lg_u32 s48, 3
    s_cbranch_scc1 k_spare_end
    ds_read2st64_b32 v[32:33], v7 offset0:0 offset1:1
    ds_read2st64_b32 v[34:35], v7 offset0:2 offset1:3
    ds_read2st64_b32 v[36:37], v7 offset0:4 offset1:5
    ds_read2st64_b32 v[38:39], v7 offset0:6 offset1:7
    s_waitcnt lgkmcnt(0)
    v_pk_add_f32 v[32:33], v[32:33], v[34:35]
    v_pk_add_f32 v[36:37], v[36:37], v[38:39]
    v_pk_add_f32 v[32:33], v[32:33], v[36:37]
    v_mul_f32 v32, 0x3b124925, v32
    v_mul_f32 v33, 0x3b124925, v33
    v_fma_f32 v33, -v32, v32, v33
    v_max_f32 v33, 0, v33
    v_cvt_pk_bf16_f32 v33, v33, v33
    v_lshlrev_b32 v33, 16, v33
    v_add_f32 v33, 0x3727c5ac, v33
    v_cvt_pk_bf16_f32 v33, v33, v33
    v_lshlrev_b32 v33, 16, v33
    v_sqrt_f32 v33, v33
    s_nop 0
    v_cvt_pk_bf16_f32 v32, v32, v33
    buffer_store_dword v32, v6, s[16:19], s44 offen sc1
    s_branch k_spare_end
k_s2a:
    s_mov_b64 exec, 1
    s_cmp_lt_u32 s47, 4072
    s_cbranch_scc1 k_s2g
    buffer_load_dword v14, v250, s[96:99], 0 offen offset:124 sc1
    s_waitcnt vmcnt(0)
    v_readfirstlane_b32 s48, v14
    s_mov_b64 exec, -1
    s_sleep 12
    s_bitcmp1_b32 s48, 16
    s_cbranch_scc1 k_s2b
    s_sub_u32 s47, s47, 1
    s_branch k_s2a
k_s2g:
    buffer_load_dwordx2 v[12:13], v250, s[96:99], 0 offen offset:160 sc1
    s_waitcnt vmcnt(0)
    v_and_b32 v12, v12, v13
    s_nop 0
    v_readfirstlane_b32 s48, v12
    s_mov_b64 exec, -1
    s_cmp_eq_u32 s48, 0x01010101
    s_cbranch_scc1 k_s2b
    s_sleep 16
    s_sub_u32 s47, s47, 1
    s_cbranch_scc0 k_s2a
    s_branch k_s2b
k_s2v0:
    s_mov_b64 exec, vcc
    buffer_load_dwordx4 v[32:35], v3, s[16:19], s52 offen offset:0 sc1
    buffer_load_dwordx4 v[36:39], v3, s[16:19], s52 offen offset:2048 sc1
    s_mov_b64 exec, -1
    s_bitset1_b32 s51, 0
    s_branch k_s2n0
k_s2v1:
    s_mov_b64 exec, vcc
    buffer_load_dwordx4 v[40:43], v3, s[16:19], s53 offen offset:0 sc1
    buffer_load_dwordx4 v[44:47], v3, s[16:19], s53 offen offset:2048 sc1
    s_mov_b64 exec, -1
    s_bitset1_b32 s51, 1
    s_branch k_s2n1
k_s2v2:
    s_mov_b64 exec, vcc
    buffer_load_dwordx4 v[48:51], v3, s[16:19], s54 offen offset:0 sc1
    buffer_load_dwordx4 v[52:55], v3, s[16:19], s54 offen offset:2048 sc1
    s_mov_b64 exec, -1
    s_bitset1_b32 s51, 2
    s_branch k_s2n2
k_s2v3:
    s_mov_b64 exec, vcc
    buffer_load_dwordx4 v[56:59], v3, s[16:19], s55 offen offset:0 sc1
    buffer_load_dwordx4 v[60:63], v3, s[16:19], s55 offen offset:2048 sc1
    s_mov_b64 exec, -1
    s_bitset1_b32 s51, 3
    s_branch k_s2n3
k_s2v4:
    s_mov_b64 exec, vcc
    buffer_load_dwordx4 v[64:67], v3, s[16:19], s56 offen offset:0 sc1
    buffer_load_dwordx4 v[68:71], v3, s[16:19], s56 offen offset:2048 sc1
    s_mov_b64 exec, -1
    s_bitset1_b32 s51, 4
    s_branch k_s2n4
k_s2v5:
    s_mov_b64 exec, vcc
    buffer_load_dwordx4 v[72:75], v3, s[16:19], s57 offen offset:0 sc1
    buffer_load_dwordx4 v[76:79], v3, s[16:19], s57 offen offset:2048 sc1
    s_mov_b64 exec, -1
    s_bitset1_b32 s51, 5
    s_branch k_s2n5
k_s2v6:
    s_mov_b64 exec, vcc
    buffer_load_dwordx4 v[80:83], v3, s[16:19], s58 offen offset:0 sc1
    buffer_load_dwordx4 v[84:87], v3, s[16:19], s58 offen offset:2048 sc1
    s_mov_b64 exec, -1
    s_bitset1_b32 s51, 6
    s_branch k_s2n6
k_s2p:
    s_sub_u32 s47, s47, 1
    s_cbranch_scc1 k_s2d
    s_mov_b32 s50, s51
    s_mov_b32 s51, 0
    s_waitcnt vmcnt(0)
k_s2q:
    s_bitcmp1_b32 s50, 0
    s_cbranch_scc1 k_s2c0
    s_bitcmp1_b32 s50, 1
    s_cbranch_scc1 k_s2c1
    s_bitcmp1_b32 s50, 2
    s_cbranch_scc1 k_s2c2
    s_bitcmp1_b32 s50, 3
    s_cbranch_scc1 k_s2c3
    s_bitcmp1_b32 s50, 4
    s_cbranch_scc1 k_s2c4
    s_bitcmp1_b32 s50, 5
    s_cbranch_scc1 k_s2c5
    s_bitcmp1_b32 s50, 6
    s_cbranch_scc1 k_s2c6
    s_branch k_s2t
.section .rodata,"a"
.p2align 6
.amdhsa_kernel sequential_preLN__ssm_conv_h3__glu_gated_swiglu__prompt_kernel
  .amdhsa_next_free_vgpr 256
  .amdhsa_next_free_sgpr 100
  .amdhsa_accum_offset 256
  .amdhsa_group_segment_fixed_size 0
  .amdhsa_kernarg_size 104
  .amdhsa_user_sgpr_count 2
  .amdhsa_user_sgpr_kernarg_segment_ptr 1
  .amdhsa_system_sgpr_workgroup_id_x 1
.end_amdhsa_kernel
```
